```python
import torch

def _softmax(x, axis=-1):
    return torch.softmax(x, dim=axis)

def _gelu(x):
    return torch.nn.functional.gelu(x, approximate='tanh')

def _silu(x):
    return torch.nn.functional.silu(x)

def _sigmoid(x):
    return torch.sigmoid(x)

def _layernorm(x, axis=-1, eps=1e-05):
    m = x.mean(dim=axis, keepdim=True)
    v = x.var(dim=axis, keepdim=True, unbiased=False)
    return (x - m) / torch.sqrt(v + eps)

def _scatter_add(tgt, idx, src, axis=0):
    return tgt.clone().index_add_(axis, idx, src)

def _segment_sum(src, seg, n):
    out = torch.zeros((n,) + src.shape[1:], dtype=src.dtype)
    return out.index_add_(0, seg, src)

def _pad(x, pw):
    flat = tuple((v for pair in reversed(pw) for v in pair))
    return torch.nn.functional.pad(x, flat)
kernel_name = 'standalone__pixart__diffusion'

def setup_inputs():

    _w = lambda a: (lambda t: t.to(torch.bfloat16) if t.is_floating_point() else t)(torch.as_tensor(a))
    B, N, D, M = (2, 1024, 1152, 77)
    return {'x': _w((lambda *s: torch.randn(*s, dtype=torch.bfloat16) * 0.05)(B, N, D)), 'c': _w((lambda *s: torch.randn(*s, dtype=torch.bfloat16) * 0.05)(B, D)), 'y': _w((lambda *s: torch.randn(*s, dtype=torch.bfloat16) * 0.1)(B, M, D)), 'wqkv': _w((lambda *s: torch.randn(*s, dtype=torch.bfloat16) * 0.05)(D, 3 * D)), 'wo': _w((lambda *s: torch.randn(*s, dtype=torch.bfloat16) * 0.05)(D, D)), 'wq_c': _w((lambda *s: torch.randn(*s, dtype=torch.bfloat16) * 0.1)(D, D)), 'wkv_c': _w((lambda *s: torch.randn(*s, dtype=torch.bfloat16) * 0.1)(D, 2 * D)), 'wo_c': _w((lambda *s: torch.randn(*s, dtype=torch.bfloat16) * 0.05)(D, D)), 'w_mod': _w((lambda *s: torch.randn(*s, dtype=torch.bfloat16) * 0.05)(D, 6 * D))}

def reference(x, c, y, wqkv, wo, wq_c, wkv_c, wo_c, w_mod):
    B, N, D = x.shape
    mod = (_silu(c) @ w_mod).reshape(B, 6, 1, D)
    shift_a, scale_a, gate_a, shift_m, scale_m, gate_m = [mod[:, i] for i in range(6)]
    h = _layernorm(x, axis=-1) * (1 + scale_a) + shift_a
    qkv = h @ wqkv
    q, k, v = (qkv[..., :D].clone(), qkv[..., D:2 * D].clone(), qkv[..., 2 * D:].clone())
    p = _softmax(torch.einsum('bqd,bkd->bqk', q, k) * D ** (-0.5), axis=-1)
    x = x + gate_a * (torch.einsum('bqk,bkd->bqd', p, v) @ wo)
    hc = _layernorm(x, axis=-1)
    qc = hc @ wq_c
    kvc = y @ wkv_c
    kc, vc = (kvc[..., :D].clone(), kvc[..., D:].clone())
    pc = _softmax(torch.einsum('bqd,bkd->bqk', qc, kc) * D ** (-0.5), axis=-1)
    return x + torch.einsum('bqk,bkd->bqd', pc, vc) @ wo_c
```

```asm
; @launch kernel=standalone__pixart__diffusion_kernel grid=(256,1,1) block=(512,1,1) lds=163840
.amdgcn_target "amdgcn-amd-amdhsa--gfx950"
.text
.p2align 8
code_start:
.globl standalone__pixart__diffusion_kernel
.p2align 8
.type standalone__pixart__diffusion_kernel,@function
standalone__pixart__diffusion_kernel:
    s_getpc_b64 s[76:77]
    s_load_dwordx16 s[40:55], s[0:1], 0
    s_load_dwordx8 s[56:63], s[0:1], 64
    s_lshr_b32 s65, s2, 3
    s_lshl_b32 s78, s65, 11
    v_lshrrev_b32 v1, 6, v0
    v_and_b32 v2, 1, v0
    v_lshl_add_u32 v2, v1, 1, v2
    v_lshl_add_u32 v2, v2, 7, s78
    v_min_u32 v2, code_end - code_start - 8, v2
    s_mov_b64 exec, 3
    global_load_dword v15, v2, s[76:77]
    s_mov_b64 exec, -1
    s_cmp_ge_u32 s2, 256
    s_cbranch_scc1 quit0
    v_and_b32 v0, 63, v0
    v_readfirstlane_b32 s3, v1
    s_and_b32 s64, s2, 7
    s_mov_b32 s80, 0
    s_mov_b32 s81, 0
    s_cmp_ge_u32 s65, 23
    s_cbranch_scc1 pa_mod
    s_cmp_lt_u32 s65, 8
    s_cbranch_scc1 pa_h
    s_and_b32 s66, s64, 1
    s_lshr_b32 s67, s64, 1
    s_sub_u32 s68, 5, s66
    s_mul_i32 s70, s68, 3
    s_sub_u32 s69, s65, 8
    s_cmp_ge_u32 s69, s70
    s_cbranch_scc1 pa_spare
    s_mul_i32 s71, s69, 13
    s_lshr_b32 s71, s71, 6
    s_lshr_b32 s72, s69, 2
    s_cmp_eq_u32 s66, 0
    s_cselect_b32 s71, s71, s72
    s_mul_i32 s72, s71, s68
    s_sub_u32 s72, s69, s72
    s_lshl_b32 s74, s71, 1
    s_add_u32 s74, s74, s72
    s_mul_i32 s27, s74, 11
    s_lshr_b32 s27, s27, 6
    s_mul_i32 s27, s27, 6
    s_sub_u32 s74, s74, s27
    s_mul_i32 s73, s66, 5
    s_add_u32 s72, s72, s73
    s_mul_i32 s73, s67, 3
    s_add_u32 s71, s71, s73
    s_mul_i32 s24, s72, 884736
    s_mul_i32 s25, s71, 663552
    s_add_u32 s25, s25, 2304
    s_lshl_b32 s75, s72, 2
    s_mul_i32 s76, s71, 6
    s_mul_i32 s77, s71, 9
    s_add_u32 s77, s77, s72
    s_add_u32 s78, s77, 154
    s_waitcnt lgkmcnt(0)
    s_getpc_b64 s[0:1]
tt_pc_1:
    s_lshl_b32 s85, s2, 3
    s_add_u32 s85, s85, task_table - tt_pc_1
    s_load_dwordx2 s[0:1], s[0:1], s85
    s_mov_b32 s36, s62
    s_mov_b32 s37, s63
    s_mov_b32 s38, 131072
    s_mov_b32 s39, 0x00020000
    s_mov_b32 s4, s46
    s_mov_b32 s5, s47
    s_mov_b32 s6, 7962624
    s_mov_b32 s7, 0x00020000
    s_add_u32 s12, s62, 5029888
    s_addc_u32 s13, s63, 0
    s_mov_b32 s14, 2654208
    s_mov_b32 s15, 0x00020000
    s_cmp_ge_u32 s3, 4
    s_cbranch_scc1 wqk_loader_2
    s_mul_i32 s79, s3, 108
    s_add_u32 s79, s79, s77
    s_add_u32 s79, s79, 512
    s_lshl_b32 s28, s79, 6
    s_cmp_ge_u32 s28, 41472
    s_cbranch_scc1 pfc_4
    v_add_u32 v1, s28, v0
    s_mov_b32 s27, 58255
    v_mul_lo_u32 v2, v1, s27
    v_lshrrev_b32 v2, 21, v2
    s_mov_b32 s27, 2304
    v_mul_u32_u24 v2, s27, v2
    v_lshl_add_u32 v1, v1, 7, v2
    s_mov_b32 s27, 0
    buffer_load_dword v12, v1, s[4:7], s27 offen
pfc_4:
    s_and_b32 s84, s3, 1
    s_lshr_b32 s83, s3, 1
    s_mul_i32 s27, s83, 8192
    s_add_u32 s27, s27, 0
    v_bfe_u32 v2, v0, 1, 3
    v_lshrrev_b32 v3, 4, v0
    v_xor_b32 v2, v2, v3
    v_lshlrev_b32 v2, 4, v2
    v_and_b32 v3, 15, v0
    v_lshl_add_u32 v4, v3, 7, v2
    v_add_u32 v4, s27, v4
    v_xor_b32 v5, 64, v4
    s_mul_i32 s27, s84, 6144
    s_add_u32 s27, s27, 65536
    v_bfe_u32 v2, v0, 1, 3
    v_lshrrev_b32 v3, 4, v0
    v_xor_b32 v2, v2, v3
    v_lshlrev_b32 v2, 4, v2
    v_and_b32 v3, 15, v0
    v_lshl_add_u32 v6, v3, 7, v2
    v_add_u32 v6, s27, v6
    v_xor_b32 v7, 64, v6
    v_mov_b32 v16, 0
    v_mov_b32 v17, 0
    v_mov_b32 v18, 0
    v_mov_b32 v19, 0
    v_mov_b32 v20, 0
    v_mov_b32 v21, 0
    v_mov_b32 v22, 0
    v_mov_b32 v23, 0
    v_mov_b32 v24, 0
    v_mov_b32 v25, 0
    v_mov_b32 v26, 0
    v_mov_b32 v27, 0
    v_mov_b32 v28, 0
    v_mov_b32 v29, 0
    v_mov_b32 v30, 0
    v_mov_b32 v31, 0
    v_mov_b32 v32, 0
    v_mov_b32 v33, 0
    v_mov_b32 v34, 0
    v_mov_b32 v35, 0
    v_mov_b32 v36, 0
    v_mov_b32 v37, 0
    v_mov_b32 v38, 0
    v_mov_b32 v39, 0
    v_mov_b32 v40, 0
    v_mov_b32 v41, 0
    v_mov_b32 v42, 0
    v_mov_b32 v43, 0
    v_mov_b32 v44, 0
    v_mov_b32 v45, 0
    v_mov_b32 v46, 0
    v_mov_b32 v47, 0
    v_mov_b32 v48, 0
    v_mov_b32 v49, 0
    v_mov_b32 v50, 0
    v_mov_b32 v51, 0
    v_mov_b32 v52, 0
    v_mov_b32 v53, 0
    v_mov_b32 v54, 0
    v_mov_b32 v55, 0
    v_mov_b32 v56, 0
    v_mov_b32 v57, 0
    v_mov_b32 v58, 0
    v_mov_b32 v59, 0
    v_mov_b32 v60, 0
    v_mov_b32 v61, 0
    v_mov_b32 v62, 0
    v_mov_b32 v63, 0
    s_mov_b32 s33, 0
    s_mov_b32 s31, 0
    s_mov_b32 s30, 16384
    s_mov_b32 s32, 12288
    s_mov_b32 s34, 17
    s_barrier
    ds_read_b128 v[80:83], v6 offset:0
    ds_read_b128 v[84:87], v6 offset:2048
    ds_read_b128 v[88:91], v6 offset:4096
    ds_read_b128 v[64:67], v4 offset:0
    ds_read_b128 v[68:71], v4 offset:2048
    ds_read_b128 v[72:75], v4 offset:4096
    ds_read_b128 v[76:79], v4 offset:6144
    s_waitcnt lgkmcnt(0)
wqk_mm_5:
    v_mfma_f32_16x16x32_bf16 v[16:19], v[64:67], v[80:83], v[16:19]
    ds_read_b128 v[108:111], v7 offset:0
    v_mfma_f32_16x16x32_bf16 v[20:23], v[64:67], v[84:87], v[20:23]
    ds_read_b128 v[112:115], v7 offset:2048
    v_mfma_f32_16x16x32_bf16 v[24:27], v[64:67], v[88:91], v[24:27]
    ds_read_b128 v[116:119], v7 offset:4096
    v_mfma_f32_16x16x32_bf16 v[28:31], v[68:71], v[80:83], v[28:31]
    ds_read_b128 v[92:95], v5 offset:0
    v_mfma_f32_16x16x32_bf16 v[32:35], v[68:71], v[84:87], v[32:35]
    ds_read_b128 v[96:99], v5 offset:2048
    v_mfma_f32_16x16x32_bf16 v[36:39], v[68:71], v[88:91], v[36:39]
    ds_read_b128 v[100:103], v5 offset:4096
    v_mfma_f32_16x16x32_bf16 v[40:43], v[72:75], v[80:83], v[40:43]
    ds_read_b128 v[104:107], v5 offset:6144
    v_mfma_f32_16x16x32_bf16 v[44:47], v[72:75], v[84:87], v[44:47]
    s_add_u32 s33, s33, 1
    v_mfma_f32_16x16x32_bf16 v[48:51], v[72:75], v[88:91], v[48:51]
    s_cmp_eq_u32 s33, 4
    v_mfma_f32_16x16x32_bf16 v[52:55], v[76:79], v[80:83], v[52:55]
    s_cselect_b32 s35, 4294918144, s30
    v_mfma_f32_16x16x32_bf16 v[56:59], v[76:79], v[84:87], v[56:59]
    s_cselect_b32 s29, 4294930432, s32
    v_mfma_f32_16x16x32_bf16 v[60:63], v[76:79], v[88:91], v[60:63]
    s_cselect_b32 s33, 0, s33
    v_add_u32 v4, s35, v4
    v_add_u32 v5, s35, v5
    v_add_u32 v6, s29, v6
    v_add_u32 v7, s29, v7
    s_waitcnt lgkmcnt(0)
    s_barrier
    v_mfma_f32_16x16x32_bf16 v[16:19], v[92:95], v[108:111], v[16:19]
    ds_read_b128 v[80:83], v6 offset:0
    v_mfma_f32_16x16x32_bf16 v[20:23], v[92:95], v[112:115], v[20:23]
    ds_read_b128 v[84:87], v6 offset:2048
    v_mfma_f32_16x16x32_bf16 v[24:27], v[92:95], v[116:119], v[24:27]
    ds_read_b128 v[88:91], v6 offset:4096
    v_mfma_f32_16x16x32_bf16 v[28:31], v[96:99], v[108:111], v[28:31]
    ds_read_b128 v[64:67], v4 offset:0
    v_mfma_f32_16x16x32_bf16 v[32:35], v[96:99], v[112:115], v[32:35]
    ds_read_b128 v[68:71], v4 offset:2048
    v_mfma_f32_16x16x32_bf16 v[36:39], v[96:99], v[116:119], v[36:39]
    ds_read_b128 v[72:75], v4 offset:4096
    v_mfma_f32_16x16x32_bf16 v[40:43], v[100:103], v[108:111], v[40:43]
    ds_read_b128 v[76:79], v4 offset:6144
    v_mfma_f32_16x16x32_bf16 v[44:47], v[100:103], v[112:115], v[44:47]
    s_sub_u32 s34, s34, 1
    v_mfma_f32_16x16x32_bf16 v[48:51], v[100:103], v[116:119], v[48:51]
    s_cmp_lg_u32 s34, 0
    v_mfma_f32_16x16x32_bf16 v[52:55], v[104:107], v[108:111], v[52:55]
    v_mfma_f32_16x16x32_bf16 v[56:59], v[104:107], v[112:115], v[56:59]
    v_mfma_f32_16x16x32_bf16 v[60:63], v[104:107], v[116:119], v[60:63]
    s_waitcnt lgkmcnt(0)
    s_cbranch_scc1 wqk_mm_5
    v_mfma_f32_16x16x32_bf16 v[16:19], v[64:67], v[80:83], v[16:19]
    ds_read_b128 v[108:111], v7 offset:0
    v_mfma_f32_16x16x32_bf16 v[20:23], v[64:67], v[84:87], v[20:23]
    ds_read_b128 v[112:115], v7 offset:2048
    v_mfma_f32_16x16x32_bf16 v[24:27], v[64:67], v[88:91], v[24:27]
    ds_read_b128 v[116:119], v7 offset:4096
    v_mfma_f32_16x16x32_bf16 v[28:31], v[68:71], v[80:83], v[28:31]
    ds_read_b128 v[92:95], v5 offset:0
    v_mfma_f32_16x16x32_bf16 v[32:35], v[68:71], v[84:87], v[32:35]
    ds_read_b128 v[96:99], v5 offset:2048
    v_mfma_f32_16x16x32_bf16 v[36:39], v[68:71], v[88:91], v[36:39]
    ds_read_b128 v[100:103], v5 offset:4096
    v_mfma_f32_16x16x32_bf16 v[40:43], v[72:75], v[80:83], v[40:43]
    ds_read_b128 v[104:107], v5 offset:6144
    v_mfma_f32_16x16x32_bf16 v[44:47], v[72:75], v[84:87], v[44:47]
    v_mfma_f32_16x16x32_bf16 v[48:51], v[72:75], v[88:91], v[48:51]
    v_mfma_f32_16x16x32_bf16 v[52:55], v[76:79], v[80:83], v[52:55]
    v_mfma_f32_16x16x32_bf16 v[56:59], v[76:79], v[84:87], v[56:59]
    v_mfma_f32_16x16x32_bf16 v[60:63], v[76:79], v[88:91], v[60:63]
    s_waitcnt lgkmcnt(0)
    v_mfma_f32_16x16x32_bf16 v[16:19], v[92:95], v[108:111], v[16:19]
    v_mfma_f32_16x16x32_bf16 v[20:23], v[92:95], v[112:115], v[20:23]
    v_mfma_f32_16x16x32_bf16 v[24:27], v[92:95], v[116:119], v[24:27]
    v_mfma_f32_16x16x32_bf16 v[28:31], v[96:99], v[108:111], v[28:31]
    v_mfma_f32_16x16x32_bf16 v[32:35], v[96:99], v[112:115], v[32:35]
    v_mfma_f32_16x16x32_bf16 v[36:39], v[96:99], v[116:119], v[36:39]
    v_mfma_f32_16x16x32_bf16 v[40:43], v[100:103], v[108:111], v[40:43]
    v_mfma_f32_16x16x32_bf16 v[44:47], v[100:103], v[112:115], v[44:47]
    v_mfma_f32_16x16x32_bf16 v[48:51], v[100:103], v[116:119], v[48:51]
    v_mfma_f32_16x16x32_bf16 v[52:55], v[104:107], v[108:111], v[52:55]
    v_mfma_f32_16x16x32_bf16 v[56:59], v[104:107], v[112:115], v[56:59]
    v_mfma_f32_16x16x32_bf16 v[60:63], v[104:107], v[116:119], v[60:63]
    s_mul_i32 s27, s83, 2
    s_add_u32 s27, s27, s75
    s_mul_i32 s27, s27, 72
    s_mul_i32 s28, s84, 3
    s_add_u32 s27, s27, s28
    s_add_u32 s27, s27, s76
    s_lshl_b32 s26, s27, 10
    v_lshlrev_b32 v1, 4, v0
    s_nop 1
    v_cvt_pk_bf16_f32 v64, v16, v17
    v_cvt_pk_bf16_f32 v65, v18, v19
    v_cvt_pk_bf16_f32 v66, v28, v29
    v_cvt_pk_bf16_f32 v67, v30, v31
    s_add_u32 s27, s26, 0
    buffer_store_dwordx4 v[64:67], v1, s[12:15], s27 offen offset:0 sc1
    v_cvt_pk_bf16_f32 v68, v20, v21
    v_cvt_pk_bf16_f32 v69, v22, v23
    v_cvt_pk_bf16_f32 v70, v32, v33
    v_cvt_pk_bf16_f32 v71, v34, v35
    s_add_u32 s27, s26, 0
    buffer_store_dwordx4 v[68:71], v1, s[12:15], s27 offen offset:1024 sc1
    v_cvt_pk_bf16_f32 v72, v24, v25
    v_cvt_pk_bf16_f32 v73, v26, v27
    v_cvt_pk_bf16_f32 v74, v36, v37
    v_cvt_pk_bf16_f32 v75, v38, v39
    s_add_u32 s27, s26, 0
    buffer_store_dwordx4 v[72:75], v1, s[12:15], s27 offen offset:2048 sc1
    v_cvt_pk_bf16_f32 v76, v40, v41
    v_cvt_pk_bf16_f32 v77, v42, v43
    v_cvt_pk_bf16_f32 v78, v52, v53
    v_cvt_pk_bf16_f32 v79, v54, v55
    s_add_u32 s27, s26, 73728
    buffer_store_dwordx4 v[76:79], v1, s[12:15], s27 offen offset:0 sc1
    v_cvt_pk_bf16_f32 v80, v44, v45
    v_cvt_pk_bf16_f32 v81, v46, v47
    v_cvt_pk_bf16_f32 v82, v56, v57
    v_cvt_pk_bf16_f32 v83, v58, v59
    s_add_u32 s27, s26, 73728
    buffer_store_dwordx4 v[80:83], v1, s[12:15], s27 offen offset:1024 sc1
    v_cvt_pk_bf16_f32 v84, v48, v49
    v_cvt_pk_bf16_f32 v85, v50, v51
    v_cvt_pk_bf16_f32 v86, v60, v61
    v_cvt_pk_bf16_f32 v87, v62, v63
    s_add_u32 s27, s26, 73728
    buffer_store_dwordx4 v[84:87], v1, s[12:15], s27 offen offset:2048 sc1
    s_mov_b64 exec, -1
    s_lshl_b32 s27, s78, 7
    v_mov_b32 v8, 0
    v_mov_b32 v9, 1
    s_cmp_lg_u32 s3, 0
    s_waitcnt vmcnt(0)
    s_barrier
    s_cbranch_scc1 sig_6
    s_mov_b64 exec, 1
    buffer_store_dword v9, v8, s[36:39], s27 offen sc1
    s_mov_b64 exec, -1
sig_6:
wqk_exit_7:
    s_mov_b64 exec, -1
    s_branch next_task
wqk_loader_2:
    s_and_b32 s82, s3, 1
    s_cmp_ge_u32 s3, 6
    s_cbranch_scc1 wqk_loaderB_3
    s_lshl_b32 s27, s82, 2
    v_lshrrev_b32 v2, 4, v0
    v_add_u32 v2, s27, v2
    v_and_b32 v1, 7, v0
    v_xor_b32 v1, v1, v2
    v_lshlrev_b32 v1, 4, v1
    s_lshl_b32 s27, s82, 4
    v_lshrrev_b32 v2, 5, v0
    v_lshlrev_b32 v2, 3, v2
    v_add_u32 v2, s27, v2
    v_bfe_u32 v3, v0, 3, 2
    v_add_u32 v2, v2, v3
    s_mov_b32 s27, 6912
    v_mad_u32_u24 v1, v2, s27, v1
    s_mov_b32 s31, s24
    s_lshl_b32 s32, s82, 10
    s_add_u32 s32, s32, 0
    s_add_u32 s29, s31, 768
    s_mov_b32 s35, 0
    s_mul_i32 s27, s74, 128
    s_add_u32 s31, s31, s27
    s_mov_b32 m0, s32
    s_nop 0
    buffer_load_dwordx4 v1, s[4:7], s31 offen lds
    s_add_u32 m0, s32, 2048
    s_add_u32 s27, s31, 27648
    buffer_load_dwordx4 v1, s[4:7], s27 offen lds
    s_add_u32 m0, s32, 4096
    s_add_u32 s27, s31, 221184
    buffer_load_dwordx4 v1, s[4:7], s27 offen lds
    s_add_u32 m0, s32, 6144
    s_add_u32 s27, s31, 248832
    buffer_load_dwordx4 v1, s[4:7], s27 offen lds
    s_add_u32 m0, s32, 8192
    s_add_u32 s27, s31, 442368
    buffer_load_dwordx4 v1, s[4:7], s27 offen lds
    s_add_u32 m0, s32, 10240
    s_add_u32 s27, s31, 470016
    buffer_load_dwordx4 v1, s[4:7], s27 offen lds
    s_add_u32 m0, s32, 12288
    s_add_u32 s27, s31, 663552
    buffer_load_dwordx4 v1, s[4:7], s27 offen lds
    s_add_u32 m0, s32, 14336
    s_add_u32 s27, s31, 691200
    buffer_load_dwordx4 v1, s[4:7], s27 offen lds
    s_add_u32 s31, s31, 128
    s_cmp_ge_u32 s31, s29
    s_cselect_b32 s27, 768, 0
    s_sub_u32 s31, s31, s27
    s_add_u32 s35, s35, 1
    s_cmp_eq_u32 s35, 6
    s_cselect_b32 s27, 768, 0
    s_cselect_b32 s35, 0, s35
    s_add_u32 s31, s31, s27
    s_add_u32 s29, s29, s27
    s_add_u32 m0, s32, 16384
    s_nop 0
    buffer_load_dwordx4 v1, s[4:7], s31 offen lds
    s_add_u32 m0, s32, 18432
    s_add_u32 s27, s31, 27648
    buffer_load_dwordx4 v1, s[4:7], s27 offen lds
    s_add_u32 m0, s32, 20480
    s_add_u32 s27, s31, 221184
    buffer_load_dwordx4 v1, s[4:7], s27 offen lds
    s_add_u32 m0, s32, 22528
    s_add_u32 s27, s31, 248832
    buffer_load_dwordx4 v1, s[4:7], s27 offen lds
    s_add_u32 m0, s32, 24576
    s_add_u32 s27, s31, 442368
    buffer_load_dwordx4 v1, s[4:7], s27 offen lds
    s_add_u32 m0, s32, 26624
    s_add_u32 s27, s31, 470016
    buffer_load_dwordx4 v1, s[4:7], s27 offen lds
    s_add_u32 m0, s32, 28672
    s_add_u32 s27, s31, 663552
    buffer_load_dwordx4 v1, s[4:7], s27 offen lds
    s_add_u32 m0, s32, 30720
    s_add_u32 s27, s31, 691200
    buffer_load_dwordx4 v1, s[4:7], s27 offen lds
    s_add_u32 s31, s31, 128
    s_cmp_ge_u32 s31, s29
    s_cselect_b32 s27, 768, 0
    s_sub_u32 s31, s31, s27
    s_add_u32 s35, s35, 1
    s_cmp_eq_u32 s35, 6
    s_cselect_b32 s27, 768, 0
    s_cselect_b32 s35, 0, s35
    s_add_u32 s31, s31, s27
    s_add_u32 s29, s29, s27
    s_add_u32 m0, s32, 32768
    s_nop 0
    buffer_load_dwordx4 v1, s[4:7], s31 offen lds
    s_add_u32 m0, s32, 34816
    s_add_u32 s27, s31, 27648
    buffer_load_dwordx4 v1, s[4:7], s27 offen lds
    s_add_u32 m0, s32, 36864
    s_add_u32 s27, s31, 221184
    buffer_load_dwordx4 v1, s[4:7], s27 offen lds
    s_add_u32 m0, s32, 38912
    s_add_u32 s27, s31, 248832
    buffer_load_dwordx4 v1, s[4:7], s27 offen lds
    s_add_u32 m0, s32, 40960
    s_add_u32 s27, s31, 442368
    buffer_load_dwordx4 v1, s[4:7], s27 offen lds
    s_add_u32 m0, s32, 43008
    s_add_u32 s27, s31, 470016
    buffer_load_dwordx4 v1, s[4:7], s27 offen lds
    s_add_u32 m0, s32, 45056
    s_add_u32 s27, s31, 663552
    buffer_load_dwordx4 v1, s[4:7], s27 offen lds
    s_add_u32 m0, s32, 47104
    s_add_u32 s27, s31, 691200
    buffer_load_dwordx4 v1, s[4:7], s27 offen lds
    s_add_u32 s31, s31, 128
    s_cmp_ge_u32 s31, s29
    s_cselect_b32 s27, 768, 0
    s_sub_u32 s31, s31, s27
    s_add_u32 s35, s35, 1
    s_cmp_eq_u32 s35, 6
    s_cselect_b32 s27, 768, 0
    s_cselect_b32 s35, 0, s35
    s_add_u32 s31, s31, s27
    s_add_u32 s29, s29, s27
    s_waitcnt vmcnt(16)
    s_barrier
    s_add_u32 m0, s32, 49152
    s_nop 0
    buffer_load_dwordx4 v1, s[4:7], s31 offen lds
    s_add_u32 m0, s32, 51200
    s_add_u32 s27, s31, 27648
    buffer_load_dwordx4 v1, s[4:7], s27 offen lds
    s_add_u32 m0, s32, 53248
    s_add_u32 s27, s31, 221184
    buffer_load_dwordx4 v1, s[4:7], s27 offen lds
    s_add_u32 m0, s32, 55296
    s_add_u32 s27, s31, 248832
    buffer_load_dwordx4 v1, s[4:7], s27 offen lds
    s_add_u32 m0, s32, 57344
    s_add_u32 s27, s31, 442368
    buffer_load_dwordx4 v1, s[4:7], s27 offen lds
    s_add_u32 m0, s32, 59392
    s_add_u32 s27, s31, 470016
    buffer_load_dwordx4 v1, s[4:7], s27 offen lds
    s_add_u32 m0, s32, 61440
    s_add_u32 s27, s31, 663552
    buffer_load_dwordx4 v1, s[4:7], s27 offen lds
    s_add_u32 m0, s32, 63488
    s_add_u32 s27, s31, 691200
    buffer_load_dwordx4 v1, s[4:7], s27 offen lds
    s_add_u32 s31, s31, 128
    s_cmp_ge_u32 s31, s29
    s_cselect_b32 s27, 768, 0
    s_sub_u32 s31, s31, s27
    s_add_u32 s35, s35, 1
    s_cmp_eq_u32 s35, 6
    s_cselect_b32 s27, 768, 0
    s_cselect_b32 s35, 0, s35
    s_add_u32 s31, s31, s27
    s_add_u32 s29, s29, s27
    s_mov_b32 s33, 0
    s_mov_b32 s34, 14
wqk_ld_8:
    s_waitcnt vmcnt(16)
    s_barrier
    s_add_u32 s28, s32, s33
    s_mov_b32 m0, s28
    s_nop 0
    buffer_load_dwordx4 v1, s[4:7], s31 offen lds
    s_add_u32 m0, s28, 2048
    s_add_u32 s27, s31, 27648
    buffer_load_dwordx4 v1, s[4:7], s27 offen lds
    s_add_u32 m0, s28, 4096
    s_add_u32 s27, s31, 221184
    buffer_load_dwordx4 v1, s[4:7], s27 offen lds
    s_add_u32 m0, s28, 6144
    s_add_u32 s27, s31, 248832
    buffer_load_dwordx4 v1, s[4:7], s27 offen lds
    s_add_u32 m0, s28, 8192
    s_add_u32 s27, s31, 442368
    buffer_load_dwordx4 v1, s[4:7], s27 offen lds
    s_add_u32 m0, s28, 10240
    s_add_u32 s27, s31, 470016
    buffer_load_dwordx4 v1, s[4:7], s27 offen lds
    s_add_u32 m0, s28, 12288
    s_add_u32 s27, s31, 663552
    buffer_load_dwordx4 v1, s[4:7], s27 offen lds
    s_add_u32 m0, s28, 14336
    s_add_u32 s27, s31, 691200
    buffer_load_dwordx4 v1, s[4:7], s27 offen lds
    s_add_u32 s31, s31, 128
    s_cmp_ge_u32 s31, s29
    s_cselect_b32 s27, 768, 0
    s_sub_u32 s31, s31, s27
    s_add_u32 s35, s35, 1
    s_cmp_eq_u32 s35, 6
    s_cselect_b32 s27, 768, 0
    s_cselect_b32 s35, 0, s35
    s_add_u32 s31, s31, s27
    s_add_u32 s29, s29, s27
    s_add_u32 s33, s33, 16384
    s_cmp_eq_u32 s33, 65536
    s_cselect_b32 s33, 0, s33
    s_sub_u32 s34, s34, 1
    s_cmp_lg_u32 s34, 0
    s_cbranch_scc1 wqk_ld_8
    s_waitcnt vmcnt(16)
    s_barrier
    s_waitcnt vmcnt(8)
    s_barrier
    s_waitcnt vmcnt(0)
    s_barrier
    v_min_u32 v8, 11, v0
    v_and_b32 v9, 1, v8
    v_lshlrev_b32 v9, 7, v9
    v_lshl_add_u32 v8, v8, 2, v9
    s_mov_b32 s34, 131072
wi_9:
    global_load_dword v9, v8, s[60:61] sc1
    s_sub_u32 s34, s34, 1
    s_waitcnt vmcnt(0)
    v_cmp_ne_u32 vcc, 1, v9
    s_cmp_eq_u32 s34, 0
    s_cbranch_scc1 wid_10
    s_cmp_eq_u64 vcc, 0
    s_cbranch_scc1 wid_10
    s_sleep 3
    s_branch wi_9
wid_10:
    s_barrier
    s_branch wqk_exit_7
wqk_loaderB_3:
    s_lshl_b32 s27, s82, 2
    v_lshrrev_b32 v2, 4, v0
    v_add_u32 v2, s27, v2
    v_and_b32 v1, 7, v0
    v_xor_b32 v1, v1, v2
    v_lshlrev_b32 v1, 4, v1
    s_lshl_b32 s27, s82, 4
    v_lshrrev_b32 v2, 5, v0
    v_lshlrev_b32 v2, 3, v2
    v_add_u32 v2, s27, v2
    v_bfe_u32 v3, v0, 3, 2
    v_add_u32 v2, v2, v3
    s_mov_b32 s27, 6912
    v_mad_u32_u24 v1, v2, s27, v1
    s_mov_b32 s31, s25
    s_lshl_b32 s32, s82, 10
    s_add_u32 s32, s32, 65536
    s_add_u32 s29, s31, 768
    s_mov_b32 s35, 0
    s_mul_i32 s27, s74, 128
    s_add_u32 s31, s31, s27
    s_mov_b32 m0, s32
    s_nop 0
    buffer_load_dwordx4 v1, s[4:7], s31 offen lds
    s_add_u32 m0, s32, 2048
    s_add_u32 s27, s31, 27648
    buffer_load_dwordx4 v1, s[4:7], s27 offen lds
    s_add_u32 m0, s32, 4096
    s_add_u32 s27, s31, 221184
    buffer_load_dwordx4 v1, s[4:7], s27 offen lds
    s_add_u32 m0, s32, 6144
    s_add_u32 s27, s31, 248832
    buffer_load_dwordx4 v1, s[4:7], s27 offen lds
    s_add_u32 m0, s32, 8192
    s_add_u32 s27, s31, 442368
    buffer_load_dwordx4 v1, s[4:7], s27 offen lds
    s_add_u32 m0, s32, 10240
    s_add_u32 s27, s31, 470016
    buffer_load_dwordx4 v1, s[4:7], s27 offen lds
    s_add_u32 s31, s31, 128
    s_cmp_ge_u32 s31, s29
    s_cselect_b32 s27, 768, 0
    s_sub_u32 s31, s31, s27
    s_add_u32 s35, s35, 1
    s_cmp_eq_u32 s35, 6
    s_cselect_b32 s27, 768, 0
    s_cselect_b32 s35, 0, s35
    s_add_u32 s31, s31, s27
    s_add_u32 s29, s29, s27
    s_add_u32 m0, s32, 12288
    s_nop 0
    buffer_load_dwordx4 v1, s[4:7], s31 offen lds
    s_add_u32 m0, s32, 14336
    s_add_u32 s27, s31, 27648
    buffer_load_dwordx4 v1, s[4:7], s27 offen lds
    s_add_u32 m0, s32, 16384
    s_add_u32 s27, s31, 221184
    buffer_load_dwordx4 v1, s[4:7], s27 offen lds
    s_add_u32 m0, s32, 18432
    s_add_u32 s27, s31, 248832
    buffer_load_dwordx4 v1, s[4:7], s27 offen lds
    s_add_u32 m0, s32, 20480
    s_add_u32 s27, s31, 442368
    buffer_load_dwordx4 v1, s[4:7], s27 offen lds
    s_add_u32 m0, s32, 22528
    s_add_u32 s27, s31, 470016
    buffer_load_dwordx4 v1, s[4:7], s27 offen lds
    s_add_u32 s31, s31, 128
    s_cmp_ge_u32 s31, s29
    s_cselect_b32 s27, 768, 0
    s_sub_u32 s31, s31, s27
    s_add_u32 s35, s35, 1
    s_cmp_eq_u32 s35, 6
    s_cselect_b32 s27, 768, 0
    s_cselect_b32 s35, 0, s35
    s_add_u32 s31, s31, s27
    s_add_u32 s29, s29, s27
    s_add_u32 m0, s32, 24576
    s_nop 0
    buffer_load_dwordx4 v1, s[4:7], s31 offen lds
    s_add_u32 m0, s32, 26624
    s_add_u32 s27, s31, 27648
    buffer_load_dwordx4 v1, s[4:7], s27 offen lds
    s_add_u32 m0, s32, 28672
    s_add_u32 s27, s31, 221184
    buffer_load_dwordx4 v1, s[4:7], s27 offen lds
    s_add_u32 m0, s32, 30720
    s_add_u32 s27, s31, 248832
    buffer_load_dwordx4 v1, s[4:7], s27 offen lds
    s_add_u32 m0, s32, 32768
    s_add_u32 s27, s31, 442368
    buffer_load_dwordx4 v1, s[4:7], s27 offen lds
    s_add_u32 m0, s32, 34816
    s_add_u32 s27, s31, 470016
    buffer_load_dwordx4 v1, s[4:7], s27 offen lds
    s_add_u32 s31, s31, 128
    s_cmp_ge_u32 s31, s29
    s_cselect_b32 s27, 768, 0
    s_sub_u32 s31, s31, s27
    s_add_u32 s35, s35, 1
    s_cmp_eq_u32 s35, 6
    s_cselect_b32 s27, 768, 0
    s_cselect_b32 s35, 0, s35
    s_add_u32 s31, s31, s27
    s_add_u32 s29, s29, s27
    s_waitcnt vmcnt(12)
    s_barrier
    s_add_u32 m0, s32, 36864
    s_nop 0
    buffer_load_dwordx4 v1, s[4:7], s31 offen lds
    s_add_u32 m0, s32, 38912
    s_add_u32 s27, s31, 27648
    buffer_load_dwordx4 v1, s[4:7], s27 offen lds
    s_add_u32 m0, s32, 40960
    s_add_u32 s27, s31, 221184
    buffer_load_dwordx4 v1, s[4:7], s27 offen lds
    s_add_u32 m0, s32, 43008
    s_add_u32 s27, s31, 248832
    buffer_load_dwordx4 v1, s[4:7], s27 offen lds
    s_add_u32 m0, s32, 45056
    s_add_u32 s27, s31, 442368
    buffer_load_dwordx4 v1, s[4:7], s27 offen lds
    s_add_u32 m0, s32, 47104
    s_add_u32 s27, s31, 470016
    buffer_load_dwordx4 v1, s[4:7], s27 offen lds
    s_add_u32 s31, s31, 128
    s_cmp_ge_u32 s31, s29
    s_cselect_b32 s27, 768, 0
    s_sub_u32 s31, s31, s27
    s_add_u32 s35, s35, 1
    s_cmp_eq_u32 s35, 6
    s_cselect_b32 s27, 768, 0
    s_cselect_b32 s35, 0, s35
    s_add_u32 s31, s31, s27
    s_add_u32 s29, s29, s27
    s_mov_b32 s33, 0
    s_mov_b32 s34, 14
wqk_ld_11:
    s_waitcnt vmcnt(12)
    s_barrier
    s_add_u32 s28, s32, s33
    s_mov_b32 m0, s28
    s_nop 0
    buffer_load_dwordx4 v1, s[4:7], s31 offen lds
    s_add_u32 m0, s28, 2048
    s_add_u32 s27, s31, 27648
    buffer_load_dwordx4 v1, s[4:7], s27 offen lds
    s_add_u32 m0, s28, 4096
    s_add_u32 s27, s31, 221184
    buffer_load_dwordx4 v1, s[4:7], s27 offen lds
    s_add_u32 m0, s28, 6144
    s_add_u32 s27, s31, 248832
    buffer_load_dwordx4 v1, s[4:7], s27 offen lds
    s_add_u32 m0, s28, 8192
    s_add_u32 s27, s31, 442368
    buffer_load_dwordx4 v1, s[4:7], s27 offen lds
    s_add_u32 m0, s28, 10240
    s_add_u32 s27, s31, 470016
    buffer_load_dwordx4 v1, s[4:7], s27 offen lds
    s_add_u32 s31, s31, 128
    s_cmp_ge_u32 s31, s29
    s_cselect_b32 s27, 768, 0
    s_sub_u32 s31, s31, s27
    s_add_u32 s35, s35, 1
    s_cmp_eq_u32 s35, 6
    s_cselect_b32 s27, 768, 0
    s_cselect_b32 s35, 0, s35
    s_add_u32 s31, s31, s27
    s_add_u32 s29, s29, s27
    s_add_u32 s33, s33, 12288
    s_cmp_eq_u32 s33, 49152
    s_cselect_b32 s33, 0, s33
    s_sub_u32 s34, s34, 1
    s_cmp_lg_u32 s34, 0
    s_cbranch_scc1 wqk_ld_11
    s_waitcnt vmcnt(12)
    s_barrier
    s_waitcnt vmcnt(6)
    s_barrier
    s_waitcnt vmcnt(0)
    s_barrier
    s_barrier
    s_branch wqk_exit_7
pa_mod:
    s_mul_i32 s73, s64, 9
    s_add_u32 s73, s73, s65
    s_sub_u32 s73, s73, 23
    s_cmp_ge_u32 s73, 36
    s_cselect_b32 s74, 1, 0
    s_mul_i32 s75, s74, 36
    s_sub_u32 s75, s73, s75
    s_mul_i32 s31, s74, 7962624
    s_lshl_b32 s27, s75, 7
    s_add_u32 s31, s31, s27
    s_mul_i32 s76, s74, 2304
    s_waitcnt lgkmcnt(0)
    s_getpc_b64 s[0:1]
tt_pc_12:
    s_lshl_b32 s85, s2, 3
    s_add_u32 s85, s85, task_table - tt_pc_12
    s_load_dwordx2 s[0:1], s[0:1], s85
    s_mov_b32 s36, s62
    s_mov_b32 s37, s63
    s_mov_b32 s38, 131072
    s_mov_b32 s39, 0x00020000
    s_mov_b32 s4, s56
    s_mov_b32 s5, s57
    s_mov_b32 s6, 15925248
    s_mov_b32 s7, 0x00020000
    s_mov_b32 s8, s42
    s_mov_b32 s9, s43
    s_mov_b32 s10, 4608
    s_mov_b32 s11, 0x00020000
    s_lshl_b32 s27, s3, 10
    v_lshl_add_u32 v3, v0, 4, s27
    buffer_load_dwordx4 v[148:151], v3, s[8:11], 0 offen
    s_lshl_b32 s27, s3, 3
    v_lshrrev_b32 v4, 3, v0
    v_add_u32 v4, s27, v4
    v_and_b32 v5, 7, v0
    v_lshlrev_b32 v5, 4, v5
    s_mov_b32 s27, 13824
    v_mad_u32_u24 v5, v4, s27, v5
    buffer_load_dwordx4 v[16:19], v5, s[4:7], s31 offen
    s_add_u32 s31, s31, 884736
    buffer_load_dwordx4 v[20:23], v5, s[4:7], s31 offen
    s_add_u32 s31, s31, 884736
    buffer_load_dwordx4 v[24:27], v5, s[4:7], s31 offen
    s_add_u32 s31, s31, 884736
    buffer_load_dwordx4 v[28:31], v5, s[4:7], s31 offen
    s_add_u32 s31, s31, 884736
    buffer_load_dwordx4 v[32:35], v5, s[4:7], s31 offen
    s_add_u32 s31, s31, 884736
    buffer_load_dwordx4 v[36:39], v5, s[4:7], s31 offen
    v_lshlrev_b32 v4, 2, v4
    v_add_u32 v4, s76, v4
    s_waitcnt vmcnt(6)
    v_lshlrev_b32 v152, 16, v148
    v_and_b32 v153, 0xffff0000, v148
    v_lshlrev_b32 v154, 16, v149
    v_and_b32 v155, 0xffff0000, v149
    v_lshlrev_b32 v156, 16, v150
    v_and_b32 v157, 0xffff0000, v150
    v_lshlrev_b32 v158, 16, v151
    v_and_b32 v159, 0xffff0000, v151
    v_mul_f32 v140, 0xbfb8aa3b, v152
    v_mul_f32 v141, 0xbfb8aa3b, v153
    v_mul_f32 v142, 0xbfb8aa3b, v154
    v_mul_f32 v143, 0xbfb8aa3b, v155
    v_mul_f32 v144, 0xbfb8aa3b, v156
    v_mul_f32 v145, 0xbfb8aa3b, v157
    v_mul_f32 v146, 0xbfb8aa3b, v158
    v_mul_f32 v147, 0xbfb8aa3b, v159
    v_exp_f32 v140, v140
    v_exp_f32 v141, v141
    v_exp_f32 v142, v142
    v_exp_f32 v143, v143
    v_exp_f32 v144, v144
    v_exp_f32 v145, v145
    v_exp_f32 v146, v146
    v_exp_f32 v147, v147
    v_add_f32 v140, 1.0, v140
    v_add_f32 v141, 1.0, v141
    v_add_f32 v142, 1.0, v142
    v_add_f32 v143, 1.0, v143
    v_add_f32 v144, 1.0, v144
    v_add_f32 v145, 1.0, v145
    v_add_f32 v146, 1.0, v146
    v_add_f32 v147, 1.0, v147
    v_rcp_f32 v140, v140
    v_rcp_f32 v141, v141
    v_rcp_f32 v142, v142
    v_rcp_f32 v143, v143
    v_rcp_f32 v144, v144
    v_rcp_f32 v145, v145
    v_rcp_f32 v146, v146
    v_rcp_f32 v147, v147
    v_mul_f32 v152, v140, v152
    v_mul_f32 v153, v141, v153
    v_mul_f32 v154, v142, v154
    v_mul_f32 v155, v143, v155
    v_mul_f32 v156, v144, v156
    v_mul_f32 v157, v145, v157
    v_mul_f32 v158, v146, v158
    v_mul_f32 v159, v147, v159
    v_lshlrev_b32 v8, 1, v3
    v_cmp_gt_u32 vcc, 9216, v8
    s_mov_b64 exec, vcc
    ds_write_b128 v8, v[152:155] offset:0
    ds_write_b128 v8, v[156:159] offset:16
    s_mov_b64 exec, -1
    s_waitcnt lgkmcnt(0)
    s_barrier
    ds_read2st64_b32 v[88:89], v4 offset0:0 offset1:18
    ds_read2st64_b32 v[90:91], v4 offset0:1 offset1:19
    ds_read2st64_b32 v[92:93], v4 offset0:2 offset1:20
    ds_read2st64_b32 v[94:95], v4 offset0:3 offset1:21
    ds_read2st64_b32 v[96:97], v4 offset0:4 offset1:22
    ds_read2st64_b32 v[98:99], v4 offset0:5 offset1:23
    ds_read2st64_b32 v[100:101], v4 offset0:6 offset1:24
    ds_read2st64_b32 v[102:103], v4 offset0:7 offset1:25
    ds_read2st64_b32 v[104:105], v4 offset0:8 offset1:26
    s_add_u32 s31, s31, 884736
    buffer_load_dwordx4 v[40:43], v5, s[4:7], s31 offen
    s_add_u32 s31, s31, 884736
    buffer_load_dwordx4 v[44:47], v5, s[4:7], s31 offen
    s_add_u32 s31, s31, 884736
    buffer_load_dwordx4 v[48:51], v5, s[4:7], s31 offen
    v_bfe_u32 v6, v0, 1, 2
    v_lshlrev_b32 v6, 7, v6
    v_lshrrev_b32 v7, 3, v0
    v_lshl_add_u32 v6, v7, 4, v6
    v_and_b32 v7, 1, v0
    v_lshl_add_u32 v6, v7, 3, v6
    v_lshrrev_b32 v7, 4, v0
    v_lshlrev_b32 v7, 7, v7
    v_and_b32 v9, 7, v0
    v_lshl_add_u32 v7, v9, 4, v7
    s_lshl_b32 s27, s3, 9
    v_add_u32 v7, s27, v7
    v_lshlrev_b32 v9, 2, v0
    v_mov_b32 v124, 0
    v_mov_b32 v125, 0
    v_mov_b32 v126, 0
    v_mov_b32 v127, 0
    v_mov_b32 v128, 0
    v_mov_b32 v129, 0
    v_mov_b32 v130, 0
    v_mov_b32 v131, 0
    v_mov_b32 v132, 0
    v_mov_b32 v133, 0
    v_mov_b32 v134, 0
    v_mov_b32 v135, 0
    v_mov_b32 v136, 0
    v_mov_b32 v137, 0
    v_mov_b32 v138, 0
    v_mov_b32 v139, 0
    s_waitcnt lgkmcnt(0)
    s_waitcnt vmcnt(8)
    v_lshlrev_b32 v140, 16, v16
    v_and_b32 v141, 0xffff0000, v16
    v_lshlrev_b32 v142, 16, v17
    v_and_b32 v143, 0xffff0000, v17
    v_lshlrev_b32 v144, 16, v18
    v_and_b32 v145, 0xffff0000, v18
    v_lshlrev_b32 v146, 16, v19
    v_and_b32 v147, 0xffff0000, v19
    v_pk_fma_f32 v[124:125], v[88:89], v[140:141], v[124:125] op_sel:[0,0,0] op_sel_hi:[1,0,1]
    v_pk_fma_f32 v[126:127], v[88:89], v[140:141], v[126:127] op_sel:[0,1,0] op_sel_hi:[1,1,1]
    v_pk_fma_f32 v[128:129], v[88:89], v[142:143], v[128:129] op_sel:[0,0,0] op_sel_hi:[1,0,1]
    v_pk_fma_f32 v[130:131], v[88:89], v[142:143], v[130:131] op_sel:[0,1,0] op_sel_hi:[1,1,1]
    v_pk_fma_f32 v[132:133], v[88:89], v[144:145], v[132:133] op_sel:[0,0,0] op_sel_hi:[1,0,1]
    v_pk_fma_f32 v[134:135], v[88:89], v[144:145], v[134:135] op_sel:[0,1,0] op_sel_hi:[1,1,1]
    v_pk_fma_f32 v[136:137], v[88:89], v[146:147], v[136:137] op_sel:[0,0,0] op_sel_hi:[1,0,1]
    v_pk_fma_f32 v[138:139], v[88:89], v[146:147], v[138:139] op_sel:[0,1,0] op_sel_hi:[1,1,1]
    s_waitcnt vmcnt(7)
    v_lshlrev_b32 v140, 16, v20
    v_and_b32 v141, 0xffff0000, v20
    v_lshlrev_b32 v142, 16, v21
    v_and_b32 v143, 0xffff0000, v21
    v_lshlrev_b32 v144, 16, v22
    v_and_b32 v145, 0xffff0000, v22
    v_lshlrev_b32 v146, 16, v23
    v_and_b32 v147, 0xffff0000, v23
    v_pk_fma_f32 v[124:125], v[90:91], v[140:141], v[124:125] op_sel:[0,0,0] op_sel_hi:[1,0,1]
    v_pk_fma_f32 v[126:127], v[90:91], v[140:141], v[126:127] op_sel:[0,1,0] op_sel_hi:[1,1,1]
    v_pk_fma_f32 v[128:129], v[90:91], v[142:143], v[128:129] op_sel:[0,0,0] op_sel_hi:[1,0,1]
    v_pk_fma_f32 v[130:131], v[90:91], v[142:143], v[130:131] op_sel:[0,1,0] op_sel_hi:[1,1,1]
    v_pk_fma_f32 v[132:133], v[90:91], v[144:145], v[132:133] op_sel:[0,0,0] op_sel_hi:[1,0,1]
    v_pk_fma_f32 v[134:135], v[90:91], v[144:145], v[134:135] op_sel:[0,1,0] op_sel_hi:[1,1,1]
    v_pk_fma_f32 v[136:137], v[90:91], v[146:147], v[136:137] op_sel:[0,0,0] op_sel_hi:[1,0,1]
    v_pk_fma_f32 v[138:139], v[90:91], v[146:147], v[138:139] op_sel:[0,1,0] op_sel_hi:[1,1,1]
    s_waitcnt vmcnt(6)
    v_lshlrev_b32 v140, 16, v24
    v_and_b32 v141, 0xffff0000, v24
    v_lshlrev_b32 v142, 16, v25
    v_and_b32 v143, 0xffff0000, v25
    v_lshlrev_b32 v144, 16, v26
    v_and_b32 v145, 0xffff0000, v26
    v_lshlrev_b32 v146, 16, v27
    v_and_b32 v147, 0xffff0000, v27
    v_pk_fma_f32 v[124:125], v[92:93], v[140:141], v[124:125] op_sel:[0,0,0] op_sel_hi:[1,0,1]
    v_pk_fma_f32 v[126:127], v[92:93], v[140:141], v[126:127] op_sel:[0,1,0] op_sel_hi:[1,1,1]
    v_pk_fma_f32 v[128:129], v[92:93], v[142:143], v[128:129] op_sel:[0,0,0] op_sel_hi:[1,0,1]
    v_pk_fma_f32 v[130:131], v[92:93], v[142:143], v[130:131] op_sel:[0,1,0] op_sel_hi:[1,1,1]
    v_pk_fma_f32 v[132:133], v[92:93], v[144:145], v[132:133] op_sel:[0,0,0] op_sel_hi:[1,0,1]
    v_pk_fma_f32 v[134:135], v[92:93], v[144:145], v[134:135] op_sel:[0,1,0] op_sel_hi:[1,1,1]
    v_pk_fma_f32 v[136:137], v[92:93], v[146:147], v[136:137] op_sel:[0,0,0] op_sel_hi:[1,0,1]
    v_pk_fma_f32 v[138:139], v[92:93], v[146:147], v[138:139] op_sel:[0,1,0] op_sel_hi:[1,1,1]
    s_waitcnt vmcnt(5)
    v_lshlrev_b32 v140, 16, v28
    v_and_b32 v141, 0xffff0000, v28
    v_lshlrev_b32 v142, 16, v29
    v_and_b32 v143, 0xffff0000, v29
    v_lshlrev_b32 v144, 16, v30
    v_and_b32 v145, 0xffff0000, v30
    v_lshlrev_b32 v146, 16, v31
    v_and_b32 v147, 0xffff0000, v31
    v_pk_fma_f32 v[124:125], v[94:95], v[140:141], v[124:125] op_sel:[0,0,0] op_sel_hi:[1,0,1]
    v_pk_fma_f32 v[126:127], v[94:95], v[140:141], v[126:127] op_sel:[0,1,0] op_sel_hi:[1,1,1]
    v_pk_fma_f32 v[128:129], v[94:95], v[142:143], v[128:129] op_sel:[0,0,0] op_sel_hi:[1,0,1]
    v_pk_fma_f32 v[130:131], v[94:95], v[142:143], v[130:131] op_sel:[0,1,0] op_sel_hi:[1,1,1]
    v_pk_fma_f32 v[132:133], v[94:95], v[144:145], v[132:133] op_sel:[0,0,0] op_sel_hi:[1,0,1]
    v_pk_fma_f32 v[134:135], v[94:95], v[144:145], v[134:135] op_sel:[0,1,0] op_sel_hi:[1,1,1]
    v_pk_fma_f32 v[136:137], v[94:95], v[146:147], v[136:137] op_sel:[0,0,0] op_sel_hi:[1,0,1]
    v_pk_fma_f32 v[138:139], v[94:95], v[146:147], v[138:139] op_sel:[0,1,0] op_sel_hi:[1,1,1]
    s_waitcnt vmcnt(4)
    v_lshlrev_b32 v140, 16, v32
    v_and_b32 v141, 0xffff0000, v32
    v_lshlrev_b32 v142, 16, v33
    v_and_b32 v143, 0xffff0000, v33
    v_lshlrev_b32 v144, 16, v34
    v_and_b32 v145, 0xffff0000, v34
    v_lshlrev_b32 v146, 16, v35
    v_and_b32 v147, 0xffff0000, v35
    v_pk_fma_f32 v[124:125], v[96:97], v[140:141], v[124:125] op_sel:[0,0,0] op_sel_hi:[1,0,1]
    v_pk_fma_f32 v[126:127], v[96:97], v[140:141], v[126:127] op_sel:[0,1,0] op_sel_hi:[1,1,1]
    v_pk_fma_f32 v[128:129], v[96:97], v[142:143], v[128:129] op_sel:[0,0,0] op_sel_hi:[1,0,1]
    v_pk_fma_f32 v[130:131], v[96:97], v[142:143], v[130:131] op_sel:[0,1,0] op_sel_hi:[1,1,1]
    v_pk_fma_f32 v[132:133], v[96:97], v[144:145], v[132:133] op_sel:[0,0,0] op_sel_hi:[1,0,1]
    v_pk_fma_f32 v[134:135], v[96:97], v[144:145], v[134:135] op_sel:[0,1,0] op_sel_hi:[1,1,1]
    v_pk_fma_f32 v[136:137], v[96:97], v[146:147], v[136:137] op_sel:[0,0,0] op_sel_hi:[1,0,1]
    v_pk_fma_f32 v[138:139], v[96:97], v[146:147], v[138:139] op_sel:[0,1,0] op_sel_hi:[1,1,1]
    s_waitcnt vmcnt(3)
    v_lshlrev_b32 v140, 16, v36
    v_and_b32 v141, 0xffff0000, v36
    v_lshlrev_b32 v142, 16, v37
    v_and_b32 v143, 0xffff0000, v37
    v_lshlrev_b32 v144, 16, v38
    v_and_b32 v145, 0xffff0000, v38
    v_lshlrev_b32 v146, 16, v39
    v_and_b32 v147, 0xffff0000, v39
    v_pk_fma_f32 v[124:125], v[98:99], v[140:141], v[124:125] op_sel:[0,0,0] op_sel_hi:[1,0,1]
    v_pk_fma_f32 v[126:127], v[98:99], v[140:141], v[126:127] op_sel:[0,1,0] op_sel_hi:[1,1,1]
    v_pk_fma_f32 v[128:129], v[98:99], v[142:143], v[128:129] op_sel:[0,0,0] op_sel_hi:[1,0,1]
    v_pk_fma_f32 v[130:131], v[98:99], v[142:143], v[130:131] op_sel:[0,1,0] op_sel_hi:[1,1,1]
    v_pk_fma_f32 v[132:133], v[98:99], v[144:145], v[132:133] op_sel:[0,0,0] op_sel_hi:[1,0,1]
    v_pk_fma_f32 v[134:135], v[98:99], v[144:145], v[134:135] op_sel:[0,1,0] op_sel_hi:[1,1,1]
    v_pk_fma_f32 v[136:137], v[98:99], v[146:147], v[136:137] op_sel:[0,0,0] op_sel_hi:[1,0,1]
    v_pk_fma_f32 v[138:139], v[98:99], v[146:147], v[138:139] op_sel:[0,1,0] op_sel_hi:[1,1,1]
    s_waitcnt vmcnt(2)
    v_lshlrev_b32 v140, 16, v40
    v_and_b32 v141, 0xffff0000, v40
    v_lshlrev_b32 v142, 16, v41
    v_and_b32 v143, 0xffff0000, v41
    v_lshlrev_b32 v144, 16, v42
    v_and_b32 v145, 0xffff0000, v42
    v_lshlrev_b32 v146, 16, v43
    v_and_b32 v147, 0xffff0000, v43
    v_pk_fma_f32 v[124:125], v[100:101], v[140:141], v[124:125] op_sel:[0,0,0] op_sel_hi:[1,0,1]
    v_pk_fma_f32 v[126:127], v[100:101], v[140:141], v[126:127] op_sel:[0,1,0] op_sel_hi:[1,1,1]
    v_pk_fma_f32 v[128:129], v[100:101], v[142:143], v[128:129] op_sel:[0,0,0] op_sel_hi:[1,0,1]
    v_pk_fma_f32 v[130:131], v[100:101], v[142:143], v[130:131] op_sel:[0,1,0] op_sel_hi:[1,1,1]
    v_pk_fma_f32 v[132:133], v[100:101], v[144:145], v[132:133] op_sel:[0,0,0] op_sel_hi:[1,0,1]
    v_pk_fma_f32 v[134:135], v[100:101], v[144:145], v[134:135] op_sel:[0,1,0] op_sel_hi:[1,1,1]
    v_pk_fma_f32 v[136:137], v[100:101], v[146:147], v[136:137] op_sel:[0,0,0] op_sel_hi:[1,0,1]
    v_pk_fma_f32 v[138:139], v[100:101], v[146:147], v[138:139] op_sel:[0,1,0] op_sel_hi:[1,1,1]
    s_waitcnt vmcnt(1)
    v_lshlrev_b32 v140, 16, v44
    v_and_b32 v141, 0xffff0000, v44
    v_lshlrev_b32 v142, 16, v45
    v_and_b32 v143, 0xffff0000, v45
    v_lshlrev_b32 v144, 16, v46
    v_and_b32 v145, 0xffff0000, v46
    v_lshlrev_b32 v146, 16, v47
    v_and_b32 v147, 0xffff0000, v47
    v_pk_fma_f32 v[124:125], v[102:103], v[140:141], v[124:125] op_sel:[0,0,0] op_sel_hi:[1,0,1]
    v_pk_fma_f32 v[126:127], v[102:103], v[140:141], v[126:127] op_sel:[0,1,0] op_sel_hi:[1,1,1]
    v_pk_fma_f32 v[128:129], v[102:103], v[142:143], v[128:129] op_sel:[0,0,0] op_sel_hi:[1,0,1]
    v_pk_fma_f32 v[130:131], v[102:103], v[142:143], v[130:131] op_sel:[0,1,0] op_sel_hi:[1,1,1]
    v_pk_fma_f32 v[132:133], v[102:103], v[144:145], v[132:133] op_sel:[0,0,0] op_sel_hi:[1,0,1]
    v_pk_fma_f32 v[134:135], v[102:103], v[144:145], v[134:135] op_sel:[0,1,0] op_sel_hi:[1,1,1]
    v_pk_fma_f32 v[136:137], v[102:103], v[146:147], v[136:137] op_sel:[0,0,0] op_sel_hi:[1,0,1]
    v_pk_fma_f32 v[138:139], v[102:103], v[146:147], v[138:139] op_sel:[0,1,0] op_sel_hi:[1,1,1]
    s_waitcnt vmcnt(0)
    v_lshlrev_b32 v140, 16, v48
    v_and_b32 v141, 0xffff0000, v48
    v_lshlrev_b32 v142, 16, v49
    v_and_b32 v143, 0xffff0000, v49
    v_lshlrev_b32 v144, 16, v50
    v_and_b32 v145, 0xffff0000, v50
    v_lshlrev_b32 v146, 16, v51
    v_and_b32 v147, 0xffff0000, v51
    v_pk_fma_f32 v[124:125], v[104:105], v[140:141], v[124:125] op_sel:[0,0,0] op_sel_hi:[1,0,1]
    v_pk_fma_f32 v[126:127], v[104:105], v[140:141], v[126:127] op_sel:[0,1,0] op_sel_hi:[1,1,1]
    v_pk_fma_f32 v[128:129], v[104:105], v[142:143], v[128:129] op_sel:[0,0,0] op_sel_hi:[1,0,1]
    v_pk_fma_f32 v[130:131], v[104:105], v[142:143], v[130:131] op_sel:[0,1,0] op_sel_hi:[1,1,1]
    v_pk_fma_f32 v[132:133], v[104:105], v[144:145], v[132:133] op_sel:[0,0,0] op_sel_hi:[1,0,1]
    v_pk_fma_f32 v[134:135], v[104:105], v[144:145], v[134:135] op_sel:[0,1,0] op_sel_hi:[1,1,1]
    v_pk_fma_f32 v[136:137], v[104:105], v[146:147], v[136:137] op_sel:[0,0,0] op_sel_hi:[1,0,1]
    v_pk_fma_f32 v[138:139], v[104:105], v[146:147], v[138:139] op_sel:[0,1,0] op_sel_hi:[1,1,1]
    s_nop 1
    v_permlane32_swap_b32 v124, v132
    v_permlane32_swap_b32 v125, v133
    v_permlane32_swap_b32 v126, v134
    v_permlane32_swap_b32 v127, v135
    v_permlane32_swap_b32 v128, v136
    v_permlane32_swap_b32 v129, v137
    v_permlane32_swap_b32 v130, v138
    v_permlane32_swap_b32 v131, v139
    v_add_f32 v124, v124, v132
    v_add_f32 v125, v125, v133
    v_add_f32 v126, v126, v134
    v_add_f32 v127, v127, v135
    v_add_f32 v128, v128, v136
    v_add_f32 v129, v129, v137
    v_add_f32 v130, v130, v138
    v_add_f32 v131, v131, v139
    s_nop 1
    v_permlane16_swap_b32 v124, v128
    v_permlane16_swap_b32 v125, v129
    v_permlane16_swap_b32 v126, v130
    v_permlane16_swap_b32 v127, v131
    v_add_f32 v128, v124, v128
    v_add_f32 v129, v125, v129
    v_add_f32 v130, v126, v130
    v_add_f32 v131, v127, v131
    s_nop 1
    v_add_f32_dpp v124, v128, v128 row_ror:8 row_mask:0xf bank_mask:0xf
    v_add_f32_dpp v125, v129, v129 row_ror:8 row_mask:0xf bank_mask:0xf
    v_add_f32_dpp v126, v130, v130 row_ror:8 row_mask:0xf bank_mask:0xf
    v_add_f32_dpp v127, v131, v131 row_ror:8 row_mask:0xf bank_mask:0xf
    ds_write_b128 v7, v[124:127] offset:9216
    s_waitcnt lgkmcnt(0)
    s_barrier
    s_cmp_lg_u32 s3, 0
    s_cbranch_scc1 gv_noredm
    ds_read_b64 v[124:125], v6 offset:9216
    ds_read_b64 v[126:127], v6 offset:9728
    ds_read_b64 v[128:129], v6 offset:10240
    ds_read_b64 v[130:131], v6 offset:10752
    ds_read_b64 v[132:133], v6 offset:11264
    ds_read_b64 v[134:135], v6 offset:11776
    ds_read_b64 v[136:137], v6 offset:12288
    ds_read_b64 v[138:139], v6 offset:12800
    s_waitcnt lgkmcnt(0)
    v_pk_add_f32 v[124:125], v[124:125], v[132:133]
    v_pk_add_f32 v[126:127], v[126:127], v[134:135]
    v_pk_add_f32 v[128:129], v[128:129], v[136:137]
    v_pk_add_f32 v[130:131], v[130:131], v[138:139]
    v_pk_add_f32 v[124:125], v[124:125], v[128:129]
    v_pk_add_f32 v[126:127], v[126:127], v[130:131]
    v_pk_add_f32 v[124:125], v[124:125], v[126:127]
    s_add_u32 s12, s62, 131072
    s_addc_u32 s13, s63, 0
    s_mov_b32 s14, 36864
    s_mov_b32 s15, 0x00020000
    s_cmp_ge_u32 s75, 18
    s_cselect_b32 s29, 1.0, 0
    s_cmp_eq_u32 s74, 0
    s_cselect_b32 s29, s29, 0
    v_add_f32 v124, s29, v124
    v_add_f32 v125, s29, v125
    s_mul_i32 s28, s74, 18432
    s_lshl_b32 s27, s75, 8
    s_add_u32 s28, s28, s27
    s_add_u32 s29, s28, 9216
    buffer_store_dword v124, v9, s[12:15], s28 offen sc1
    buffer_store_dword v125, v9, s[12:15], s29 offen sc1
    v_min_u32 v12, 11, v0
    v_and_b32 v13, 1, v12
    v_lshlrev_b32 v13, 7, v13
    v_lshl_add_u32 v12, v12, 2, v13
    s_mov_b32 s34, 131072
wi_13:
    global_load_dword v13, v12, s[60:61] sc1
    s_sub_u32 s34, s34, 1
    s_waitcnt vmcnt(0)
    v_cmp_ne_u32 vcc, 1, v13
    s_cmp_eq_u32 s34, 0
    s_cbranch_scc1 wid_14
    s_cmp_eq_u64 vcc, 0
    s_cbranch_scc1 wid_14
    s_sleep 3
    s_branch wi_13
wid_14:
    s_add_u32 s85, s73, 0
    s_lshl_b32 s27, s85, 7
    v_mov_b32 v12, 0
    v_mov_b32 v13, 1
    s_mov_b64 exec, 1
    buffer_store_dword v13, v12, s[36:39], s27 offen sc1
    s_mov_b64 exec, -1
gv_noredm:
    s_barrier
    s_mov_b64 exec, -1
    s_branch next_task
pa_spare:
    s_mul_i32 s73, s67, 3
    s_add_u32 s73, s73, s65
    s_sub_u32 s73, s73, 20
    s_waitcnt lgkmcnt(0)
    s_getpc_b64 s[0:1]
tt_pc_15:
    s_lshl_b32 s85, s2, 3
    s_add_u32 s85, s85, task_table - tt_pc_15
    s_load_dwordx2 s[0:1], s[0:1], s85
    s_mov_b32 s36, s62
    s_mov_b32 s37, s63
    s_mov_b32 s38, 131072
    s_mov_b32 s39, 0x00020000
    v_lshlrev_b32 v8, 4, v0
    v_mov_b32 v4, 0
    v_mov_b32 v5, 0
    v_mov_b32 v6, 0
    v_mov_b32 v7, 0
    s_lshl_b32 s79, s73, 3
    s_add_u32 s79, s79, s3
    s_lshl_b32 s27, s79, 10
    buffer_store_dwordx4 v[4:7], v8, s[36:39], s27 offen sc1
    s_add_u32 s27, s27, 98304
    buffer_store_dwordx4 v[4:7], v8, s[36:39], s27 offen sc1
    s_waitcnt vmcnt(0)
    s_barrier
    s_cmp_lg_u32 s3, 0
    s_cbranch_scc1 pa_noinit
    s_and_b32 s27, s73, 1
    s_lshl_b32 s27, s27, 7
    s_lshl_b32 s28, s73, 2
    s_add_u32 s27, s27, s28
    v_mov_b32 v8, 1
    v_mov_b32 v9, s27
    s_mov_b64 exec, 1
    global_store_dword v9, v8, s[60:61] sc1
    s_mov_b64 exec, -1
pa_noinit:
    s_lshl_b32 s79, s73, 3
    s_add_u32 s79, s79, s3
    s_lshr_b32 s78, s79, 1
    s_bitcmp1_b32 s79, 0
    s_cbranch_scc1 pa_noy
    s_mov_b32 s20, s44
    s_mov_b32 s21, s45
    s_mov_b32 s22, 354816
    s_mov_b32 s23, 0x00020000
    v_lshlrev_b32 v8, 7, v0
    s_lshl_b32 s27, s78, 13
    buffer_load_dword v14, v8, s[20:23], s27 offen
pa_noy:
    s_mov_b64 exec, -1
    s_branch next_task
pa_h:
    s_lshl_b32 s73, s64, 3
    s_add_u32 s73, s73, s65
    s_waitcnt lgkmcnt(0)
    s_getpc_b64 s[0:1]
tt_pc_16:
    s_lshl_b32 s85, s2, 3
    s_add_u32 s85, s85, task_table - tt_pc_16
    s_load_dwordx2 s[0:1], s[0:1], s85
    s_mov_b32 s36, s62
    s_mov_b32 s37, s63
    s_mov_b32 s38, 131072
    s_mov_b32 s39, 0x00020000
    s_lshl_b32 s79, s73, 3
    s_add_u32 s79, s79, s3
    s_mov_b32 s20, s46
    s_mov_b32 s21, s47
    s_mov_b32 s22, 7962624
    s_mov_b32 s23, 0x00020000
    s_lshl_b32 s28, s79, 6
    v_add_u32 v8, s28, v0
    s_mov_b32 s27, 58255
    v_mul_lo_u32 v9, v8, s27
    v_lshrrev_b32 v9, 21, v9
    s_mov_b32 s27, 2304
    v_mul_u32_u24 v9, s27, v9
    v_lshl_add_u32 v8, v8, 7, v9
    s_mov_b32 s27, 0
    buffer_load_dword v13, v8, s[20:23], s27 offen
    s_add_u32 s28, s28, 32768
    s_cmp_ge_u32 s28, 32768
    s_cbranch_scc1 pfc_17
    v_add_u32 v8, s28, v0
    s_mov_b32 s27, 58255
    v_mul_lo_u32 v9, v8, s27
    v_lshrrev_b32 v9, 21, v9
    s_mov_b32 s27, 2304
    v_mul_u32_u24 v9, s27, v9
    v_lshl_add_u32 v8, v8, 7, v9
    s_mov_b32 s27, 0
    buffer_load_dword v13, v8, s[20:23], s27 offen
pfc_17:
    s_cmp_ge_u32 s3, 6
    s_cbranch_scc1 pa_hhelp
    s_mov_b32 s16, s40
    s_mov_b32 s17, s41
    s_mov_b32 s18, 4718592
    s_mov_b32 s19, 0x00020000
    v_lshrrev_b32 v6, 3, v0
    s_mov_b32 s27, 2304
    v_mul_u32_u24 v6, s27, v6
    v_and_b32 v7, 7, v0
    v_lshl_add_u32 v6, v7, 4, v6
    s_mul_i32 s75, s73, 73728
    s_mul_i32 s76, s3, 384
    s_add_u32 s75, s75, s76
    buffer_load_dwordx4 v[112:115], v6, s[16:19], s75 offen offset:0
    buffer_load_dwordx4 v[116:119], v6, s[16:19], s75 offen offset:128
    buffer_load_dwordx4 v[120:123], v6, s[16:19], s75 offen offset:256
    s_add_u32 s75, s75, 18432
    buffer_load_dwordx4 v[124:127], v6, s[16:19], s75 offen offset:0
    buffer_load_dwordx4 v[128:131], v6, s[16:19], s75 offen offset:128
    buffer_load_dwordx4 v[132:135], v6, s[16:19], s75 offen offset:256
    s_add_u32 s75, s75, 18432
    buffer_load_dwordx4 v[136:139], v6, s[16:19], s75 offen offset:0
    buffer_load_dwordx4 v[140:143], v6, s[16:19], s75 offen offset:128
    buffer_load_dwordx4 v[144:147], v6, s[16:19], s75 offen offset:256
    s_add_u32 s75, s75, 18432
    buffer_load_dwordx4 v[148:151], v6, s[16:19], s75 offen offset:0
    buffer_load_dwordx4 v[152:155], v6, s[16:19], s75 offen offset:128
    buffer_load_dwordx4 v[156:159], v6, s[16:19], s75 offen offset:256
    v_lshlrev_b32 v7, 5, v7
    v_lshrrev_b32 v8, 3, v0
    v_lshl_add_u32 v7, v8, 2, v7
    s_mov_b32 s77, 0x3f803f80
    s_waitcnt vmcnt(9)
    ds_bpermute_b32 v208, v7, v112
    ds_bpermute_b32 v209, v7, v113
    ds_bpermute_b32 v210, v7, v114
    ds_bpermute_b32 v211, v7, v115
    ds_bpermute_b32 v212, v7, v116
    ds_bpermute_b32 v213, v7, v117
    ds_bpermute_b32 v214, v7, v118
    ds_bpermute_b32 v215, v7, v119
    ds_bpermute_b32 v216, v7, v120
    ds_bpermute_b32 v217, v7, v121
    ds_bpermute_b32 v218, v7, v122
    ds_bpermute_b32 v219, v7, v123
    s_waitcnt vmcnt(6)
    ds_bpermute_b32 v220, v7, v124
    ds_bpermute_b32 v221, v7, v125
    ds_bpermute_b32 v222, v7, v126
    ds_bpermute_b32 v223, v7, v127
    ds_bpermute_b32 v224, v7, v128
    ds_bpermute_b32 v225, v7, v129
    ds_bpermute_b32 v226, v7, v130
    ds_bpermute_b32 v227, v7, v131
    ds_bpermute_b32 v228, v7, v132
    ds_bpermute_b32 v229, v7, v133
    ds_bpermute_b32 v230, v7, v134
    ds_bpermute_b32 v231, v7, v135
    s_waitcnt vmcnt(3)
    ds_bpermute_b32 v232, v7, v136
    ds_bpermute_b32 v233, v7, v137
    ds_bpermute_b32 v234, v7, v138
    ds_bpermute_b32 v235, v7, v139
    ds_bpermute_b32 v236, v7, v140
    ds_bpermute_b32 v237, v7, v141
    ds_bpermute_b32 v238, v7, v142
    ds_bpermute_b32 v239, v7, v143
    ds_bpermute_b32 v240, v7, v144
    ds_bpermute_b32 v241, v7, v145
    ds_bpermute_b32 v242, v7, v146
    ds_bpermute_b32 v243, v7, v147
    s_waitcnt vmcnt(0)
    ds_bpermute_b32 v244, v7, v148
    ds_bpermute_b32 v245, v7, v149
    ds_bpermute_b32 v246, v7, v150
    ds_bpermute_b32 v247, v7, v151
    ds_bpermute_b32 v248, v7, v152
    ds_bpermute_b32 v249, v7, v153
    ds_bpermute_b32 v250, v7, v154
    ds_bpermute_b32 v251, v7, v155
    ds_bpermute_b32 v252, v7, v156
    ds_bpermute_b32 v253, v7, v157
    ds_bpermute_b32 v254, v7, v158
    ds_bpermute_b32 v255, v7, v159
    v_mov_b32 v16, 0
    v_mov_b32 v17, 0
    v_mov_b32 v18, 0
    v_mov_b32 v19, 0
    v_mov_b32 v20, 0
    v_mov_b32 v21, 0
    v_mov_b32 v22, 0
    v_mov_b32 v23, 0
    s_waitcnt lgkmcnt(0)
    v_dot2_f32_bf16 v16, v208, s77, v16
    v_dot2_f32_bf16 v20, v208, v208, v20
    v_dot2_f32_bf16 v17, v220, s77, v17
    v_dot2_f32_bf16 v21, v220, v220, v21
    v_dot2_f32_bf16 v18, v232, s77, v18
    v_dot2_f32_bf16 v22, v232, v232, v22
    v_dot2_f32_bf16 v19, v244, s77, v19
    v_dot2_f32_bf16 v23, v244, v244, v23
    v_dot2_f32_bf16 v16, v209, s77, v16
    v_dot2_f32_bf16 v20, v209, v209, v20
    v_dot2_f32_bf16 v17, v221, s77, v17
    v_dot2_f32_bf16 v21, v221, v221, v21
    v_dot2_f32_bf16 v18, v233, s77, v18
    v_dot2_f32_bf16 v22, v233, v233, v22
    v_dot2_f32_bf16 v19, v245, s77, v19
    v_dot2_f32_bf16 v23, v245, v245, v23
    v_dot2_f32_bf16 v16, v210, s77, v16
    v_dot2_f32_bf16 v20, v210, v210, v20
    v_dot2_f32_bf16 v17, v222, s77, v17
    v_dot2_f32_bf16 v21, v222, v222, v21
    v_dot2_f32_bf16 v18, v234, s77, v18
    v_dot2_f32_bf16 v22, v234, v234, v22
    v_dot2_f32_bf16 v19, v246, s77, v19
    v_dot2_f32_bf16 v23, v246, v246, v23
    v_dot2_f32_bf16 v16, v211, s77, v16
    v_dot2_f32_bf16 v20, v211, v211, v20
    v_dot2_f32_bf16 v17, v223, s77, v17
    v_dot2_f32_bf16 v21, v223, v223, v21
    v_dot2_f32_bf16 v18, v235, s77, v18
    v_dot2_f32_bf16 v22, v235, v235, v22
    v_dot2_f32_bf16 v19, v247, s77, v19
    v_dot2_f32_bf16 v23, v247, v247, v23
    v_dot2_f32_bf16 v16, v212, s77, v16
    v_dot2_f32_bf16 v20, v212, v212, v20
    v_dot2_f32_bf16 v17, v224, s77, v17
    v_dot2_f32_bf16 v21, v224, v224, v21
    v_dot2_f32_bf16 v18, v236, s77, v18
    v_dot2_f32_bf16 v22, v236, v236, v22
    v_dot2_f32_bf16 v19, v248, s77, v19
    v_dot2_f32_bf16 v23, v248, v248, v23
    v_dot2_f32_bf16 v16, v213, s77, v16
    v_dot2_f32_bf16 v20, v213, v213, v20
    v_dot2_f32_bf16 v17, v225, s77, v17
    v_dot2_f32_bf16 v21, v225, v225, v21
    v_dot2_f32_bf16 v18, v237, s77, v18
    v_dot2_f32_bf16 v22, v237, v237, v22
    v_dot2_f32_bf16 v19, v249, s77, v19
    v_dot2_f32_bf16 v23, v249, v249, v23
    v_dot2_f32_bf16 v16, v214, s77, v16
    v_dot2_f32_bf16 v20, v214, v214, v20
    v_dot2_f32_bf16 v17, v226, s77, v17
    v_dot2_f32_bf16 v21, v226, v226, v21
    v_dot2_f32_bf16 v18, v238, s77, v18
    v_dot2_f32_bf16 v22, v238, v238, v22
    v_dot2_f32_bf16 v19, v250, s77, v19
    v_dot2_f32_bf16 v23, v250, v250, v23
    v_dot2_f32_bf16 v16, v215, s77, v16
    v_dot2_f32_bf16 v20, v215, v215, v20
    v_dot2_f32_bf16 v17, v227, s77, v17
    v_dot2_f32_bf16 v21, v227, v227, v21
    v_dot2_f32_bf16 v18, v239, s77, v18
    v_dot2_f32_bf16 v22, v239, v239, v22
    v_dot2_f32_bf16 v19, v251, s77, v19
    v_dot2_f32_bf16 v23, v251, v251, v23
    v_dot2_f32_bf16 v16, v216, s77, v16
    v_dot2_f32_bf16 v20, v216, v216, v20
    v_dot2_f32_bf16 v17, v228, s77, v17
    v_dot2_f32_bf16 v21, v228, v228, v21
    v_dot2_f32_bf16 v18, v240, s77, v18
    v_dot2_f32_bf16 v22, v240, v240, v22
    v_dot2_f32_bf16 v19, v252, s77, v19
    v_dot2_f32_bf16 v23, v252, v252, v23
    v_dot2_f32_bf16 v16, v217, s77, v16
    v_dot2_f32_bf16 v20, v217, v217, v20
    v_dot2_f32_bf16 v17, v229, s77, v17
    v_dot2_f32_bf16 v21, v229, v229, v21
    v_dot2_f32_bf16 v18, v241, s77, v18
    v_dot2_f32_bf16 v22, v241, v241, v22
    v_dot2_f32_bf16 v19, v253, s77, v19
    v_dot2_f32_bf16 v23, v253, v253, v23
    v_dot2_f32_bf16 v16, v218, s77, v16
    v_dot2_f32_bf16 v20, v218, v218, v20
    v_dot2_f32_bf16 v17, v230, s77, v17
    v_dot2_f32_bf16 v21, v230, v230, v21
    v_dot2_f32_bf16 v18, v242, s77, v18
    v_dot2_f32_bf16 v22, v242, v242, v22
    v_dot2_f32_bf16 v19, v254, s77, v19
    v_dot2_f32_bf16 v23, v254, v254, v23
    v_dot2_f32_bf16 v16, v219, s77, v16
    v_dot2_f32_bf16 v20, v219, v219, v20
    v_dot2_f32_bf16 v17, v231, s77, v17
    v_dot2_f32_bf16 v21, v231, v231, v21
    v_dot2_f32_bf16 v18, v243, s77, v18
    v_dot2_f32_bf16 v22, v243, v243, v22
    v_dot2_f32_bf16 v19, v255, s77, v19
    v_dot2_f32_bf16 v23, v255, v255, v23
    s_nop 3
    v_permlane32_swap_b32 v16, v20
    v_permlane32_swap_b32 v17, v21
    v_permlane32_swap_b32 v18, v22
    v_permlane32_swap_b32 v19, v23
    v_add_f32 v16, v16, v20
    v_add_f32 v17, v17, v21
    v_add_f32 v18, v18, v22
    v_add_f32 v19, v19, v23
    s_nop 1
    v_permlane16_swap_b32 v16, v18
    v_permlane16_swap_b32 v17, v19
    v_add_f32 v18, v16, v18
    v_add_f32 v19, v17, v19
    s_nop 1
    v_add_f32_dpp v16, v18, v18 row_ror:8 row_mask:0xf bank_mask:0xf
    v_add_f32_dpp v17, v19, v19 row_ror:8 row_mask:0xf bank_mask:0xf
    v_and_b32 v9, 7, v0
    v_mul_u32_u24 v9, 192, v9
    v_lshrrev_b32 v10, 4, v0
    v_lshl_add_u32 v10, v10, 3, v9
    s_lshl_b32 s27, s3, 5
    v_add_u32 v10, s27, v10
    ds_write_b64 v10, v[16:17] offset:0
    s_waitcnt lgkmcnt(0)
    s_barrier
    ds_read_b128 v[112:115], v9 offset:0
    ds_read_b128 v[116:119], v9 offset:16
    ds_read_b128 v[120:123], v9 offset:32
    ds_read_b128 v[124:127], v9 offset:48
    ds_read_b128 v[128:131], v9 offset:64
    ds_read_b128 v[132:135], v9 offset:80
    ds_read_b128 v[136:139], v9 offset:96
    ds_read_b128 v[140:143], v9 offset:112
    ds_read_b128 v[144:147], v9 offset:128
    ds_read_b128 v[148:151], v9 offset:144
    ds_read_b128 v[152:155], v9 offset:160
    ds_read_b128 v[156:159], v9 offset:176
    s_waitcnt lgkmcnt(0)
    v_pk_add_f32 v[112:113], v[112:113], v[120:121]
    v_pk_add_f32 v[114:115], v[114:115], v[122:123]
    v_pk_add_f32 v[116:117], v[116:117], v[124:125]
    v_pk_add_f32 v[118:119], v[118:119], v[126:127]
    v_pk_add_f32 v[112:113], v[112:113], v[128:129]
    v_pk_add_f32 v[114:115], v[114:115], v[130:131]
    v_pk_add_f32 v[116:117], v[116:117], v[132:133]
    v_pk_add_f32 v[118:119], v[118:119], v[134:135]
    v_pk_add_f32 v[112:113], v[112:113], v[136:137]
    v_pk_add_f32 v[114:115], v[114:115], v[138:139]
    v_pk_add_f32 v[116:117], v[116:117], v[140:141]
    v_pk_add_f32 v[118:119], v[118:119], v[142:143]
    v_pk_add_f32 v[112:113], v[112:113], v[144:145]
    v_pk_add_f32 v[114:115], v[114:115], v[146:147]
    v_pk_add_f32 v[116:117], v[116:117], v[148:149]
    v_pk_add_f32 v[118:119], v[118:119], v[150:151]
    v_pk_add_f32 v[112:113], v[112:113], v[152:153]
    v_pk_add_f32 v[114:115], v[114:115], v[154:155]
    v_pk_add_f32 v[116:117], v[116:117], v[156:157]
    v_pk_add_f32 v[118:119], v[118:119], v[158:159]
    v_mul_f32 v112, 0x3a638e39, v112
    v_mul_f32 v116, 0x3a638e39, v116
    v_fma_f32 v116, -v112, v112, v116
    v_max_f32 v116, 0, v116
    v_add_f32 v116, 0x3727c5ac, v116
    v_rsq_f32 v116, v116
    s_nop 0
    v_mul_f32 v112, v112, v116
    v_mul_f32 v113, 0x3a638e39, v113
    v_mul_f32 v117, 0x3a638e39, v117
    v_fma_f32 v117, -v113, v113, v117
    v_max_f32 v117, 0, v117
    v_add_f32 v117, 0x3727c5ac, v117
    v_rsq_f32 v117, v117
    s_nop 0
    v_mul_f32 v113, v113, v117
    v_mul_f32 v114, 0x3a638e39, v114
    v_mul_f32 v118, 0x3a638e39, v118
    v_fma_f32 v118, -v114, v114, v118
    v_max_f32 v118, 0, v118
    v_add_f32 v118, 0x3727c5ac, v118
    v_rsq_f32 v118, v118
    s_nop 0
    v_mul_f32 v114, v114, v118
    v_mul_f32 v115, 0x3a638e39, v115
    v_mul_f32 v119, 0x3a638e39, v119
    v_fma_f32 v119, -v115, v115, v119
    v_max_f32 v119, 0, v119
    v_add_f32 v119, 0x3727c5ac, v119
    v_rsq_f32 v119, v119
    s_nop 0
    v_mul_f32 v115, v115, v119
    v_lshlrev_b32 v16, 16, v208
    v_and_b32 v17, 0xffff0000, v208
    v_fma_f32 v16, v16, v116, -v112
    v_fma_f32 v17, v17, v116, -v112
    v_lshlrev_b32 v18, 16, v209
    v_and_b32 v19, 0xffff0000, v209
    v_fma_f32 v18, v18, v116, -v112
    v_fma_f32 v19, v19, v116, -v112
    v_lshlrev_b32 v20, 16, v210
    v_and_b32 v21, 0xffff0000, v210
    v_fma_f32 v20, v20, v116, -v112
    v_fma_f32 v21, v21, v116, -v112
    v_lshlrev_b32 v22, 16, v211
    v_and_b32 v23, 0xffff0000, v211
    v_fma_f32 v22, v22, v116, -v112
    v_fma_f32 v23, v23, v116, -v112
    v_lshlrev_b32 v24, 16, v212
    v_and_b32 v25, 0xffff0000, v212
    v_fma_f32 v24, v24, v116, -v112
    v_fma_f32 v25, v25, v116, -v112
    v_lshlrev_b32 v26, 16, v213
    v_and_b32 v27, 0xffff0000, v213
    v_fma_f32 v26, v26, v116, -v112
    v_fma_f32 v27, v27, v116, -v112
    v_lshlrev_b32 v28, 16, v214
    v_and_b32 v29, 0xffff0000, v214
    v_fma_f32 v28, v28, v116, -v112
    v_fma_f32 v29, v29, v116, -v112
    v_lshlrev_b32 v30, 16, v215
    v_and_b32 v31, 0xffff0000, v215
    v_fma_f32 v30, v30, v116, -v112
    v_fma_f32 v31, v31, v116, -v112
    v_lshlrev_b32 v32, 16, v216
    v_and_b32 v33, 0xffff0000, v216
    v_fma_f32 v32, v32, v116, -v112
    v_fma_f32 v33, v33, v116, -v112
    v_lshlrev_b32 v34, 16, v217
    v_and_b32 v35, 0xffff0000, v217
    v_fma_f32 v34, v34, v116, -v112
    v_fma_f32 v35, v35, v116, -v112
    v_lshlrev_b32 v36, 16, v218
    v_and_b32 v37, 0xffff0000, v218
    v_fma_f32 v36, v36, v116, -v112
    v_fma_f32 v37, v37, v116, -v112
    v_lshlrev_b32 v38, 16, v219
    v_and_b32 v39, 0xffff0000, v219
    v_fma_f32 v38, v38, v116, -v112
    v_fma_f32 v39, v39, v116, -v112
    v_lshlrev_b32 v40, 16, v220
    v_and_b32 v41, 0xffff0000, v220
    v_fma_f32 v40, v40, v117, -v113
    v_fma_f32 v41, v41, v117, -v113
    v_lshlrev_b32 v42, 16, v221
    v_and_b32 v43, 0xffff0000, v221
    v_fma_f32 v42, v42, v117, -v113
    v_fma_f32 v43, v43, v117, -v113
    v_lshlrev_b32 v44, 16, v222
    v_and_b32 v45, 0xffff0000, v222
    v_fma_f32 v44, v44, v117, -v113
    v_fma_f32 v45, v45, v117, -v113
    v_lshlrev_b32 v46, 16, v223
    v_and_b32 v47, 0xffff0000, v223
    v_fma_f32 v46, v46, v117, -v113
    v_fma_f32 v47, v47, v117, -v113
    v_lshlrev_b32 v48, 16, v224
    v_and_b32 v49, 0xffff0000, v224
    v_fma_f32 v48, v48, v117, -v113
    v_fma_f32 v49, v49, v117, -v113
    v_lshlrev_b32 v50, 16, v225
    v_and_b32 v51, 0xffff0000, v225
    v_fma_f32 v50, v50, v117, -v113
    v_fma_f32 v51, v51, v117, -v113
    v_lshlrev_b32 v52, 16, v226
    v_and_b32 v53, 0xffff0000, v226
    v_fma_f32 v52, v52, v117, -v113
    v_fma_f32 v53, v53, v117, -v113
    v_lshlrev_b32 v54, 16, v227
    v_and_b32 v55, 0xffff0000, v227
    v_fma_f32 v54, v54, v117, -v113
    v_fma_f32 v55, v55, v117, -v113
    v_lshlrev_b32 v56, 16, v228
    v_and_b32 v57, 0xffff0000, v228
    v_fma_f32 v56, v56, v117, -v113
    v_fma_f32 v57, v57, v117, -v113
    v_lshlrev_b32 v58, 16, v229
    v_and_b32 v59, 0xffff0000, v229
    v_fma_f32 v58, v58, v117, -v113
    v_fma_f32 v59, v59, v117, -v113
    v_lshlrev_b32 v60, 16, v230
    v_and_b32 v61, 0xffff0000, v230
    v_fma_f32 v60, v60, v117, -v113
    v_fma_f32 v61, v61, v117, -v113
    v_lshlrev_b32 v62, 16, v231
    v_and_b32 v63, 0xffff0000, v231
    v_fma_f32 v62, v62, v117, -v113
    v_fma_f32 v63, v63, v117, -v113
    v_lshlrev_b32 v64, 16, v232
    v_and_b32 v65, 0xffff0000, v232
    v_fma_f32 v64, v64, v118, -v114
    v_fma_f32 v65, v65, v118, -v114
    v_lshlrev_b32 v66, 16, v233
    v_and_b32 v67, 0xffff0000, v233
    v_fma_f32 v66, v66, v118, -v114
    v_fma_f32 v67, v67, v118, -v114
    v_lshlrev_b32 v68, 16, v234
    v_and_b32 v69, 0xffff0000, v234
    v_fma_f32 v68, v68, v118, -v114
    v_fma_f32 v69, v69, v118, -v114
    v_lshlrev_b32 v70, 16, v235
    v_and_b32 v71, 0xffff0000, v235
    v_fma_f32 v70, v70, v118, -v114
    v_fma_f32 v71, v71, v118, -v114
    v_lshlrev_b32 v72, 16, v236
    v_and_b32 v73, 0xffff0000, v236
    v_fma_f32 v72, v72, v118, -v114
    v_fma_f32 v73, v73, v118, -v114
    v_lshlrev_b32 v74, 16, v237
    v_and_b32 v75, 0xffff0000, v237
    v_fma_f32 v74, v74, v118, -v114
    v_fma_f32 v75, v75, v118, -v114
    v_lshlrev_b32 v76, 16, v238
    v_and_b32 v77, 0xffff0000, v238
    v_fma_f32 v76, v76, v118, -v114
    v_fma_f32 v77, v77, v118, -v114
    v_lshlrev_b32 v78, 16, v239
    v_and_b32 v79, 0xffff0000, v239
    v_fma_f32 v78, v78, v118, -v114
    v_fma_f32 v79, v79, v118, -v114
    v_lshlrev_b32 v80, 16, v240
    v_and_b32 v81, 0xffff0000, v240
    v_fma_f32 v80, v80, v118, -v114
    v_fma_f32 v81, v81, v118, -v114
    v_lshlrev_b32 v82, 16, v241
    v_and_b32 v83, 0xffff0000, v241
    v_fma_f32 v82, v82, v118, -v114
    v_fma_f32 v83, v83, v118, -v114
    v_lshlrev_b32 v84, 16, v242
    v_and_b32 v85, 0xffff0000, v242
    v_fma_f32 v84, v84, v118, -v114
    v_fma_f32 v85, v85, v118, -v114
    v_lshlrev_b32 v86, 16, v243
    v_and_b32 v87, 0xffff0000, v243
    v_fma_f32 v86, v86, v118, -v114
    v_fma_f32 v87, v87, v118, -v114
    v_lshlrev_b32 v88, 16, v244
    v_and_b32 v89, 0xffff0000, v244
    v_fma_f32 v88, v88, v119, -v115
    v_fma_f32 v89, v89, v119, -v115
    v_lshlrev_b32 v90, 16, v245
    v_and_b32 v91, 0xffff0000, v245
    v_fma_f32 v90, v90, v119, -v115
    v_fma_f32 v91, v91, v119, -v115
    v_lshlrev_b32 v92, 16, v246
    v_and_b32 v93, 0xffff0000, v246
    v_fma_f32 v92, v92, v119, -v115
    v_fma_f32 v93, v93, v119, -v115
    v_lshlrev_b32 v94, 16, v247
    v_and_b32 v95, 0xffff0000, v247
    v_fma_f32 v94, v94, v119, -v115
    v_fma_f32 v95, v95, v119, -v115
    v_lshlrev_b32 v96, 16, v248
    v_and_b32 v97, 0xffff0000, v248
    v_fma_f32 v96, v96, v119, -v115
    v_fma_f32 v97, v97, v119, -v115
    v_lshlrev_b32 v98, 16, v249
    v_and_b32 v99, 0xffff0000, v249
    v_fma_f32 v98, v98, v119, -v115
    v_fma_f32 v99, v99, v119, -v115
    v_lshlrev_b32 v100, 16, v250
    v_and_b32 v101, 0xffff0000, v250
    v_fma_f32 v100, v100, v119, -v115
    v_fma_f32 v101, v101, v119, -v115
    v_lshlrev_b32 v102, 16, v251
    v_and_b32 v103, 0xffff0000, v251
    v_fma_f32 v102, v102, v119, -v115
    v_fma_f32 v103, v103, v119, -v115
    v_lshlrev_b32 v104, 16, v252
    v_and_b32 v105, 0xffff0000, v252
    v_fma_f32 v104, v104, v119, -v115
    v_fma_f32 v105, v105, v119, -v115
    v_lshlrev_b32 v106, 16, v253
    v_and_b32 v107, 0xffff0000, v253
    v_fma_f32 v106, v106, v119, -v115
    v_fma_f32 v107, v107, v119, -v115
    v_lshlrev_b32 v108, 16, v254
    v_and_b32 v109, 0xffff0000, v254
    v_fma_f32 v108, v108, v119, -v115
    v_fma_f32 v109, v109, v119, -v115
    v_lshlrev_b32 v110, 16, v255
    v_and_b32 v111, 0xffff0000, v255
    v_fma_f32 v110, v110, v119, -v115
    v_fma_f32 v111, v111, v119, -v115
    s_add_u32 s4, s62, 311296
    s_addc_u32 s5, s63, 0
    s_mov_b32 s6, 4718592
    s_mov_b32 s7, 0x00020000
    v_lshrrev_b32 v8, 3, v0
    v_lshlrev_b32 v8, 5, v8
    s_mul_i32 s27, s3, 768
    v_add_u32 v8, s27, v8
    v_lshrrev_b32 v9, 5, v0
    v_lshlrev_b32 v9, 17, v9
    v_bfe_u32 v10, v0, 3, 2
    v_lshl_add_u32 v9, v10, 8, v9
    v_and_b32 v10, 7, v0
    v_lshl_add_u32 v9, v10, 4, v9
    s_mul_i32 s31, s3, 768
    s_lshl_b32 s76, s73, 1
    s_add_u32 s31, s31, s76
    s_lshl_b32 s31, s31, 10
    s_barrier
    ds_read_b128 v[112:115], v8 offset:2048
    ds_read_b128 v[116:119], v8 offset:2064
    ds_read_b128 v[120:123], v8 offset:6656
    ds_read_b128 v[124:127], v8 offset:6672
    ds_read_b128 v[128:131], v8 offset:11264
    ds_read_b128 v[132:135], v8 offset:11280
    ds_read_b128 v[136:139], v8 offset:15872
    ds_read_b128 v[140:143], v8 offset:15888
    ds_read_b128 v[144:147], v8 offset:2304
    ds_read_b128 v[148:151], v8 offset:2320
    ds_read_b128 v[152:155], v8 offset:6912
    ds_read_b128 v[156:159], v8 offset:6928
    ds_read_b128 v[160:163], v8 offset:11520
    ds_read_b128 v[164:167], v8 offset:11536
    ds_read_b128 v[168:171], v8 offset:16128
    ds_read_b128 v[172:175], v8 offset:16144
    ds_read_b128 v[176:179], v8 offset:2560
    ds_read_b128 v[180:183], v8 offset:2576
    ds_read_b128 v[184:187], v8 offset:7168
    ds_read_b128 v[188:191], v8 offset:7184
    ds_read_b128 v[192:195], v8 offset:11776
    ds_read_b128 v[196:199], v8 offset:11792
    ds_read_b128 v[200:203], v8 offset:16384
    ds_read_b128 v[204:207], v8 offset:16400
    s_waitcnt lgkmcnt(15)
    v_pk_add_f32 v[112:113], v[112:113], v[128:129]
    v_pk_add_f32 v[114:115], v[114:115], v[130:131]
    v_pk_add_f32 v[116:117], v[116:117], v[132:133]
    v_pk_add_f32 v[118:119], v[118:119], v[134:135]
    v_pk_add_f32 v[120:121], v[120:121], v[136:137]
    v_pk_add_f32 v[122:123], v[122:123], v[138:139]
    v_pk_add_f32 v[124:125], v[124:125], v[140:141]
    v_pk_add_f32 v[126:127], v[126:127], v[142:143]
    s_add_u32 s27, s31, 0
    v_pk_fma_f32 v[16:17], v[16:17], v[120:121], v[112:113]
    v_pk_fma_f32 v[18:19], v[18:19], v[122:123], v[114:115]
    v_pk_fma_f32 v[20:21], v[20:21], v[124:125], v[116:117]
    v_pk_fma_f32 v[22:23], v[22:23], v[126:127], v[118:119]
    v_cvt_pk_bf16_f32 v208, v16, v17
    v_cvt_pk_bf16_f32 v209, v18, v19
    v_cvt_pk_bf16_f32 v210, v20, v21
    v_cvt_pk_bf16_f32 v211, v22, v23
    buffer_store_dwordx4 v[208:211], v9, s[4:7], s27 offen offset:0 sc1
    v_pk_fma_f32 v[40:41], v[40:41], v[120:121], v[112:113]
    v_pk_fma_f32 v[42:43], v[42:43], v[122:123], v[114:115]
    v_pk_fma_f32 v[44:45], v[44:45], v[124:125], v[116:117]
    v_pk_fma_f32 v[46:47], v[46:47], v[126:127], v[118:119]
    v_cvt_pk_bf16_f32 v220, v40, v41
    v_cvt_pk_bf16_f32 v221, v42, v43
    v_cvt_pk_bf16_f32 v222, v44, v45
    v_cvt_pk_bf16_f32 v223, v46, v47
    buffer_store_dwordx4 v[220:223], v9, s[4:7], s27 offen offset:128 sc1
    v_pk_fma_f32 v[64:65], v[64:65], v[120:121], v[112:113]
    v_pk_fma_f32 v[66:67], v[66:67], v[122:123], v[114:115]
    v_pk_fma_f32 v[68:69], v[68:69], v[124:125], v[116:117]
    v_pk_fma_f32 v[70:71], v[70:71], v[126:127], v[118:119]
    v_cvt_pk_bf16_f32 v232, v64, v65
    v_cvt_pk_bf16_f32 v233, v66, v67
    v_cvt_pk_bf16_f32 v234, v68, v69
    v_cvt_pk_bf16_f32 v235, v70, v71
    buffer_store_dwordx4 v[232:235], v9, s[4:7], s27 offen offset:1024 sc1
    v_pk_fma_f32 v[88:89], v[88:89], v[120:121], v[112:113]
    v_pk_fma_f32 v[90:91], v[90:91], v[122:123], v[114:115]
    v_pk_fma_f32 v[92:93], v[92:93], v[124:125], v[116:117]
    v_pk_fma_f32 v[94:95], v[94:95], v[126:127], v[118:119]
    v_cvt_pk_bf16_f32 v244, v88, v89
    v_cvt_pk_bf16_f32 v245, v90, v91
    v_cvt_pk_bf16_f32 v246, v92, v93
    v_cvt_pk_bf16_f32 v247, v94, v95
    buffer_store_dwordx4 v[244:247], v9, s[4:7], s27 offen offset:1152 sc1
    s_waitcnt lgkmcnt(8)
    v_pk_add_f32 v[144:145], v[144:145], v[160:161]
    v_pk_add_f32 v[146:147], v[146:147], v[162:163]
    v_pk_add_f32 v[148:149], v[148:149], v[164:165]
    v_pk_add_f32 v[150:151], v[150:151], v[166:167]
    v_pk_add_f32 v[152:153], v[152:153], v[168:169]
    v_pk_add_f32 v[154:155], v[154:155], v[170:171]
    v_pk_add_f32 v[156:157], v[156:157], v[172:173]
    v_pk_add_f32 v[158:159], v[158:159], v[174:175]
    s_add_u32 s27, s31, 262144
    v_pk_fma_f32 v[24:25], v[24:25], v[152:153], v[144:145]
    v_pk_fma_f32 v[26:27], v[26:27], v[154:155], v[146:147]
    v_pk_fma_f32 v[28:29], v[28:29], v[156:157], v[148:149]
    v_pk_fma_f32 v[30:31], v[30:31], v[158:159], v[150:151]
    v_cvt_pk_bf16_f32 v212, v24, v25
    v_cvt_pk_bf16_f32 v213, v26, v27
    v_cvt_pk_bf16_f32 v214, v28, v29
    v_cvt_pk_bf16_f32 v215, v30, v31
    buffer_store_dwordx4 v[212:215], v9, s[4:7], s27 offen offset:0 sc1
    v_pk_fma_f32 v[48:49], v[48:49], v[152:153], v[144:145]
    v_pk_fma_f32 v[50:51], v[50:51], v[154:155], v[146:147]
    v_pk_fma_f32 v[52:53], v[52:53], v[156:157], v[148:149]
    v_pk_fma_f32 v[54:55], v[54:55], v[158:159], v[150:151]
    v_cvt_pk_bf16_f32 v224, v48, v49
    v_cvt_pk_bf16_f32 v225, v50, v51
    v_cvt_pk_bf16_f32 v226, v52, v53
    v_cvt_pk_bf16_f32 v227, v54, v55
    buffer_store_dwordx4 v[224:227], v9, s[4:7], s27 offen offset:128 sc1
    v_pk_fma_f32 v[72:73], v[72:73], v[152:153], v[144:145]
    v_pk_fma_f32 v[74:75], v[74:75], v[154:155], v[146:147]
    v_pk_fma_f32 v[76:77], v[76:77], v[156:157], v[148:149]
    v_pk_fma_f32 v[78:79], v[78:79], v[158:159], v[150:151]
    v_cvt_pk_bf16_f32 v236, v72, v73
    v_cvt_pk_bf16_f32 v237, v74, v75
    v_cvt_pk_bf16_f32 v238, v76, v77
    v_cvt_pk_bf16_f32 v239, v78, v79
    buffer_store_dwordx4 v[236:239], v9, s[4:7], s27 offen offset:1024 sc1
    v_pk_fma_f32 v[96:97], v[96:97], v[152:153], v[144:145]
    v_pk_fma_f32 v[98:99], v[98:99], v[154:155], v[146:147]
    v_pk_fma_f32 v[100:101], v[100:101], v[156:157], v[148:149]
    v_pk_fma_f32 v[102:103], v[102:103], v[158:159], v[150:151]
    v_cvt_pk_bf16_f32 v248, v96, v97
    v_cvt_pk_bf16_f32 v249, v98, v99
    v_cvt_pk_bf16_f32 v250, v100, v101
    v_cvt_pk_bf16_f32 v251, v102, v103
    buffer_store_dwordx4 v[248:251], v9, s[4:7], s27 offen offset:1152 sc1
    s_waitcnt lgkmcnt(0)
    v_pk_add_f32 v[176:177], v[176:177], v[192:193]
    v_pk_add_f32 v[178:179], v[178:179], v[194:195]
    v_pk_add_f32 v[180:181], v[180:181], v[196:197]
    v_pk_add_f32 v[182:183], v[182:183], v[198:199]
    v_pk_add_f32 v[184:185], v[184:185], v[200:201]
    v_pk_add_f32 v[186:187], v[186:187], v[202:203]
    v_pk_add_f32 v[188:189], v[188:189], v[204:205]
    v_pk_add_f32 v[190:191], v[190:191], v[206:207]
    s_add_u32 s27, s31, 524288
    v_pk_fma_f32 v[32:33], v[32:33], v[184:185], v[176:177]
    v_pk_fma_f32 v[34:35], v[34:35], v[186:187], v[178:179]
    v_pk_fma_f32 v[36:37], v[36:37], v[188:189], v[180:181]
    v_pk_fma_f32 v[38:39], v[38:39], v[190:191], v[182:183]
    v_cvt_pk_bf16_f32 v216, v32, v33
    v_cvt_pk_bf16_f32 v217, v34, v35
    v_cvt_pk_bf16_f32 v218, v36, v37
    v_cvt_pk_bf16_f32 v219, v38, v39
    buffer_store_dwordx4 v[216:219], v9, s[4:7], s27 offen offset:0 sc1
    v_pk_fma_f32 v[56:57], v[56:57], v[184:185], v[176:177]
    v_pk_fma_f32 v[58:59], v[58:59], v[186:187], v[178:179]
    v_pk_fma_f32 v[60:61], v[60:61], v[188:189], v[180:181]
    v_pk_fma_f32 v[62:63], v[62:63], v[190:191], v[182:183]
    v_cvt_pk_bf16_f32 v228, v56, v57
    v_cvt_pk_bf16_f32 v229, v58, v59
    v_cvt_pk_bf16_f32 v230, v60, v61
    v_cvt_pk_bf16_f32 v231, v62, v63
    buffer_store_dwordx4 v[228:231], v9, s[4:7], s27 offen offset:128 sc1
    v_pk_fma_f32 v[80:81], v[80:81], v[184:185], v[176:177]
    v_pk_fma_f32 v[82:83], v[82:83], v[186:187], v[178:179]
    v_pk_fma_f32 v[84:85], v[84:85], v[188:189], v[180:181]
    v_pk_fma_f32 v[86:87], v[86:87], v[190:191], v[182:183]
    v_cvt_pk_bf16_f32 v240, v80, v81
    v_cvt_pk_bf16_f32 v241, v82, v83
    v_cvt_pk_bf16_f32 v242, v84, v85
    v_cvt_pk_bf16_f32 v243, v86, v87
    buffer_store_dwordx4 v[240:243], v9, s[4:7], s27 offen offset:1024 sc1
    v_pk_fma_f32 v[104:105], v[104:105], v[184:185], v[176:177]
    v_pk_fma_f32 v[106:107], v[106:107], v[186:187], v[178:179]
    v_pk_fma_f32 v[108:109], v[108:109], v[188:189], v[180:181]
    v_pk_fma_f32 v[110:111], v[110:111], v[190:191], v[182:183]
    v_cvt_pk_bf16_f32 v252, v104, v105
    v_cvt_pk_bf16_f32 v253, v106, v107
    v_cvt_pk_bf16_f32 v254, v108, v109
    v_cvt_pk_bf16_f32 v255, v110, v111
    buffer_store_dwordx4 v[252:255], v9, s[4:7], s27 offen offset:1152 sc1
    s_add_u32 s85, s73, 90
    s_mov_b64 exec, -1
    s_lshl_b32 s27, s85, 7
    v_mov_b32 v12, 0
    v_mov_b32 v13, 1
    s_cmp_lg_u32 s3, 0
    s_waitcnt vmcnt(0)
    s_barrier
    s_cbranch_scc1 sig_18
    s_mov_b64 exec, 1
    buffer_store_dword v13, v12, s[36:39], s27 offen sc1
    s_mov_b64 exec, -1
sig_18:
pa_hout:
    s_mov_b64 exec, -1
    s_branch next_task
pa_hhelp:
    s_cmp_eq_u32 s3, 7
    s_cbranch_scc1 pa_hpoll
    s_waitcnt vmcnt(0)
    s_mov_b32 s20, s46
    s_mov_b32 s21, s47
    s_mov_b32 s22, 7962624
    s_mov_b32 s23, 0x00020000
    s_lshl_b32 s28, s73, 6
    v_add_u32 v8, s28, v0
    s_mov_b32 s27, 58255
    v_mul_lo_u32 v9, v8, s27
    v_lshrrev_b32 v9, 20, v9
    s_mov_b32 s27, 4608
    v_mul_u32_u24 v9, s27, v9
    v_lshl_add_u32 v8, v8, 7, v9
    s_mov_b32 s27, 4608
    buffer_load_dword v13, v8, s[20:23], s27 offen
    s_add_u32 s28, s28, 4096
    v_add_u32 v8, s28, v0
    s_mov_b32 s27, 58255
    v_mul_lo_u32 v9, v8, s27
    v_lshrrev_b32 v9, 20, v9
    s_mov_b32 s27, 4608
    v_mul_u32_u24 v9, s27, v9
    v_lshl_add_u32 v8, v8, 7, v9
    s_mov_b32 s27, 4608
    buffer_load_dword v13, v8, s[20:23], s27 offen
    s_add_u32 s28, s28, 4096
    v_add_u32 v8, s28, v0
    s_mov_b32 s27, 58255
    v_mul_lo_u32 v9, v8, s27
    v_lshrrev_b32 v9, 20, v9
    s_mov_b32 s27, 4608
    v_mul_u32_u24 v9, s27, v9
    v_lshl_add_u32 v8, v8, 7, v9
    s_mov_b32 s27, 4608
    buffer_load_dword v13, v8, s[20:23], s27 offen
    s_add_u32 s28, s28, 4096
    v_add_u32 v8, s28, v0
    s_mov_b32 s27, 58255
    v_mul_lo_u32 v9, v8, s27
    v_lshrrev_b32 v9, 20, v9
    s_mov_b32 s27, 4608
    v_mul_u32_u24 v9, s27, v9
    v_lshl_add_u32 v8, v8, 7, v9
    s_mov_b32 s27, 4608
    buffer_load_dword v13, v8, s[20:23], s27 offen
    s_add_u32 s28, s28, 4096
    v_add_u32 v8, s28, v0
    s_mov_b32 s27, 58255
    v_mul_lo_u32 v9, v8, s27
    v_lshrrev_b32 v9, 20, v9
    s_mov_b32 s27, 4608
    v_mul_u32_u24 v9, s27, v9
    v_lshl_add_u32 v8, v8, 7, v9
    s_mov_b32 s27, 4608
    buffer_load_dword v13, v8, s[20:23], s27 offen
    s_add_u32 s28, s28, 4096
    s_cmp_ge_u32 s28, 20736
    s_cbranch_scc1 pfc_19
    v_add_u32 v8, s28, v0
    s_mov_b32 s27, 58255
    v_mul_lo_u32 v9, v8, s27
    v_lshrrev_b32 v9, 20, v9
    s_mov_b32 s27, 4608
    v_mul_u32_u24 v9, s27, v9
    v_lshl_add_u32 v8, v8, 7, v9
    s_mov_b32 s27, 4608
    buffer_load_dword v13, v8, s[20:23], s27 offen
pfc_19:
    s_mov_b32 s20, s48
    s_mov_b32 s21, s49
    s_mov_b32 s22, 2654208
    s_mov_b32 s23, 0x00020000
    v_lshlrev_b32 v8, 7, v0
    s_lshl_b32 s27, s73, 13
    buffer_load_dword v13, v8, s[20:23], s27 offen
    s_add_u32 s27, s27, 524288
    buffer_load_dword v13, v8, s[20:23], s27 offen
    s_add_u32 s27, s27, 524288
    buffer_load_dword v13, v8, s[20:23], s27 offen
    s_add_u32 s27, s27, 524288
    buffer_load_dword v13, v8, s[20:23], s27 offen
    s_add_u32 s27, s27, 524288
    buffer_load_dword v13, v8, s[20:23], s27 offen
    s_add_u32 s27, s27, 524288
    buffer_load_dword v13, v8, s[20:23], s27 offen
pa_hidle:
    s_waitcnt lgkmcnt(0)
    s_barrier
    s_barrier
    s_barrier
    s_branch pa_hout
pa_hpoll:
    v_min_u32 v8, 11, v0
    v_and_b32 v9, 1, v8
    v_lshlrev_b32 v9, 7, v9
    v_lshl_add_u32 v8, v8, 2, v9
    s_mov_b32 s34, 131072
wi_20:
    global_load_dword v9, v8, s[60:61] sc1
    s_sub_u32 s34, s34, 1
    s_waitcnt vmcnt(0)
    v_cmp_ne_u32 vcc, 1, v9
    s_cmp_eq_u32 s34, 0
    s_cbranch_scc1 wid_21
    s_cmp_eq_u64 vcc, 0
    s_cbranch_scc1 wid_21
    s_sleep 3
    s_branch wi_20
wid_21:
    s_barrier
    v_min_u32 v8, 35, v0
    v_lshlrev_b32 v8, 7, v8
    s_mov_b32 s27, 0
    s_mov_b32 s28, 4608
    s_mov_b32 s34, 131072
    s_mov_b32 exec_hi, 15
pa_mp:
    buffer_load_dword v9, v8, s[36:39], s27 offen sc1
    buffer_load_dword v10, v8, s[36:39], s28 offen sc1
    s_sub_u32 s34, s34, 1
    s_waitcnt vmcnt(0)
    v_add_u32 v9, v9, v10
    v_cmp_ne_u32 vcc, 2, v9
    s_cmp_eq_u32 s34, 0
    s_cbranch_scc1 pa_mpd
    s_cmp_eq_u64 vcc, 0
    s_cbranch_scc1 pa_mpd
    s_sleep 2
    s_branch pa_mp
pa_mpd:
    s_mov_b64 exec, -1
    s_add_u32 s12, s62, 131072
    s_addc_u32 s13, s63, 0
    s_mov_b32 s14, 36864
    s_mov_b32 s15, 0x00020000
    v_lshlrev_b32 v8, 4, v0
    s_lshr_b32 s79, s73, 5
    s_mul_i32 s79, s79, 9216
    s_mov_b32 m0, 2048
    s_add_u32 s27, s79, 0
    buffer_load_dwordx4 v8, s[12:15], s27 offen offset:0 sc1 lds
    buffer_load_dwordx4 v8, s[12:15], s27 offen offset:1024 sc1 lds
    buffer_load_dwordx4 v8, s[12:15], s27 offen offset:2048 sc1 lds
    buffer_load_dwordx4 v8, s[12:15], s27 offen offset:3072 sc1 lds
    s_mov_b32 m0, 6144
    s_add_u32 s27, s79, 4096
    buffer_load_dwordx4 v8, s[12:15], s27 offen offset:0 sc1 lds
    buffer_load_dwordx4 v8, s[12:15], s27 offen offset:1024 sc1 lds
    buffer_load_dwordx4 v8, s[12:15], s27 offen offset:2048 sc1 lds
    buffer_load_dwordx4 v8, s[12:15], s27 offen offset:3072 sc1 lds
    s_mov_b32 m0, 10240
    s_add_u32 s27, s79, 8192
    buffer_load_dwordx4 v8, s[12:15], s27 offen offset:0 sc1 lds
    s_mov_b32 m0, 11264
    s_add_u32 s27, s79, 18432
    buffer_load_dwordx4 v8, s[12:15], s27 offen offset:0 sc1 lds
    buffer_load_dwordx4 v8, s[12:15], s27 offen offset:1024 sc1 lds
    buffer_load_dwordx4 v8, s[12:15], s27 offen offset:2048 sc1 lds
    buffer_load_dwordx4 v8, s[12:15], s27 offen offset:3072 sc1 lds
    s_mov_b32 m0, 15360
    s_add_u32 s27, s79, 22528
    buffer_load_dwordx4 v8, s[12:15], s27 offen offset:0 sc1 lds
    buffer_load_dwordx4 v8, s[12:15], s27 offen offset:1024 sc1 lds
    buffer_load_dwordx4 v8, s[12:15], s27 offen offset:2048 sc1 lds
    buffer_load_dwordx4 v8, s[12:15], s27 offen offset:3072 sc1 lds
    s_mov_b32 m0, 19456
    s_add_u32 s27, s79, 26624
    buffer_load_dwordx4 v8, s[12:15], s27 offen offset:0 sc1 lds
    s_waitcnt vmcnt(0)
    s_barrier
    s_barrier
    s_branch pa_hout
quit0:
    s_endpgm
next_task:
    s_waitcnt lgkmcnt(0)
    s_add_u32 s80, s80, 1
    s_and_b32 s66, s0, 15
    s_bfe_u32 s67, s0, 0x50004
    s_bfe_u32 s68, s0, 0x50009
    s_bfe_u32 s74, s0, 0x2000e
    s_lshr_b64 s[0:1], s[0:1], 16
    s_cmp_eq_u32 s66, 1
    s_cbranch_scc1 role_T
    s_cmp_eq_u32 s66, 5
    s_cbranch_scc1 role_S
    s_cmp_eq_u32 s66, 7
    s_cbranch_scc1 role_PV
    s_cmp_eq_u32 s66, 6
    s_cbranch_scc1 role_V
    s_cmp_eq_u32 s66, 2
    s_cbranch_scc1 role_wvo
    s_cmp_eq_u32 s66, 3
    s_cbranch_scc1 role_kvc
    s_cmp_eq_u32 s66, 4
    s_cbranch_scc1 role_gate
    s_cmp_eq_u32 s66, 8
    s_cbranch_scc1 role_AT
    s_cmp_eq_u32 s66, 9
    s_cbranch_scc1 role_BT
    s_cmp_eq_u32 s66, 10
    s_cbranch_scc1 role_pf
    s_branch role_E
role_T:
    s_mul_i32 s66, s67, 9
    s_add_u32 s66, s66, s68
    s_lshl_b32 s24, s68, 13
    s_lshl_b32 s25, s67, 13
    s_lshl_b32 s75, s68, 2
    s_lshl_b32 s76, s67, 3
    s_add_u32 s78, s66, 262
    s_lshl_b32 s69, s68, 2
    s_mul_i32 s69, s69, 43
    s_lshr_b32 s69, s69, 7
    s_add_u32 s4, s62, 5029888
    s_addc_u32 s5, s63, 0
    s_mov_b32 s6, 2654208
    s_mov_b32 s7, 0x00020000
    s_add_u32 s8, s62, 311296
    s_addc_u32 s9, s63, 0
    s_mov_b32 s10, 4718592
    s_mov_b32 s11, 0x00020000
    s_add_u32 s12, s62, 10338304
    s_addc_u32 s13, s63, 0
    s_mov_b32 s14, 4718592
    s_mov_b32 s15, 0x00020000
    s_cmp_ge_u32 s3, 4
    s_cbranch_scc1 tt_loader_22
    s_cmp_ge_u32 s3, 4
    s_cbranch_scc1 tpf_24
    s_mul_i32 s79, s66, 4
    s_add_u32 s79, s79, s3
    s_add_u32 s79, s79, 72
    s_mov_b32 s20, s52
    s_mov_b32 s21, s53
    s_mov_b32 s22, 5308416
    s_mov_b32 s23, 0x00020000
    v_lshlrev_b32 v8, 7, v0
    s_lshl_b32 s27, s79, 13
    buffer_load_dword v14, v8, s[20:23], s27 offen
tpf_24:
    s_and_b32 s84, s3, 1
    s_lshr_b32 s83, s3, 1
    s_mul_i32 s27, s83, 4096
    s_add_u32 s27, s27, 0
    v_lshlrev_b32 v4, 4, v0
    v_add_u32 v4, s27, v4
    s_mul_i32 s27, s84, 4096
    s_add_u32 s27, s27, 49152
    v_lshlrev_b32 v5, 4, v0
    v_add_u32 v5, s27, v5
    v_mov_b32 v16, 0
    v_mov_b32 v17, 0
    v_mov_b32 v18, 0
    v_mov_b32 v19, 0
    v_mov_b32 v20, 0
    v_mov_b32 v21, 0
    v_mov_b32 v22, 0
    v_mov_b32 v23, 0
    v_mov_b32 v24, 0
    v_mov_b32 v25, 0
    v_mov_b32 v26, 0
    v_mov_b32 v27, 0
    v_mov_b32 v28, 0
    v_mov_b32 v29, 0
    v_mov_b32 v30, 0
    v_mov_b32 v31, 0
    v_mov_b32 v32, 0
    v_mov_b32 v33, 0
    v_mov_b32 v34, 0
    v_mov_b32 v35, 0
    v_mov_b32 v36, 0
    v_mov_b32 v37, 0
    v_mov_b32 v38, 0
    v_mov_b32 v39, 0
    v_mov_b32 v40, 0
    v_mov_b32 v41, 0
    v_mov_b32 v42, 0
    v_mov_b32 v43, 0
    v_mov_b32 v44, 0
    v_mov_b32 v45, 0
    v_mov_b32 v46, 0
    v_mov_b32 v47, 0
    v_mov_b32 v48, 0
    v_mov_b32 v49, 0
    v_mov_b32 v50, 0
    v_mov_b32 v51, 0
    v_mov_b32 v52, 0
    v_mov_b32 v53, 0
    v_mov_b32 v54, 0
    v_mov_b32 v55, 0
    v_mov_b32 v56, 0
    v_mov_b32 v57, 0
    v_mov_b32 v58, 0
    v_mov_b32 v59, 0
    v_mov_b32 v60, 0
    v_mov_b32 v61, 0
    v_mov_b32 v62, 0
    v_mov_b32 v63, 0
    v_mov_b32 v64, 0
    v_mov_b32 v65, 0
    v_mov_b32 v66, 0
    v_mov_b32 v67, 0
    v_mov_b32 v68, 0
    v_mov_b32 v69, 0
    v_mov_b32 v70, 0
    v_mov_b32 v71, 0
    v_mov_b32 v72, 0
    v_mov_b32 v73, 0
    v_mov_b32 v74, 0
    v_mov_b32 v75, 0
    v_mov_b32 v76, 0
    v_mov_b32 v77, 0
    v_mov_b32 v78, 0
    v_mov_b32 v79, 0
    s_mov_b32 s33, 0
    s_mov_b32 s31, 0
    s_mov_b32 s30, 16384
    s_mov_b32 s32, 16384
    s_mov_b32 s34, 17
    s_barrier
    ds_read_b128 v[96:99], v5 offset:0
    ds_read_b128 v[100:103], v5 offset:1024
    ds_read_b128 v[104:107], v5 offset:2048
    ds_read_b128 v[108:111], v5 offset:3072
    ds_read_b128 v[80:83], v4 offset:0
    ds_read_b128 v[84:87], v4 offset:1024
    ds_read_b128 v[88:91], v4 offset:2048
    ds_read_b128 v[92:95], v4 offset:3072
    s_waitcnt lgkmcnt(0)
tt_mm_25:
    v_mfma_f32_16x16x32_bf16 v[16:19], v[80:83], v[96:99], v[16:19]
    ds_read_b128 v[128:131], v5 offset:8192
    v_mfma_f32_16x16x32_bf16 v[20:23], v[80:83], v[100:103], v[20:23]
    ds_read_b128 v[132:135], v5 offset:9216
    v_mfma_f32_16x16x32_bf16 v[24:27], v[80:83], v[104:107], v[24:27]
    ds_read_b128 v[136:139], v5 offset:10240
    v_mfma_f32_16x16x32_bf16 v[28:31], v[80:83], v[108:111], v[28:31]
    ds_read_b128 v[140:143], v5 offset:11264
    v_mfma_f32_16x16x32_bf16 v[32:35], v[84:87], v[96:99], v[32:35]
    ds_read_b128 v[112:115], v4 offset:8192
    v_mfma_f32_16x16x32_bf16 v[36:39], v[84:87], v[100:103], v[36:39]
    ds_read_b128 v[116:119], v4 offset:9216
    v_mfma_f32_16x16x32_bf16 v[40:43], v[84:87], v[104:107], v[40:43]
    ds_read_b128 v[120:123], v4 offset:10240
    v_mfma_f32_16x16x32_bf16 v[44:47], v[84:87], v[108:111], v[44:47]
    ds_read_b128 v[124:127], v4 offset:11264
    v_mfma_f32_16x16x32_bf16 v[48:51], v[88:91], v[96:99], v[48:51]
    s_add_u32 s33, s33, 1
    v_mfma_f32_16x16x32_bf16 v[52:55], v[88:91], v[100:103], v[52:55]
    s_cmp_eq_u32 s33, 3
    v_mfma_f32_16x16x32_bf16 v[56:59], v[88:91], v[104:107], v[56:59]
    s_cselect_b32 s35, 4294934528, s30
    v_mfma_f32_16x16x32_bf16 v[60:63], v[88:91], v[108:111], v[60:63]
    s_cselect_b32 s29, 4294934528, s32
    v_mfma_f32_16x16x32_bf16 v[64:67], v[92:95], v[96:99], v[64:67]
    s_cselect_b32 s33, 0, s33
    v_mfma_f32_16x16x32_bf16 v[68:71], v[92:95], v[100:103], v[68:71]
    v_add_u32 v4, s35, v4
    v_mfma_f32_16x16x32_bf16 v[72:75], v[92:95], v[104:107], v[72:75]
    v_add_u32 v5, s29, v5
    v_mfma_f32_16x16x32_bf16 v[76:79], v[92:95], v[108:111], v[76:79]
    s_waitcnt lgkmcnt(0)
    s_barrier
    v_mfma_f32_16x16x32_bf16 v[16:19], v[112:115], v[128:131], v[16:19]
    ds_read_b128 v[96:99], v5 offset:0
    v_mfma_f32_16x16x32_bf16 v[20:23], v[112:115], v[132:135], v[20:23]
    ds_read_b128 v[100:103], v5 offset:1024
    v_mfma_f32_16x16x32_bf16 v[24:27], v[112:115], v[136:139], v[24:27]
    ds_read_b128 v[104:107], v5 offset:2048
    v_mfma_f32_16x16x32_bf16 v[28:31], v[112:115], v[140:143], v[28:31]
    ds_read_b128 v[108:111], v5 offset:3072
    v_mfma_f32_16x16x32_bf16 v[32:35], v[116:119], v[128:131], v[32:35]
    ds_read_b128 v[80:83], v4 offset:0
    v_mfma_f32_16x16x32_bf16 v[36:39], v[116:119], v[132:135], v[36:39]
    ds_read_b128 v[84:87], v4 offset:1024
    v_mfma_f32_16x16x32_bf16 v[40:43], v[116:119], v[136:139], v[40:43]
    ds_read_b128 v[88:91], v4 offset:2048
    v_mfma_f32_16x16x32_bf16 v[44:47], v[116:119], v[140:143], v[44:47]
    ds_read_b128 v[92:95], v4 offset:3072
    v_mfma_f32_16x16x32_bf16 v[48:51], v[120:123], v[128:131], v[48:51]
    s_sub_u32 s34, s34, 1
    v_mfma_f32_16x16x32_bf16 v[52:55], v[120:123], v[132:135], v[52:55]
    s_cmp_lg_u32 s34, 0
    v_mfma_f32_16x16x32_bf16 v[56:59], v[120:123], v[136:139], v[56:59]
    v_mfma_f32_16x16x32_bf16 v[60:63], v[120:123], v[140:143], v[60:63]
    v_mfma_f32_16x16x32_bf16 v[64:67], v[124:127], v[128:131], v[64:67]
    v_mfma_f32_16x16x32_bf16 v[68:71], v[124:127], v[132:135], v[68:71]
    v_mfma_f32_16x16x32_bf16 v[72:75], v[124:127], v[136:139], v[72:75]
    v_mfma_f32_16x16x32_bf16 v[76:79], v[124:127], v[140:143], v[76:79]
    s_waitcnt lgkmcnt(0)
    s_cbranch_scc1 tt_mm_25
    v_mfma_f32_16x16x32_bf16 v[16:19], v[80:83], v[96:99], v[16:19]
    ds_read_b128 v[128:131], v5 offset:8192
    v_mfma_f32_16x16x32_bf16 v[20:23], v[80:83], v[100:103], v[20:23]
    ds_read_b128 v[132:135], v5 offset:9216
    v_mfma_f32_16x16x32_bf16 v[24:27], v[80:83], v[104:107], v[24:27]
    ds_read_b128 v[136:139], v5 offset:10240
    v_mfma_f32_16x16x32_bf16 v[28:31], v[80:83], v[108:111], v[28:31]
    ds_read_b128 v[140:143], v5 offset:11264
    v_mfma_f32_16x16x32_bf16 v[32:35], v[84:87], v[96:99], v[32:35]
    ds_read_b128 v[112:115], v4 offset:8192
    v_mfma_f32_16x16x32_bf16 v[36:39], v[84:87], v[100:103], v[36:39]
    ds_read_b128 v[116:119], v4 offset:9216
    v_mfma_f32_16x16x32_bf16 v[40:43], v[84:87], v[104:107], v[40:43]
    ds_read_b128 v[120:123], v4 offset:10240
    v_mfma_f32_16x16x32_bf16 v[44:47], v[84:87], v[108:111], v[44:47]
    ds_read_b128 v[124:127], v4 offset:11264
    v_mfma_f32_16x16x32_bf16 v[48:51], v[88:91], v[96:99], v[48:51]
    v_mfma_f32_16x16x32_bf16 v[52:55], v[88:91], v[100:103], v[52:55]
    v_mfma_f32_16x16x32_bf16 v[56:59], v[88:91], v[104:107], v[56:59]
    v_mfma_f32_16x16x32_bf16 v[60:63], v[88:91], v[108:111], v[60:63]
    v_mfma_f32_16x16x32_bf16 v[64:67], v[92:95], v[96:99], v[64:67]
    v_mfma_f32_16x16x32_bf16 v[68:71], v[92:95], v[100:103], v[68:71]
    v_mfma_f32_16x16x32_bf16 v[72:75], v[92:95], v[104:107], v[72:75]
    v_mfma_f32_16x16x32_bf16 v[76:79], v[92:95], v[108:111], v[76:79]
    s_waitcnt lgkmcnt(0)
    v_mfma_f32_16x16x32_bf16 v[16:19], v[112:115], v[128:131], v[16:19]
    v_mfma_f32_16x16x32_bf16 v[20:23], v[112:115], v[132:135], v[20:23]
    v_mfma_f32_16x16x32_bf16 v[24:27], v[112:115], v[136:139], v[24:27]
    v_mfma_f32_16x16x32_bf16 v[28:31], v[112:115], v[140:143], v[28:31]
    v_mfma_f32_16x16x32_bf16 v[32:35], v[116:119], v[128:131], v[32:35]
    v_mfma_f32_16x16x32_bf16 v[36:39], v[116:119], v[132:135], v[36:39]
    v_mfma_f32_16x16x32_bf16 v[40:43], v[116:119], v[136:139], v[40:43]
    v_mfma_f32_16x16x32_bf16 v[44:47], v[116:119], v[140:143], v[44:47]
    v_mfma_f32_16x16x32_bf16 v[48:51], v[120:123], v[128:131], v[48:51]
    v_mfma_f32_16x16x32_bf16 v[52:55], v[120:123], v[132:135], v[52:55]
    v_mfma_f32_16x16x32_bf16 v[56:59], v[120:123], v[136:139], v[56:59]
    v_mfma_f32_16x16x32_bf16 v[60:63], v[120:123], v[140:143], v[60:63]
    v_mfma_f32_16x16x32_bf16 v[64:67], v[124:127], v[128:131], v[64:67]
    v_mfma_f32_16x16x32_bf16 v[68:71], v[124:127], v[132:135], v[68:71]
    v_mfma_f32_16x16x32_bf16 v[72:75], v[124:127], v[136:139], v[72:75]
    v_mfma_f32_16x16x32_bf16 v[76:79], v[124:127], v[140:143], v[76:79]
    s_mul_i32 s27, s83, 2
    s_add_u32 s27, s27, s75
    s_mul_i32 s27, s27, 128
    s_mul_i32 s28, s84, 4
    s_add_u32 s27, s27, s28
    s_add_u32 s27, s27, s76
    s_lshl_b32 s26, s27, 10
    v_lshlrev_b32 v1, 4, v0
    s_nop 1
    v_cvt_pk_bf16_f32 v80, v16, v17
    v_cvt_pk_bf16_f32 v81, v18, v19
    v_cvt_pk_bf16_f32 v82, v32, v33
    v_cvt_pk_bf16_f32 v83, v34, v35
    s_add_u32 s27, s26, 0
    buffer_store_dwordx4 v[80:83], v1, s[12:15], s27 offen offset:0 sc1
    v_cvt_pk_bf16_f32 v84, v20, v21
    v_cvt_pk_bf16_f32 v85, v22, v23
    v_cvt_pk_bf16_f32 v86, v36, v37
    v_cvt_pk_bf16_f32 v87, v38, v39
    s_add_u32 s27, s26, 0
    buffer_store_dwordx4 v[84:87], v1, s[12:15], s27 offen offset:1024 sc1
    v_cvt_pk_bf16_f32 v88, v24, v25
    v_cvt_pk_bf16_f32 v89, v26, v27
    v_cvt_pk_bf16_f32 v90, v40, v41
    v_cvt_pk_bf16_f32 v91, v42, v43
    s_add_u32 s27, s26, 0
    buffer_store_dwordx4 v[88:91], v1, s[12:15], s27 offen offset:2048 sc1
    v_cvt_pk_bf16_f32 v92, v28, v29
    v_cvt_pk_bf16_f32 v93, v30, v31
    v_cvt_pk_bf16_f32 v94, v44, v45
    v_cvt_pk_bf16_f32 v95, v46, v47
    s_add_u32 s27, s26, 0
    buffer_store_dwordx4 v[92:95], v1, s[12:15], s27 offen offset:3072 sc1
    v_cvt_pk_bf16_f32 v96, v48, v49
    v_cvt_pk_bf16_f32 v97, v50, v51
    v_cvt_pk_bf16_f32 v98, v64, v65
    v_cvt_pk_bf16_f32 v99, v66, v67
    s_add_u32 s27, s26, 131072
    buffer_store_dwordx4 v[96:99], v1, s[12:15], s27 offen offset:0 sc1
    v_cvt_pk_bf16_f32 v100, v52, v53
    v_cvt_pk_bf16_f32 v101, v54, v55
    v_cvt_pk_bf16_f32 v102, v68, v69
    v_cvt_pk_bf16_f32 v103, v70, v71
    s_add_u32 s27, s26, 131072
    buffer_store_dwordx4 v[100:103], v1, s[12:15], s27 offen offset:1024 sc1
    v_cvt_pk_bf16_f32 v104, v56, v57
    v_cvt_pk_bf16_f32 v105, v58, v59
    v_cvt_pk_bf16_f32 v106, v72, v73
    v_cvt_pk_bf16_f32 v107, v74, v75
    s_add_u32 s27, s26, 131072
    buffer_store_dwordx4 v[104:107], v1, s[12:15], s27 offen offset:2048 sc1
    v_cvt_pk_bf16_f32 v108, v60, v61
    v_cvt_pk_bf16_f32 v109, v62, v63
    v_cvt_pk_bf16_f32 v110, v76, v77
    v_cvt_pk_bf16_f32 v111, v78, v79
    s_add_u32 s27, s26, 131072
    buffer_store_dwordx4 v[108:111], v1, s[12:15], s27 offen offset:3072 sc1
    s_mov_b64 exec, -1
    s_lshl_b32 s27, s78, 7
    v_mov_b32 v8, 0
    v_mov_b32 v9, 1
    s_cmp_lg_u32 s3, 0
    s_waitcnt vmcnt(0)
    s_barrier
    s_cbranch_scc1 sig_26
    s_mov_b64 exec, 1
    buffer_store_dword v9, v8, s[36:39], s27 offen sc1
    s_mov_b64 exec, -1
sig_26:
tt_exit_27:
    s_mov_b64 exec, -1
    s_branch next_task
tt_loader_22:
    s_and_b32 s82, s3, 1
    s_cmp_ge_u32 s3, 6
    s_cbranch_scc1 tt_loaderB_23
    v_lshlrev_b32 v1, 4, v0
    s_mul_i32 s31, s82, 73728
    s_add_u32 s31, s31, s24
    s_mul_i32 s32, s82, 8192
    s_add_u32 s32, s32, 0
    s_add_u32 s29, s31, 442368
    s_mov_b32 s35, 0
    s_mul_i32 s27, s74, 147456
    s_add_u32 s31, s31, s27
    s_mul_i32 s85, s69, 9
    s_add_u32 s85, s85, 154
    v_min_u32 v252, 17, v0
    v_lshlrev_b32 v252, 7, v252
    s_lshl_b32 s27, s85, 7
    s_mov_b32 s34, 131072
    s_mov_b64 exec, 0x3ffff
poll_28:
    buffer_load_dword v253, v252, s[36:39], s27 offen sc1
    s_sub_u32 s34, s34, 1
    s_waitcnt vmcnt(0)
    v_cmp_ne_u32 vcc, 1, v253
    s_cmp_eq_u32 s34, 0
    s_cbranch_scc1 polled_29
    s_cmp_eq_u64 vcc, 0
    s_cbranch_scc1 polled_29
    s_sleep 3
    s_branch poll_28
polled_29:
    s_mov_b64 exec, -1
    s_mov_b32 m0, s32
    s_nop 0
    buffer_load_dwordx4 v1, s[4:7], s31 offen sc1 lds
    buffer_load_dwordx4 v1, s[4:7], s31 offen offset:1024 sc1 lds
    buffer_load_dwordx4 v1, s[4:7], s31 offen offset:2048 sc1 lds
    buffer_load_dwordx4 v1, s[4:7], s31 offen offset:3072 sc1 lds
    s_add_u32 m0, s32, 4096
    s_add_u32 s27, s31, 4096
    buffer_load_dwordx4 v1, s[4:7], s27 offen sc1 lds
    buffer_load_dwordx4 v1, s[4:7], s27 offen offset:1024 sc1 lds
    buffer_load_dwordx4 v1, s[4:7], s27 offen offset:2048 sc1 lds
    buffer_load_dwordx4 v1, s[4:7], s27 offen offset:3072 sc1 lds
    s_add_u32 s31, s31, 147456
    s_cmp_ge_u32 s31, s29
    s_cselect_b32 s27, 442368, 0
    s_sub_u32 s31, s31, s27
    s_add_u32 s35, s35, 1
    s_cmp_eq_u32 s35, 3
    s_cselect_b32 s27, 442368, 0
    s_cselect_b32 s35, 0, s35
    s_add_u32 s31, s31, s27
    s_add_u32 s29, s29, s27
    s_add_u32 m0, s32, 16384
    s_nop 0
    buffer_load_dwordx4 v1, s[4:7], s31 offen sc1 lds
    buffer_load_dwordx4 v1, s[4:7], s31 offen offset:1024 sc1 lds
    buffer_load_dwordx4 v1, s[4:7], s31 offen offset:2048 sc1 lds
    buffer_load_dwordx4 v1, s[4:7], s31 offen offset:3072 sc1 lds
    s_add_u32 m0, s32, 20480
    s_add_u32 s27, s31, 4096
    buffer_load_dwordx4 v1, s[4:7], s27 offen sc1 lds
    buffer_load_dwordx4 v1, s[4:7], s27 offen offset:1024 sc1 lds
    buffer_load_dwordx4 v1, s[4:7], s27 offen offset:2048 sc1 lds
    buffer_load_dwordx4 v1, s[4:7], s27 offen offset:3072 sc1 lds
    s_add_u32 s31, s31, 147456
    s_cmp_ge_u32 s31, s29
    s_cselect_b32 s27, 442368, 0
    s_sub_u32 s31, s31, s27
    s_add_u32 s35, s35, 1
    s_cmp_eq_u32 s35, 3
    s_cselect_b32 s27, 442368, 0
    s_cselect_b32 s35, 0, s35
    s_add_u32 s31, s31, s27
    s_add_u32 s29, s29, s27
    s_add_u32 m0, s32, 32768
    s_nop 0
    buffer_load_dwordx4 v1, s[4:7], s31 offen sc1 lds
    buffer_load_dwordx4 v1, s[4:7], s31 offen offset:1024 sc1 lds
    buffer_load_dwordx4 v1, s[4:7], s31 offen offset:2048 sc1 lds
    buffer_load_dwordx4 v1, s[4:7], s31 offen offset:3072 sc1 lds
    s_add_u32 m0, s32, 36864
    s_add_u32 s27, s31, 4096
    buffer_load_dwordx4 v1, s[4:7], s27 offen sc1 lds
    buffer_load_dwordx4 v1, s[4:7], s27 offen offset:1024 sc1 lds
    buffer_load_dwordx4 v1, s[4:7], s27 offen offset:2048 sc1 lds
    buffer_load_dwordx4 v1, s[4:7], s27 offen offset:3072 sc1 lds
    s_add_u32 s31, s31, 147456
    s_cmp_ge_u32 s31, s29
    s_cselect_b32 s27, 442368, 0
    s_sub_u32 s31, s31, s27
    s_add_u32 s35, s35, 1
    s_cmp_eq_u32 s35, 3
    s_cselect_b32 s27, 442368, 0
    s_cselect_b32 s35, 0, s35
    s_add_u32 s31, s31, s27
    s_add_u32 s29, s29, s27
    s_waitcnt vmcnt(16)
    s_barrier
    s_mov_b32 s33, 0
    s_mov_b32 s34, 15
tt_ld_30:
    s_waitcnt vmcnt(8)
    s_barrier
    s_add_u32 s28, s32, s33
    s_mov_b32 m0, s28
    s_nop 0
    buffer_load_dwordx4 v1, s[4:7], s31 offen sc1 lds
    buffer_load_dwordx4 v1, s[4:7], s31 offen offset:1024 sc1 lds
    buffer_load_dwordx4 v1, s[4:7], s31 offen offset:2048 sc1 lds
    buffer_load_dwordx4 v1, s[4:7], s31 offen offset:3072 sc1 lds
    s_add_u32 m0, s28, 4096
    s_add_u32 s27, s31, 4096
    buffer_load_dwordx4 v1, s[4:7], s27 offen sc1 lds
    buffer_load_dwordx4 v1, s[4:7], s27 offen offset:1024 sc1 lds
    buffer_load_dwordx4 v1, s[4:7], s27 offen offset:2048 sc1 lds
    buffer_load_dwordx4 v1, s[4:7], s27 offen offset:3072 sc1 lds
    s_add_u32 s31, s31, 147456
    s_cmp_ge_u32 s31, s29
    s_cselect_b32 s27, 442368, 0
    s_sub_u32 s31, s31, s27
    s_add_u32 s35, s35, 1
    s_cmp_eq_u32 s35, 3
    s_cselect_b32 s27, 442368, 0
    s_cselect_b32 s35, 0, s35
    s_add_u32 s31, s31, s27
    s_add_u32 s29, s29, s27
    s_add_u32 s33, s33, 16384
    s_cmp_eq_u32 s33, 49152
    s_cselect_b32 s33, 0, s33
    s_sub_u32 s34, s34, 1
    s_cmp_lg_u32 s34, 0
    s_cbranch_scc1 tt_ld_30
    s_waitcnt vmcnt(8)
    s_barrier
    s_waitcnt vmcnt(0)
    s_barrier
    s_barrier
    s_branch tt_exit_27
tt_loaderB_23:
    v_lshlrev_b32 v1, 4, v0
    s_mul_i32 s31, s82, 131072
    s_add_u32 s31, s31, s25
    s_mul_i32 s32, s82, 8192
    s_add_u32 s32, s32, 49152
    s_add_u32 s29, s31, 786432
    s_mov_b32 s35, 0
    s_mul_i32 s27, s74, 262144
    s_add_u32 s31, s31, s27
    s_mul_i32 s85, s67, 4
    s_add_u32 s85, s85, 90
    v_min_u32 v252, 3, v0
    v_lshlrev_b32 v252, 7, v252
    s_lshl_b32 s27, s85, 7
    s_mov_b32 s34, 131072
    s_mov_b64 exec, 0xf
poll_31:
    buffer_load_dword v253, v252, s[36:39], s27 offen sc1
    s_sub_u32 s34, s34, 1
    s_waitcnt vmcnt(0)
    v_cmp_ne_u32 vcc, 1, v253
    s_cmp_eq_u32 s34, 0
    s_cbranch_scc1 polled_32
    s_cmp_eq_u64 vcc, 0
    s_cbranch_scc1 polled_32
    s_sleep 3
    s_branch poll_31
polled_32:
    s_mov_b64 exec, -1
    s_mov_b32 m0, s32
    s_nop 0
    buffer_load_dwordx4 v1, s[8:11], s31 offen sc1 lds
    buffer_load_dwordx4 v1, s[8:11], s31 offen offset:1024 sc1 lds
    buffer_load_dwordx4 v1, s[8:11], s31 offen offset:2048 sc1 lds
    buffer_load_dwordx4 v1, s[8:11], s31 offen offset:3072 sc1 lds
    s_add_u32 m0, s32, 4096
    s_add_u32 s27, s31, 4096
    buffer_load_dwordx4 v1, s[8:11], s27 offen sc1 lds
    buffer_load_dwordx4 v1, s[8:11], s27 offen offset:1024 sc1 lds
    buffer_load_dwordx4 v1, s[8:11], s27 offen offset:2048 sc1 lds
    buffer_load_dwordx4 v1, s[8:11], s27 offen offset:3072 sc1 lds
    s_add_u32 s31, s31, 262144
    s_cmp_ge_u32 s31, s29
    s_cselect_b32 s27, 786432, 0
    s_sub_u32 s31, s31, s27
    s_add_u32 s35, s35, 1
    s_cmp_eq_u32 s35, 3
    s_cselect_b32 s27, 786432, 0
    s_cselect_b32 s35, 0, s35
    s_add_u32 s31, s31, s27
    s_add_u32 s29, s29, s27
    s_add_u32 m0, s32, 16384
    s_nop 0
    buffer_load_dwordx4 v1, s[8:11], s31 offen sc1 lds
    buffer_load_dwordx4 v1, s[8:11], s31 offen offset:1024 sc1 lds
    buffer_load_dwordx4 v1, s[8:11], s31 offen offset:2048 sc1 lds
    buffer_load_dwordx4 v1, s[8:11], s31 offen offset:3072 sc1 lds
    s_add_u32 m0, s32, 20480
    s_add_u32 s27, s31, 4096
    buffer_load_dwordx4 v1, s[8:11], s27 offen sc1 lds
    buffer_load_dwordx4 v1, s[8:11], s27 offen offset:1024 sc1 lds
    buffer_load_dwordx4 v1, s[8:11], s27 offen offset:2048 sc1 lds
    buffer_load_dwordx4 v1, s[8:11], s27 offen offset:3072 sc1 lds
    s_add_u32 s31, s31, 262144
    s_cmp_ge_u32 s31, s29
    s_cselect_b32 s27, 786432, 0
    s_sub_u32 s31, s31, s27
    s_add_u32 s35, s35, 1
    s_cmp_eq_u32 s35, 3
    s_cselect_b32 s27, 786432, 0
    s_cselect_b32 s35, 0, s35
    s_add_u32 s31, s31, s27
    s_add_u32 s29, s29, s27
    s_add_u32 m0, s32, 32768
    s_nop 0
    buffer_load_dwordx4 v1, s[8:11], s31 offen sc1 lds
    buffer_load_dwordx4 v1, s[8:11], s31 offen offset:1024 sc1 lds
    buffer_load_dwordx4 v1, s[8:11], s31 offen offset:2048 sc1 lds
    buffer_load_dwordx4 v1, s[8:11], s31 offen offset:3072 sc1 lds
    s_add_u32 m0, s32, 36864
    s_add_u32 s27, s31, 4096
    buffer_load_dwordx4 v1, s[8:11], s27 offen sc1 lds
    buffer_load_dwordx4 v1, s[8:11], s27 offen offset:1024 sc1 lds
    buffer_load_dwordx4 v1, s[8:11], s27 offen offset:2048 sc1 lds
    buffer_load_dwordx4 v1, s[8:11], s27 offen offset:3072 sc1 lds
    s_add_u32 s31, s31, 262144
    s_cmp_ge_u32 s31, s29
    s_cselect_b32 s27, 786432, 0
    s_sub_u32 s31, s31, s27
    s_add_u32 s35, s35, 1
    s_cmp_eq_u32 s35, 3
    s_cselect_b32 s27, 786432, 0
    s_cselect_b32 s35, 0, s35
    s_add_u32 s31, s31, s27
    s_add_u32 s29, s29, s27
    s_waitcnt vmcnt(16)
    s_barrier
    s_mov_b32 s33, 0
    s_mov_b32 s34, 15
tt_ld_33:
    s_waitcnt vmcnt(8)
    s_barrier
    s_add_u32 s28, s32, s33
    s_mov_b32 m0, s28
    s_nop 0
    buffer_load_dwordx4 v1, s[8:11], s31 offen sc1 lds
    buffer_load_dwordx4 v1, s[8:11], s31 offen offset:1024 sc1 lds
    buffer_load_dwordx4 v1, s[8:11], s31 offen offset:2048 sc1 lds
    buffer_load_dwordx4 v1, s[8:11], s31 offen offset:3072 sc1 lds
    s_add_u32 m0, s28, 4096
    s_add_u32 s27, s31, 4096
    buffer_load_dwordx4 v1, s[8:11], s27 offen sc1 lds
    buffer_load_dwordx4 v1, s[8:11], s27 offen offset:1024 sc1 lds
    buffer_load_dwordx4 v1, s[8:11], s27 offen offset:2048 sc1 lds
    buffer_load_dwordx4 v1, s[8:11], s27 offen offset:3072 sc1 lds
    s_add_u32 s31, s31, 262144
    s_cmp_ge_u32 s31, s29
    s_cselect_b32 s27, 786432, 0
    s_sub_u32 s31, s31, s27
    s_add_u32 s35, s35, 1
    s_cmp_eq_u32 s35, 3
    s_cselect_b32 s27, 786432, 0
    s_cselect_b32 s35, 0, s35
    s_add_u32 s31, s31, s27
    s_add_u32 s29, s29, s27
    s_add_u32 s33, s33, 16384
    s_cmp_eq_u32 s33, 49152
    s_cselect_b32 s33, 0, s33
    s_sub_u32 s34, s34, 1
    s_cmp_lg_u32 s34, 0
    s_cbranch_scc1 tt_ld_33
    s_waitcnt vmcnt(8)
    s_barrier
    s_waitcnt vmcnt(0)
    s_barrier
    s_barrier
    s_branch tt_exit_27
role_wvo:
    s_mul_i32 s66, s67, 9
    s_add_u32 s66, s66, s68
    s_mul_i32 s74, s74, 6
    s_mul_i32 s24, s68, 884736
    s_add_u32 s24, s24, 4608
    s_lshl_b32 s25, s67, 8
    s_lshl_b32 s75, s68, 2
    s_lshl_b32 s76, s67, 3
    s_add_u32 s78, s66, 406
    s_mov_b32 s4, s46
    s_mov_b32 s5, s47
    s_mov_b32 s6, 7962624
    s_mov_b32 s7, 0x00020000
    s_mov_b32 s8, s48
    s_mov_b32 s9, s49
    s_mov_b32 s10, 2654208
    s_mov_b32 s11, 0x00020000
    s_add_u32 s12, s62, 7684096
    s_addc_u32 s13, s63, 0
    s_mov_b32 s14, 2654208
    s_mov_b32 s15, 0x00020000
    s_cmp_ge_u32 s3, 4
    s_cbranch_scc1 wvo_loader_34
    s_and_b32 s84, s3, 1
    s_lshr_b32 s83, s3, 1
    s_mul_i32 s27, s83, 8192
    s_add_u32 s27, s27, 0
    v_bfe_u32 v2, v0, 1, 3
    v_lshrrev_b32 v3, 4, v0
    v_xor_b32 v2, v2, v3
    v_lshlrev_b32 v2, 4, v2
    v_and_b32 v3, 15, v0
    v_lshl_add_u32 v4, v3, 7, v2
    v_add_u32 v4, s27, v4
    v_xor_b32 v5, 64, v4
    v_lshrrev_b32 v2, 4, v0
    v_lshlrev_b32 v2, 3, v2
    v_bfe_u32 v3, v0, 2, 2
    v_add_u32 v2, v2, v3
    v_lshlrev_b32 v2, 7, v2
    v_and_b32 v3, 3, v0
    v_lshl_add_u32 v2, v3, 3, v2
    v_bfe_u32 v3, v0, 3, 2
    v_lshl_add_u32 v2, v3, 5, v2
    s_mul_i32 s27, s84, 4
    s_add_u32 s27, s27, 0
    s_and_b32 s28, s27, 3
    s_lshl_b32 s28, s28, 5
    s_lshr_b32 s27, s27, 2
    s_lshl_b32 s27, s27, 13
    s_add_u32 s27, s27, 65536
    v_xor_b32 v6, s28, v2
    v_add_u32 v6, s27, v6
    s_mul_i32 s27, s84, 4
    s_add_u32 s27, s27, 1
    s_and_b32 s28, s27, 3
    s_lshl_b32 s28, s28, 5
    s_lshr_b32 s27, s27, 2
    s_lshl_b32 s27, s27, 13
    s_add_u32 s27, s27, 65536
    v_xor_b32 v7, s28, v2
    v_add_u32 v7, s27, v7
    s_mul_i32 s27, s84, 4
    s_add_u32 s27, s27, 2
    s_and_b32 s28, s27, 3
    s_lshl_b32 s28, s28, 5
    s_lshr_b32 s27, s27, 2
    s_lshl_b32 s27, s27, 13
    s_add_u32 s27, s27, 65536
    v_xor_b32 v8, s28, v2
    v_add_u32 v8, s27, v8
    s_mul_i32 s27, s84, 4
    s_add_u32 s27, s27, 3
    s_and_b32 s28, s27, 3
    s_lshl_b32 s28, s28, 5
    s_lshr_b32 s27, s27, 2
    s_lshl_b32 s27, s27, 13
    s_add_u32 s27, s27, 65536
    v_xor_b32 v9, s28, v2
    v_add_u32 v9, s27, v9
    v_mov_b32 v16, 0
    v_mov_b32 v17, 0
    v_mov_b32 v18, 0
    v_mov_b32 v19, 0
    v_mov_b32 v20, 0
    v_mov_b32 v21, 0
    v_mov_b32 v22, 0
    v_mov_b32 v23, 0
    v_mov_b32 v24, 0
    v_mov_b32 v25, 0
    v_mov_b32 v26, 0
    v_mov_b32 v27, 0
    v_mov_b32 v28, 0
    v_mov_b32 v29, 0
    v_mov_b32 v30, 0
    v_mov_b32 v31, 0
    v_mov_b32 v32, 0
    v_mov_b32 v33, 0
    v_mov_b32 v34, 0
    v_mov_b32 v35, 0
    v_mov_b32 v36, 0
    v_mov_b32 v37, 0
    v_mov_b32 v38, 0
    v_mov_b32 v39, 0
    v_mov_b32 v40, 0
    v_mov_b32 v41, 0
    v_mov_b32 v42, 0
    v_mov_b32 v43, 0
    v_mov_b32 v44, 0
    v_mov_b32 v45, 0
    v_mov_b32 v46, 0
    v_mov_b32 v47, 0
    v_mov_b32 v48, 0
    v_mov_b32 v49, 0
    v_mov_b32 v50, 0
    v_mov_b32 v51, 0
    v_mov_b32 v52, 0
    v_mov_b32 v53, 0
    v_mov_b32 v54, 0
    v_mov_b32 v55, 0
    v_mov_b32 v56, 0
    v_mov_b32 v57, 0
    v_mov_b32 v58, 0
    v_mov_b32 v59, 0
    v_mov_b32 v60, 0
    v_mov_b32 v61, 0
    v_mov_b32 v62, 0
    v_mov_b32 v63, 0
    v_mov_b32 v64, 0
    v_mov_b32 v65, 0
    v_mov_b32 v66, 0
    v_mov_b32 v67, 0
    v_mov_b32 v68, 0
    v_mov_b32 v69, 0
    v_mov_b32 v70, 0
    v_mov_b32 v71, 0
    v_mov_b32 v72, 0
    v_mov_b32 v73, 0
    v_mov_b32 v74, 0
    v_mov_b32 v75, 0
    v_mov_b32 v76, 0
    v_mov_b32 v77, 0
    v_mov_b32 v78, 0
    v_mov_b32 v79, 0
    s_mov_b32 s33, 0
    s_mov_b32 s31, 0
    s_mov_b32 s30, 16384
    s_mov_b32 s32, 16384
    s_mov_b32 s34, 17
    s_barrier
    ds_read_b64_tr_b16 v[96:97], v6 offset:0
    ds_read_b64_tr_b16 v[98:99], v6 offset:512
    ds_read_b64_tr_b16 v[100:101], v7 offset:0
    ds_read_b64_tr_b16 v[102:103], v7 offset:512
    ds_read_b64_tr_b16 v[104:105], v8 offset:0
    ds_read_b64_tr_b16 v[106:107], v8 offset:512
    ds_read_b64_tr_b16 v[108:109], v9 offset:0
    ds_read_b64_tr_b16 v[110:111], v9 offset:512
    ds_read_b128 v[80:83], v4 offset:0
    ds_read_b128 v[84:87], v4 offset:2048
    ds_read_b128 v[88:91], v4 offset:4096
    ds_read_b128 v[92:95], v4 offset:6144
    s_waitcnt lgkmcnt(0)
wvo_mm_36:
    v_mfma_f32_16x16x32_bf16 v[16:19], v[80:83], v[96:99], v[16:19]
    ds_read_b64_tr_b16 v[128:129], v6 offset:4096
    v_mfma_f32_16x16x32_bf16 v[20:23], v[80:83], v[100:103], v[20:23]
    ds_read_b64_tr_b16 v[130:131], v6 offset:4608
    v_mfma_f32_16x16x32_bf16 v[24:27], v[80:83], v[104:107], v[24:27]
    ds_read_b64_tr_b16 v[132:133], v7 offset:4096
    v_mfma_f32_16x16x32_bf16 v[28:31], v[80:83], v[108:111], v[28:31]
    ds_read_b64_tr_b16 v[134:135], v7 offset:4608
    v_mfma_f32_16x16x32_bf16 v[32:35], v[84:87], v[96:99], v[32:35]
    ds_read_b64_tr_b16 v[136:137], v8 offset:4096
    v_mfma_f32_16x16x32_bf16 v[36:39], v[84:87], v[100:103], v[36:39]
    ds_read_b64_tr_b16 v[138:139], v8 offset:4608
    v_mfma_f32_16x16x32_bf16 v[40:43], v[84:87], v[104:107], v[40:43]
    ds_read_b64_tr_b16 v[140:141], v9 offset:4096
    v_mfma_f32_16x16x32_bf16 v[44:47], v[84:87], v[108:111], v[44:47]
    ds_read_b64_tr_b16 v[142:143], v9 offset:4608
    v_mfma_f32_16x16x32_bf16 v[48:51], v[88:91], v[96:99], v[48:51]
    ds_read_b128 v[112:115], v5 offset:0
    v_mfma_f32_16x16x32_bf16 v[52:55], v[88:91], v[100:103], v[52:55]
    ds_read_b128 v[116:119], v5 offset:2048
    v_mfma_f32_16x16x32_bf16 v[56:59], v[88:91], v[104:107], v[56:59]
    ds_read_b128 v[120:123], v5 offset:4096
    v_mfma_f32_16x16x32_bf16 v[60:63], v[88:91], v[108:111], v[60:63]
    ds_read_b128 v[124:127], v5 offset:6144
    v_mfma_f32_16x16x32_bf16 v[64:67], v[92:95], v[96:99], v[64:67]
    s_add_u32 s33, s33, 1
    v_mfma_f32_16x16x32_bf16 v[68:71], v[92:95], v[100:103], v[68:71]
    s_cmp_eq_u32 s33, 4
    v_mfma_f32_16x16x32_bf16 v[72:75], v[92:95], v[104:107], v[72:75]
    s_cselect_b32 s35, 4294918144, s30
    v_mfma_f32_16x16x32_bf16 v[76:79], v[92:95], v[108:111], v[76:79]
    s_cselect_b32 s29, 4294918144, s32
    s_cselect_b32 s33, 0, s33
    v_add_u32 v4, s35, v4
    v_add_u32 v5, s35, v5
    v_add_u32 v6, s29, v6
    v_add_u32 v7, s29, v7
    v_add_u32 v8, s29, v8
    v_add_u32 v9, s29, v9
    s_waitcnt lgkmcnt(0)
    s_barrier
    v_mfma_f32_16x16x32_bf16 v[16:19], v[112:115], v[128:131], v[16:19]
    ds_read_b64_tr_b16 v[96:97], v6 offset:0
    v_mfma_f32_16x16x32_bf16 v[20:23], v[112:115], v[132:135], v[20:23]
    ds_read_b64_tr_b16 v[98:99], v6 offset:512
    v_mfma_f32_16x16x32_bf16 v[24:27], v[112:115], v[136:139], v[24:27]
    ds_read_b64_tr_b16 v[100:101], v7 offset:0
    v_mfma_f32_16x16x32_bf16 v[28:31], v[112:115], v[140:143], v[28:31]
    ds_read_b64_tr_b16 v[102:103], v7 offset:512
    v_mfma_f32_16x16x32_bf16 v[32:35], v[116:119], v[128:131], v[32:35]
    ds_read_b64_tr_b16 v[104:105], v8 offset:0
    v_mfma_f32_16x16x32_bf16 v[36:39], v[116:119], v[132:135], v[36:39]
    ds_read_b64_tr_b16 v[106:107], v8 offset:512
    v_mfma_f32_16x16x32_bf16 v[40:43], v[116:119], v[136:139], v[40:43]
    ds_read_b64_tr_b16 v[108:109], v9 offset:0
    v_mfma_f32_16x16x32_bf16 v[44:47], v[116:119], v[140:143], v[44:47]
    ds_read_b64_tr_b16 v[110:111], v9 offset:512
    v_mfma_f32_16x16x32_bf16 v[48:51], v[120:123], v[128:131], v[48:51]
    ds_read_b128 v[80:83], v4 offset:0
    v_mfma_f32_16x16x32_bf16 v[52:55], v[120:123], v[132:135], v[52:55]
    ds_read_b128 v[84:87], v4 offset:2048
    v_mfma_f32_16x16x32_bf16 v[56:59], v[120:123], v[136:139], v[56:59]
    ds_read_b128 v[88:91], v4 offset:4096
    v_mfma_f32_16x16x32_bf16 v[60:63], v[120:123], v[140:143], v[60:63]
    ds_read_b128 v[92:95], v4 offset:6144
    v_mfma_f32_16x16x32_bf16 v[64:67], v[124:127], v[128:131], v[64:67]
    s_sub_u32 s34, s34, 1
    v_mfma_f32_16x16x32_bf16 v[68:71], v[124:127], v[132:135], v[68:71]
    s_cmp_lg_u32 s34, 0
    v_mfma_f32_16x16x32_bf16 v[72:75], v[124:127], v[136:139], v[72:75]
    v_mfma_f32_16x16x32_bf16 v[76:79], v[124:127], v[140:143], v[76:79]
    s_waitcnt lgkmcnt(0)
    s_cbranch_scc1 wvo_mm_36
    v_mfma_f32_16x16x32_bf16 v[16:19], v[80:83], v[96:99], v[16:19]
    ds_read_b64_tr_b16 v[128:129], v6 offset:4096
    v_mfma_f32_16x16x32_bf16 v[20:23], v[80:83], v[100:103], v[20:23]
    ds_read_b64_tr_b16 v[130:131], v6 offset:4608
    v_mfma_f32_16x16x32_bf16 v[24:27], v[80:83], v[104:107], v[24:27]
    ds_read_b64_tr_b16 v[132:133], v7 offset:4096
    v_mfma_f32_16x16x32_bf16 v[28:31], v[80:83], v[108:111], v[28:31]
    ds_read_b64_tr_b16 v[134:135], v7 offset:4608
    v_mfma_f32_16x16x32_bf16 v[32:35], v[84:87], v[96:99], v[32:35]
    ds_read_b64_tr_b16 v[136:137], v8 offset:4096
    v_mfma_f32_16x16x32_bf16 v[36:39], v[84:87], v[100:103], v[36:39]
    ds_read_b64_tr_b16 v[138:139], v8 offset:4608
    v_mfma_f32_16x16x32_bf16 v[40:43], v[84:87], v[104:107], v[40:43]
    ds_read_b64_tr_b16 v[140:141], v9 offset:4096
    v_mfma_f32_16x16x32_bf16 v[44:47], v[84:87], v[108:111], v[44:47]
    ds_read_b64_tr_b16 v[142:143], v9 offset:4608
    v_mfma_f32_16x16x32_bf16 v[48:51], v[88:91], v[96:99], v[48:51]
    ds_read_b128 v[112:115], v5 offset:0
    v_mfma_f32_16x16x32_bf16 v[52:55], v[88:91], v[100:103], v[52:55]
    ds_read_b128 v[116:119], v5 offset:2048
    v_mfma_f32_16x16x32_bf16 v[56:59], v[88:91], v[104:107], v[56:59]
    ds_read_b128 v[120:123], v5 offset:4096
    v_mfma_f32_16x16x32_bf16 v[60:63], v[88:91], v[108:111], v[60:63]
    ds_read_b128 v[124:127], v5 offset:6144
    v_mfma_f32_16x16x32_bf16 v[64:67], v[92:95], v[96:99], v[64:67]
    v_mfma_f32_16x16x32_bf16 v[68:71], v[92:95], v[100:103], v[68:71]
    v_mfma_f32_16x16x32_bf16 v[72:75], v[92:95], v[104:107], v[72:75]
    v_mfma_f32_16x16x32_bf16 v[76:79], v[92:95], v[108:111], v[76:79]
    s_waitcnt lgkmcnt(0)
    v_mfma_f32_16x16x32_bf16 v[16:19], v[112:115], v[128:131], v[16:19]
    v_mfma_f32_16x16x32_bf16 v[20:23], v[112:115], v[132:135], v[20:23]
    v_mfma_f32_16x16x32_bf16 v[24:27], v[112:115], v[136:139], v[24:27]
    v_mfma_f32_16x16x32_bf16 v[28:31], v[112:115], v[140:143], v[28:31]
    v_mfma_f32_16x16x32_bf16 v[32:35], v[116:119], v[128:131], v[32:35]
    v_mfma_f32_16x16x32_bf16 v[36:39], v[116:119], v[132:135], v[36:39]
    v_mfma_f32_16x16x32_bf16 v[40:43], v[116:119], v[136:139], v[40:43]
    v_mfma_f32_16x16x32_bf16 v[44:47], v[116:119], v[140:143], v[44:47]
    v_mfma_f32_16x16x32_bf16 v[48:51], v[120:123], v[128:131], v[48:51]
    v_mfma_f32_16x16x32_bf16 v[52:55], v[120:123], v[132:135], v[52:55]
    v_mfma_f32_16x16x32_bf16 v[56:59], v[120:123], v[136:139], v[56:59]
    v_mfma_f32_16x16x32_bf16 v[60:63], v[120:123], v[140:143], v[60:63]
    v_mfma_f32_16x16x32_bf16 v[64:67], v[124:127], v[128:131], v[64:67]
    v_mfma_f32_16x16x32_bf16 v[68:71], v[124:127], v[132:135], v[68:71]
    v_mfma_f32_16x16x32_bf16 v[72:75], v[124:127], v[136:139], v[72:75]
    v_mfma_f32_16x16x32_bf16 v[76:79], v[124:127], v[140:143], v[76:79]
    s_mul_i32 s27, s83, 2
    s_add_u32 s27, s27, s75
    s_mul_i32 s27, s27, 72
    s_mul_i32 s28, s84, 4
    s_add_u32 s27, s27, s28
    s_add_u32 s27, s27, s76
    s_lshl_b32 s26, s27, 10
    v_bfe_u32 v2, v0, 2, 1
    v_lshlrev_b32 v1, 10, v2
    v_bfe_u32 v2, v0, 3, 1
    v_lshl_add_u32 v1, v2, 6, v1
    v_and_b32 v2, 0x33, v0
    v_lshl_add_u32 v1, v2, 4, v1
    s_nop 1
    v_cvt_pk_bf16_f32 v80, v16, v17
    v_cvt_pk_bf16_f32 v81, v18, v19
    v_cvt_pk_bf16_f32 v82, v32, v33
    v_cvt_pk_bf16_f32 v83, v34, v35
    s_add_u32 s27, s26, 0
    buffer_store_dwordx4 v[80:83], v1, s[12:15], s27 offen offset:0 sc1
    v_cvt_pk_bf16_f32 v84, v20, v21
    v_cvt_pk_bf16_f32 v85, v22, v23
    v_cvt_pk_bf16_f32 v86, v36, v37
    v_cvt_pk_bf16_f32 v87, v38, v39
    s_add_u32 s27, s26, 0
    buffer_store_dwordx4 v[84:87], v1, s[12:15], s27 offen offset:128 sc1
    v_cvt_pk_bf16_f32 v88, v24, v25
    v_cvt_pk_bf16_f32 v89, v26, v27
    v_cvt_pk_bf16_f32 v90, v40, v41
    v_cvt_pk_bf16_f32 v91, v42, v43
    s_add_u32 s27, s26, 0
    buffer_store_dwordx4 v[88:91], v1, s[12:15], s27 offen offset:2048 sc1
    v_cvt_pk_bf16_f32 v92, v28, v29
    v_cvt_pk_bf16_f32 v93, v30, v31
    v_cvt_pk_bf16_f32 v94, v44, v45
    v_cvt_pk_bf16_f32 v95, v46, v47
    s_add_u32 s27, s26, 0
    buffer_store_dwordx4 v[92:95], v1, s[12:15], s27 offen offset:2176 sc1
    v_cvt_pk_bf16_f32 v96, v48, v49
    v_cvt_pk_bf16_f32 v97, v50, v51
    v_cvt_pk_bf16_f32 v98, v64, v65
    v_cvt_pk_bf16_f32 v99, v66, v67
    s_add_u32 s27, s26, 73728
    buffer_store_dwordx4 v[96:99], v1, s[12:15], s27 offen offset:0 sc1
    v_cvt_pk_bf16_f32 v100, v52, v53
    v_cvt_pk_bf16_f32 v101, v54, v55
    v_cvt_pk_bf16_f32 v102, v68, v69
    v_cvt_pk_bf16_f32 v103, v70, v71
    s_add_u32 s27, s26, 73728
    buffer_store_dwordx4 v[100:103], v1, s[12:15], s27 offen offset:128 sc1
    v_cvt_pk_bf16_f32 v104, v56, v57
    v_cvt_pk_bf16_f32 v105, v58, v59
    v_cvt_pk_bf16_f32 v106, v72, v73
    v_cvt_pk_bf16_f32 v107, v74, v75
    s_add_u32 s27, s26, 73728
    buffer_store_dwordx4 v[104:107], v1, s[12:15], s27 offen offset:2048 sc1
    v_cvt_pk_bf16_f32 v108, v60, v61
    v_cvt_pk_bf16_f32 v109, v62, v63
    v_cvt_pk_bf16_f32 v110, v76, v77
    v_cvt_pk_bf16_f32 v111, v78, v79
    s_add_u32 s27, s26, 73728
    buffer_store_dwordx4 v[108:111], v1, s[12:15], s27 offen offset:2176 sc1
    s_mov_b64 exec, -1
    s_lshl_b32 s27, s78, 7
    v_mov_b32 v8, 0
    v_mov_b32 v9, 1
    s_cmp_lg_u32 s3, 0
    s_waitcnt vmcnt(0)
    s_barrier
    s_cbranch_scc1 sig_37
    s_mov_b64 exec, 1
    buffer_store_dword v9, v8, s[36:39], s27 offen sc1
    s_mov_b64 exec, -1
sig_37:
wvo_exit_38:
    s_lshl_b32 s79, s66, 2
    s_and_b32 s28, s3, 3
    s_add_u32 s79, s79, s28
    s_cmp_ge_u32 s3, 4
    s_cselect_b32 s20, s50, s54
    s_cselect_b32 s21, s51, s55
    s_mov_b32 s22, 2654208
    s_mov_b32 s23, 0x00020000
    v_lshlrev_b32 v8, 7, v0
    s_lshl_b32 s27, s79, 13
    buffer_load_dword v14, v8, s[20:23], s27 offen
    s_mov_b64 exec, -1
    s_branch next_task
wvo_loader_34:
    s_and_b32 s82, s3, 1
    s_cmp_ge_u32 s3, 6
    s_cbranch_scc1 wvo_loaderB_35
    s_lshl_b32 s27, s82, 2
    v_lshrrev_b32 v2, 4, v0
    v_add_u32 v2, s27, v2
    v_and_b32 v1, 7, v0
    v_xor_b32 v1, v1, v2
    v_lshlrev_b32 v1, 4, v1
    s_lshl_b32 s27, s82, 4
    v_lshrrev_b32 v2, 5, v0
    v_lshlrev_b32 v2, 3, v2
    v_add_u32 v2, s27, v2
    v_bfe_u32 v3, v0, 3, 2
    v_add_u32 v2, v2, v3
    s_mov_b32 s27, 6912
    v_mad_u32_u24 v1, v2, s27, v1
    s_mov_b32 s31, s24
    s_lshl_b32 s32, s82, 10
    s_add_u32 s32, s32, 0
    s_add_u32 s29, s31, 2304
    s_mov_b32 s35, 0
    s_mul_i32 s27, s74, 128
    s_add_u32 s31, s31, s27
    s_mov_b32 m0, s32
    s_nop 0
    buffer_load_dwordx4 v1, s[4:7], s31 offen lds
    s_add_u32 m0, s32, 2048
    s_add_u32 s27, s31, 27648
    buffer_load_dwordx4 v1, s[4:7], s27 offen lds
    s_add_u32 m0, s32, 4096
    s_add_u32 s27, s31, 221184
    buffer_load_dwordx4 v1, s[4:7], s27 offen lds
    s_add_u32 m0, s32, 6144
    s_add_u32 s27, s31, 248832
    buffer_load_dwordx4 v1, s[4:7], s27 offen lds
    s_add_u32 m0, s32, 8192
    s_add_u32 s27, s31, 442368
    buffer_load_dwordx4 v1, s[4:7], s27 offen lds
    s_add_u32 m0, s32, 10240
    s_add_u32 s27, s31, 470016
    buffer_load_dwordx4 v1, s[4:7], s27 offen lds
    s_add_u32 m0, s32, 12288
    s_add_u32 s27, s31, 663552
    buffer_load_dwordx4 v1, s[4:7], s27 offen lds
    s_add_u32 m0, s32, 14336
    s_add_u32 s27, s31, 691200
    buffer_load_dwordx4 v1, s[4:7], s27 offen lds
    s_add_u32 s31, s31, 128
    s_cmp_ge_u32 s31, s29
    s_cselect_b32 s27, 2304, 0
    s_sub_u32 s31, s31, s27
    s_add_u32 m0, s32, 16384
    s_nop 0
    buffer_load_dwordx4 v1, s[4:7], s31 offen lds
    s_add_u32 m0, s32, 18432
    s_add_u32 s27, s31, 27648
    buffer_load_dwordx4 v1, s[4:7], s27 offen lds
    s_add_u32 m0, s32, 20480
    s_add_u32 s27, s31, 221184
    buffer_load_dwordx4 v1, s[4:7], s27 offen lds
    s_add_u32 m0, s32, 22528
    s_add_u32 s27, s31, 248832
    buffer_load_dwordx4 v1, s[4:7], s27 offen lds
    s_add_u32 m0, s32, 24576
    s_add_u32 s27, s31, 442368
    buffer_load_dwordx4 v1, s[4:7], s27 offen lds
    s_add_u32 m0, s32, 26624
    s_add_u32 s27, s31, 470016
    buffer_load_dwordx4 v1, s[4:7], s27 offen lds
    s_add_u32 m0, s32, 28672
    s_add_u32 s27, s31, 663552
    buffer_load_dwordx4 v1, s[4:7], s27 offen lds
    s_add_u32 m0, s32, 30720
    s_add_u32 s27, s31, 691200
    buffer_load_dwordx4 v1, s[4:7], s27 offen lds
    s_add_u32 s31, s31, 128
    s_cmp_ge_u32 s31, s29
    s_cselect_b32 s27, 2304, 0
    s_sub_u32 s31, s31, s27
    s_add_u32 m0, s32, 32768
    s_nop 0
    buffer_load_dwordx4 v1, s[4:7], s31 offen lds
    s_add_u32 m0, s32, 34816
    s_add_u32 s27, s31, 27648
    buffer_load_dwordx4 v1, s[4:7], s27 offen lds
    s_add_u32 m0, s32, 36864
    s_add_u32 s27, s31, 221184
    buffer_load_dwordx4 v1, s[4:7], s27 offen lds
    s_add_u32 m0, s32, 38912
    s_add_u32 s27, s31, 248832
    buffer_load_dwordx4 v1, s[4:7], s27 offen lds
    s_add_u32 m0, s32, 40960
    s_add_u32 s27, s31, 442368
    buffer_load_dwordx4 v1, s[4:7], s27 offen lds
    s_add_u32 m0, s32, 43008
    s_add_u32 s27, s31, 470016
    buffer_load_dwordx4 v1, s[4:7], s27 offen lds
    s_add_u32 m0, s32, 45056
    s_add_u32 s27, s31, 663552
    buffer_load_dwordx4 v1, s[4:7], s27 offen lds
    s_add_u32 m0, s32, 47104
    s_add_u32 s27, s31, 691200
    buffer_load_dwordx4 v1, s[4:7], s27 offen lds
    s_add_u32 s31, s31, 128
    s_cmp_ge_u32 s31, s29
    s_cselect_b32 s27, 2304, 0
    s_sub_u32 s31, s31, s27
    s_waitcnt vmcnt(16)
    s_barrier
    s_add_u32 m0, s32, 49152
    s_nop 0
    buffer_load_dwordx4 v1, s[4:7], s31 offen lds
    s_add_u32 m0, s32, 51200
    s_add_u32 s27, s31, 27648
    buffer_load_dwordx4 v1, s[4:7], s27 offen lds
    s_add_u32 m0, s32, 53248
    s_add_u32 s27, s31, 221184
    buffer_load_dwordx4 v1, s[4:7], s27 offen lds
    s_add_u32 m0, s32, 55296
    s_add_u32 s27, s31, 248832
    buffer_load_dwordx4 v1, s[4:7], s27 offen lds
    s_add_u32 m0, s32, 57344
    s_add_u32 s27, s31, 442368
    buffer_load_dwordx4 v1, s[4:7], s27 offen lds
    s_add_u32 m0, s32, 59392
    s_add_u32 s27, s31, 470016
    buffer_load_dwordx4 v1, s[4:7], s27 offen lds
    s_add_u32 m0, s32, 61440
    s_add_u32 s27, s31, 663552
    buffer_load_dwordx4 v1, s[4:7], s27 offen lds
    s_add_u32 m0, s32, 63488
    s_add_u32 s27, s31, 691200
    buffer_load_dwordx4 v1, s[4:7], s27 offen lds
    s_add_u32 s31, s31, 128
    s_cmp_ge_u32 s31, s29
    s_cselect_b32 s27, 2304, 0
    s_sub_u32 s31, s31, s27
    s_mov_b32 s33, 0
    s_mov_b32 s34, 14
wvo_ld_39:
    s_waitcnt vmcnt(16)
    s_barrier
    s_add_u32 s28, s32, s33
    s_mov_b32 m0, s28
    s_nop 0
    buffer_load_dwordx4 v1, s[4:7], s31 offen lds
    s_add_u32 m0, s28, 2048
    s_add_u32 s27, s31, 27648
    buffer_load_dwordx4 v1, s[4:7], s27 offen lds
    s_add_u32 m0, s28, 4096
    s_add_u32 s27, s31, 221184
    buffer_load_dwordx4 v1, s[4:7], s27 offen lds
    s_add_u32 m0, s28, 6144
    s_add_u32 s27, s31, 248832
    buffer_load_dwordx4 v1, s[4:7], s27 offen lds
    s_add_u32 m0, s28, 8192
    s_add_u32 s27, s31, 442368
    buffer_load_dwordx4 v1, s[4:7], s27 offen lds
    s_add_u32 m0, s28, 10240
    s_add_u32 s27, s31, 470016
    buffer_load_dwordx4 v1, s[4:7], s27 offen lds
    s_add_u32 m0, s28, 12288
    s_add_u32 s27, s31, 663552
    buffer_load_dwordx4 v1, s[4:7], s27 offen lds
    s_add_u32 m0, s28, 14336
    s_add_u32 s27, s31, 691200
    buffer_load_dwordx4 v1, s[4:7], s27 offen lds
    s_add_u32 s31, s31, 128
    s_cmp_ge_u32 s31, s29
    s_cselect_b32 s27, 2304, 0
    s_sub_u32 s31, s31, s27
    s_add_u32 s33, s33, 16384
    s_cmp_eq_u32 s33, 65536
    s_cselect_b32 s33, 0, s33
    s_sub_u32 s34, s34, 1
    s_cmp_lg_u32 s34, 0
    s_cbranch_scc1 wvo_ld_39
    s_waitcnt vmcnt(16)
    s_barrier
    s_waitcnt vmcnt(8)
    s_barrier
    s_waitcnt vmcnt(0)
    s_barrier
    v_min_u32 v8, 11, v0
    v_and_b32 v9, 1, v8
    v_lshlrev_b32 v9, 7, v9
    v_lshl_add_u32 v8, v8, 2, v9
    s_mov_b32 s34, 131072
wi_40:
    global_load_dword v9, v8, s[60:61] sc1
    s_sub_u32 s34, s34, 1
    s_waitcnt vmcnt(0)
    v_cmp_ne_u32 vcc, 1, v9
    s_cmp_eq_u32 s34, 0
    s_cbranch_scc1 wid_41
    s_cmp_eq_u64 vcc, 0
    s_cbranch_scc1 wid_41
    s_sleep 3
    s_branch wi_40
wid_41:
    s_barrier
    s_branch wvo_exit_38
wvo_loaderB_35:
    s_lshl_b32 s27, s82, 2
    v_bfe_u32 v2, v0, 4, 1
    v_lshlrev_b32 v2, 1, v2
    v_or_b32 v2, s27, v2
    v_and_b32 v1, 7, v0
    v_xor_b32 v1, v1, v2
    v_lshlrev_b32 v1, 4, v1
    s_lshl_b32 s27, s82, 3
    v_lshrrev_b32 v2, 3, v0
    v_add_u32 v2, s27, v2
    s_mov_b32 s27, 2304
    v_mad_u32_u24 v1, v2, s27, v1
    s_mov_b32 s31, s25
    s_lshl_b32 s32, s82, 10
    s_add_u32 s32, s32, 65536
    s_add_u32 s29, s31, 2654208
    s_mov_b32 s35, 0
    s_mul_i32 s27, s74, 147456
    s_add_u32 s31, s31, s27
    s_mov_b32 m0, s32
    s_nop 0
    buffer_load_dwordx4 v1, s[8:11], s31 offen lds
    s_add_u32 m0, s32, 2048
    s_add_u32 s27, s31, 36864
    buffer_load_dwordx4 v1, s[8:11], s27 offen lds
    s_add_u32 m0, s32, 4096
    s_add_u32 s27, s31, 73728
    buffer_load_dwordx4 v1, s[8:11], s27 offen lds
    s_add_u32 m0, s32, 6144
    s_add_u32 s27, s31, 110592
    buffer_load_dwordx4 v1, s[8:11], s27 offen lds
    s_add_u32 m0, s32, 8192
    s_add_u32 s27, s31, 128
    buffer_load_dwordx4 v1, s[8:11], s27 offen lds
    s_add_u32 m0, s32, 10240
    s_add_u32 s27, s31, 36992
    buffer_load_dwordx4 v1, s[8:11], s27 offen lds
    s_add_u32 m0, s32, 12288
    s_add_u32 s27, s31, 73856
    buffer_load_dwordx4 v1, s[8:11], s27 offen lds
    s_add_u32 m0, s32, 14336
    s_add_u32 s27, s31, 110720
    buffer_load_dwordx4 v1, s[8:11], s27 offen lds
    s_add_u32 s31, s31, 147456
    s_cmp_ge_u32 s31, s29
    s_cselect_b32 s27, 2654208, 0
    s_sub_u32 s31, s31, s27
    s_add_u32 m0, s32, 16384
    s_nop 0
    buffer_load_dwordx4 v1, s[8:11], s31 offen lds
    s_add_u32 m0, s32, 18432
    s_add_u32 s27, s31, 36864
    buffer_load_dwordx4 v1, s[8:11], s27 offen lds
    s_add_u32 m0, s32, 20480
    s_add_u32 s27, s31, 73728
    buffer_load_dwordx4 v1, s[8:11], s27 offen lds
    s_add_u32 m0, s32, 22528
    s_add_u32 s27, s31, 110592
    buffer_load_dwordx4 v1, s[8:11], s27 offen lds
    s_add_u32 m0, s32, 24576
    s_add_u32 s27, s31, 128
    buffer_load_dwordx4 v1, s[8:11], s27 offen lds
    s_add_u32 m0, s32, 26624
    s_add_u32 s27, s31, 36992
    buffer_load_dwordx4 v1, s[8:11], s27 offen lds
    s_add_u32 m0, s32, 28672
    s_add_u32 s27, s31, 73856
    buffer_load_dwordx4 v1, s[8:11], s27 offen lds
    s_add_u32 m0, s32, 30720
    s_add_u32 s27, s31, 110720
    buffer_load_dwordx4 v1, s[8:11], s27 offen lds
    s_add_u32 s31, s31, 147456
    s_cmp_ge_u32 s31, s29
    s_cselect_b32 s27, 2654208, 0
    s_sub_u32 s31, s31, s27
    s_add_u32 m0, s32, 32768
    s_nop 0
    buffer_load_dwordx4 v1, s[8:11], s31 offen lds
    s_add_u32 m0, s32, 34816
    s_add_u32 s27, s31, 36864
    buffer_load_dwordx4 v1, s[8:11], s27 offen lds
    s_add_u32 m0, s32, 36864
    s_add_u32 s27, s31, 73728
    buffer_load_dwordx4 v1, s[8:11], s27 offen lds
    s_add_u32 m0, s32, 38912
    s_add_u32 s27, s31, 110592
    buffer_load_dwordx4 v1, s[8:11], s27 offen lds
    s_add_u32 m0, s32, 40960
    s_add_u32 s27, s31, 128
    buffer_load_dwordx4 v1, s[8:11], s27 offen lds
    s_add_u32 m0, s32, 43008
    s_add_u32 s27, s31, 36992
    buffer_load_dwordx4 v1, s[8:11], s27 offen lds
    s_add_u32 m0, s32, 45056
    s_add_u32 s27, s31, 73856
    buffer_load_dwordx4 v1, s[8:11], s27 offen lds
    s_add_u32 m0, s32, 47104
    s_add_u32 s27, s31, 110720
    buffer_load_dwordx4 v1, s[8:11], s27 offen lds
    s_add_u32 s31, s31, 147456
    s_cmp_ge_u32 s31, s29
    s_cselect_b32 s27, 2654208, 0
    s_sub_u32 s31, s31, s27
    s_waitcnt vmcnt(16)
    s_barrier
    s_add_u32 m0, s32, 49152
    s_nop 0
    buffer_load_dwordx4 v1, s[8:11], s31 offen lds
    s_add_u32 m0, s32, 51200
    s_add_u32 s27, s31, 36864
    buffer_load_dwordx4 v1, s[8:11], s27 offen lds
    s_add_u32 m0, s32, 53248
    s_add_u32 s27, s31, 73728
    buffer_load_dwordx4 v1, s[8:11], s27 offen lds
    s_add_u32 m0, s32, 55296
    s_add_u32 s27, s31, 110592
    buffer_load_dwordx4 v1, s[8:11], s27 offen lds
    s_add_u32 m0, s32, 57344
    s_add_u32 s27, s31, 128
    buffer_load_dwordx4 v1, s[8:11], s27 offen lds
    s_add_u32 m0, s32, 59392
    s_add_u32 s27, s31, 36992
    buffer_load_dwordx4 v1, s[8:11], s27 offen lds
    s_add_u32 m0, s32, 61440
    s_add_u32 s27, s31, 73856
    buffer_load_dwordx4 v1, s[8:11], s27 offen lds
    s_add_u32 m0, s32, 63488
    s_add_u32 s27, s31, 110720
    buffer_load_dwordx4 v1, s[8:11], s27 offen lds
    s_add_u32 s31, s31, 147456
    s_cmp_ge_u32 s31, s29
    s_cselect_b32 s27, 2654208, 0
    s_sub_u32 s31, s31, s27
    s_mov_b32 s33, 0
    s_mov_b32 s34, 14
wvo_ld_42:
    s_waitcnt vmcnt(16)
    s_barrier
    s_add_u32 s28, s32, s33
    s_mov_b32 m0, s28
    s_nop 0
    buffer_load_dwordx4 v1, s[8:11], s31 offen lds
    s_add_u32 m0, s28, 2048
    s_add_u32 s27, s31, 36864
    buffer_load_dwordx4 v1, s[8:11], s27 offen lds
    s_add_u32 m0, s28, 4096
    s_add_u32 s27, s31, 73728
    buffer_load_dwordx4 v1, s[8:11], s27 offen lds
    s_add_u32 m0, s28, 6144
    s_add_u32 s27, s31, 110592
    buffer_load_dwordx4 v1, s[8:11], s27 offen lds
    s_add_u32 m0, s28, 8192
    s_add_u32 s27, s31, 128
    buffer_load_dwordx4 v1, s[8:11], s27 offen lds
    s_add_u32 m0, s28, 10240
    s_add_u32 s27, s31, 36992
    buffer_load_dwordx4 v1, s[8:11], s27 offen lds
    s_add_u32 m0, s28, 12288
    s_add_u32 s27, s31, 73856
    buffer_load_dwordx4 v1, s[8:11], s27 offen lds
    s_add_u32 m0, s28, 14336
    s_add_u32 s27, s31, 110720
    buffer_load_dwordx4 v1, s[8:11], s27 offen lds
    s_add_u32 s31, s31, 147456
    s_cmp_ge_u32 s31, s29
    s_cselect_b32 s27, 2654208, 0
    s_sub_u32 s31, s31, s27
    s_add_u32 s33, s33, 16384
    s_cmp_eq_u32 s33, 65536
    s_cselect_b32 s33, 0, s33
    s_sub_u32 s34, s34, 1
    s_cmp_lg_u32 s34, 0
    s_cbranch_scc1 wvo_ld_42
    s_waitcnt vmcnt(16)
    s_barrier
    s_waitcnt vmcnt(8)
    s_barrier
    s_waitcnt vmcnt(0)
    s_barrier
    s_barrier
    s_branch wvo_exit_38
role_kvc:
    s_mul_i32 s24, s68, 384
    s_mul_i32 s25, s67, 177408
    s_mul_i32 s78, s67, 12
    s_add_u32 s78, s78, s68
    s_add_u32 s78, s78, 487
    s_mov_b32 s4, s52
    s_mov_b32 s5, s53
    s_mov_b32 s6, 5308416
    s_mov_b32 s7, 0x00020000
    s_mov_b32 s8, s44
    s_mov_b32 s9, s45
    s_mov_b32 s10, 354816
    s_mov_b32 s11, 0x00020000
    s_add_u32 s12, s62, 23969792
    s_addc_u32 s13, s63, 0
    s_mov_b32 s14, 737280
    s_mov_b32 s15, 0x00020000
    s_cmp_ge_u32 s3, 4
    s_cbranch_scc1 kvc_loader_43
    s_and_b32 s84, s3, 0
    s_lshr_b32 s83, s3, 0
    v_lshrrev_b32 v2, 4, v0
    v_lshlrev_b32 v2, 3, v2
    v_bfe_u32 v3, v0, 2, 2
    v_add_u32 v2, v2, v3
    v_lshlrev_b32 v2, 7, v2
    v_and_b32 v3, 3, v0
    v_lshl_add_u32 v2, v3, 3, v2
    v_bfe_u32 v3, v0, 3, 2
    v_lshl_add_u32 v2, v3, 5, v2
    s_mul_i32 s27, s83, 3
    s_add_u32 s27, s27, 0
    s_and_b32 s28, s27, 3
    s_lshl_b32 s28, s28, 5
    s_lshr_b32 s27, s27, 2
    s_lshl_b32 s27, s27, 13
    s_add_u32 s27, s27, 0
    v_xor_b32 v4, s28, v2
    v_add_u32 v4, s27, v4
    s_mul_i32 s27, s83, 3
    s_add_u32 s27, s27, 1
    s_and_b32 s28, s27, 3
    s_lshl_b32 s28, s28, 5
    s_lshr_b32 s27, s27, 2
    s_lshl_b32 s27, s27, 13
    s_add_u32 s27, s27, 0
    v_xor_b32 v5, s28, v2
    v_add_u32 v5, s27, v5
    s_mul_i32 s27, s83, 3
    s_add_u32 s27, s27, 2
    s_and_b32 s28, s27, 3
    s_lshl_b32 s28, s28, 5
    s_lshr_b32 s27, s27, 2
    s_lshl_b32 s27, s27, 13
    s_add_u32 s27, s27, 0
    v_xor_b32 v6, s28, v2
    v_add_u32 v6, s27, v6
    s_mul_i32 s27, s84, 10240
    s_add_u32 s27, s27, 98304
    v_bfe_u32 v2, v0, 1, 3
    v_lshrrev_b32 v3, 4, v0
    v_xor_b32 v2, v2, v3
    v_lshlrev_b32 v2, 4, v2
    v_and_b32 v3, 15, v0
    v_lshl_add_u32 v7, v3, 7, v2
    v_add_u32 v7, s27, v7
    v_xor_b32 v8, 64, v7
    v_mov_b32 v16, 0
    v_mov_b32 v17, 0
    v_mov_b32 v18, 0
    v_mov_b32 v19, 0
    v_mov_b32 v20, 0
    v_mov_b32 v21, 0
    v_mov_b32 v22, 0
    v_mov_b32 v23, 0
    v_mov_b32 v24, 0
    v_mov_b32 v25, 0
    v_mov_b32 v26, 0
    v_mov_b32 v27, 0
    v_mov_b32 v28, 0
    v_mov_b32 v29, 0
    v_mov_b32 v30, 0
    v_mov_b32 v31, 0
    v_mov_b32 v32, 0
    v_mov_b32 v33, 0
    v_mov_b32 v34, 0
    v_mov_b32 v35, 0
    v_mov_b32 v36, 0
    v_mov_b32 v37, 0
    v_mov_b32 v38, 0
    v_mov_b32 v39, 0
    v_mov_b32 v40, 0
    v_mov_b32 v41, 0
    v_mov_b32 v42, 0
    v_mov_b32 v43, 0
    v_mov_b32 v44, 0
    v_mov_b32 v45, 0
    v_mov_b32 v46, 0
    v_mov_b32 v47, 0
    v_mov_b32 v48, 0
    v_mov_b32 v49, 0
    v_mov_b32 v50, 0
    v_mov_b32 v51, 0
    v_mov_b32 v52, 0
    v_mov_b32 v53, 0
    v_mov_b32 v54, 0
    v_mov_b32 v55, 0
    v_mov_b32 v56, 0
    v_mov_b32 v57, 0
    v_mov_b32 v58, 0
    v_mov_b32 v59, 0
    v_mov_b32 v60, 0
    v_mov_b32 v61, 0
    v_mov_b32 v62, 0
    v_mov_b32 v63, 0
    v_mov_b32 v64, 0
    v_mov_b32 v65, 0
    v_mov_b32 v66, 0
    v_mov_b32 v67, 0
    v_mov_b32 v68, 0
    v_mov_b32 v69, 0
    v_mov_b32 v70, 0
    v_mov_b32 v71, 0
    v_mov_b32 v72, 0
    v_mov_b32 v73, 0
    v_mov_b32 v74, 0
    v_mov_b32 v75, 0
    s_mov_b32 s33, 0
    s_mov_b32 s31, 0
    s_mov_b32 s30, 24576
    s_mov_b32 s32, 10240
    s_mov_b32 s34, 17
    s_barrier
    ds_read_b64_tr_b16 v[76:77], v4 offset:0
    ds_read_b64_tr_b16 v[78:79], v4 offset:512
    ds_read_b64_tr_b16 v[80:81], v5 offset:0
    ds_read_b64_tr_b16 v[82:83], v5 offset:512
    ds_read_b64_tr_b16 v[84:85], v6 offset:0
    ds_read_b64_tr_b16 v[86:87], v6 offset:512
    ds_read_b128 v[88:91], v7 offset:0
    ds_read_b128 v[92:95], v7 offset:2048
    ds_read_b128 v[96:99], v7 offset:4096
    ds_read_b128 v[100:103], v7 offset:6144
    ds_read_b128 v[104:107], v7 offset:8192
    s_waitcnt lgkmcnt(0)
kvc_mm_45:
    v_mfma_f32_16x16x32_bf16 v[16:19], v[76:79], v[88:91], v[16:19]
    ds_read_b64_tr_b16 v[108:109], v4 offset:4096
    v_mfma_f32_16x16x32_bf16 v[20:23], v[76:79], v[92:95], v[20:23]
    ds_read_b64_tr_b16 v[110:111], v4 offset:4608
    v_mfma_f32_16x16x32_bf16 v[24:27], v[76:79], v[96:99], v[24:27]
    ds_read_b64_tr_b16 v[112:113], v5 offset:4096
    v_mfma_f32_16x16x32_bf16 v[28:31], v[76:79], v[100:103], v[28:31]
    ds_read_b64_tr_b16 v[114:115], v5 offset:4608
    v_mfma_f32_16x16x32_bf16 v[32:35], v[76:79], v[104:107], v[32:35]
    ds_read_b64_tr_b16 v[116:117], v6 offset:4096
    v_mfma_f32_16x16x32_bf16 v[36:39], v[80:83], v[88:91], v[36:39]
    ds_read_b64_tr_b16 v[118:119], v6 offset:4608
    v_mfma_f32_16x16x32_bf16 v[40:43], v[80:83], v[92:95], v[40:43]
    ds_read_b128 v[120:123], v8 offset:0
    v_mfma_f32_16x16x32_bf16 v[44:47], v[80:83], v[96:99], v[44:47]
    ds_read_b128 v[124:127], v8 offset:2048
    v_mfma_f32_16x16x32_bf16 v[48:51], v[80:83], v[100:103], v[48:51]
    ds_read_b128 v[128:131], v8 offset:4096
    v_mfma_f32_16x16x32_bf16 v[52:55], v[80:83], v[104:107], v[52:55]
    ds_read_b128 v[132:135], v8 offset:6144
    v_mfma_f32_16x16x32_bf16 v[56:59], v[84:87], v[88:91], v[56:59]
    ds_read_b128 v[136:139], v8 offset:8192
    v_mfma_f32_16x16x32_bf16 v[60:63], v[84:87], v[92:95], v[60:63]
    s_add_u32 s33, s33, 1
    v_mfma_f32_16x16x32_bf16 v[64:67], v[84:87], v[96:99], v[64:67]
    s_cmp_eq_u32 s33, 4
    v_mfma_f32_16x16x32_bf16 v[68:71], v[84:87], v[100:103], v[68:71]
    s_cselect_b32 s35, 4294893568, s30
    v_mfma_f32_16x16x32_bf16 v[72:75], v[84:87], v[104:107], v[72:75]
    s_cselect_b32 s29, 4294936576, s32
    s_cselect_b32 s33, 0, s33
    v_add_u32 v4, s35, v4
    v_add_u32 v5, s35, v5
    v_add_u32 v6, s35, v6
    v_add_u32 v7, s29, v7
    v_add_u32 v8, s29, v8
    s_waitcnt lgkmcnt(0)
    s_barrier
    v_mfma_f32_16x16x32_bf16 v[16:19], v[108:111], v[120:123], v[16:19]
    ds_read_b64_tr_b16 v[76:77], v4 offset:0
    v_mfma_f32_16x16x32_bf16 v[20:23], v[108:111], v[124:127], v[20:23]
    ds_read_b64_tr_b16 v[78:79], v4 offset:512
    v_mfma_f32_16x16x32_bf16 v[24:27], v[108:111], v[128:131], v[24:27]
    ds_read_b64_tr_b16 v[80:81], v5 offset:0
    v_mfma_f32_16x16x32_bf16 v[28:31], v[108:111], v[132:135], v[28:31]
    ds_read_b64_tr_b16 v[82:83], v5 offset:512
    v_mfma_f32_16x16x32_bf16 v[32:35], v[108:111], v[136:139], v[32:35]
    ds_read_b64_tr_b16 v[84:85], v6 offset:0
    v_mfma_f32_16x16x32_bf16 v[36:39], v[112:115], v[120:123], v[36:39]
    ds_read_b64_tr_b16 v[86:87], v6 offset:512
    v_mfma_f32_16x16x32_bf16 v[40:43], v[112:115], v[124:127], v[40:43]
    ds_read_b128 v[88:91], v7 offset:0
    v_mfma_f32_16x16x32_bf16 v[44:47], v[112:115], v[128:131], v[44:47]
    ds_read_b128 v[92:95], v7 offset:2048
    v_mfma_f32_16x16x32_bf16 v[48:51], v[112:115], v[132:135], v[48:51]
    ds_read_b128 v[96:99], v7 offset:4096
    v_mfma_f32_16x16x32_bf16 v[52:55], v[112:115], v[136:139], v[52:55]
    ds_read_b128 v[100:103], v7 offset:6144
    v_mfma_f32_16x16x32_bf16 v[56:59], v[116:119], v[120:123], v[56:59]
    ds_read_b128 v[104:107], v7 offset:8192
    v_mfma_f32_16x16x32_bf16 v[60:63], v[116:119], v[124:127], v[60:63]
    s_sub_u32 s34, s34, 1
    v_mfma_f32_16x16x32_bf16 v[64:67], v[116:119], v[128:131], v[64:67]
    s_cmp_lg_u32 s34, 0
    v_mfma_f32_16x16x32_bf16 v[68:71], v[116:119], v[132:135], v[68:71]
    v_mfma_f32_16x16x32_bf16 v[72:75], v[116:119], v[136:139], v[72:75]
    s_waitcnt lgkmcnt(0)
    s_cbranch_scc1 kvc_mm_45
    v_mfma_f32_16x16x32_bf16 v[16:19], v[76:79], v[88:91], v[16:19]
    ds_read_b64_tr_b16 v[108:109], v4 offset:4096
    v_mfma_f32_16x16x32_bf16 v[20:23], v[76:79], v[92:95], v[20:23]
    ds_read_b64_tr_b16 v[110:111], v4 offset:4608
    v_mfma_f32_16x16x32_bf16 v[24:27], v[76:79], v[96:99], v[24:27]
    ds_read_b64_tr_b16 v[112:113], v5 offset:4096
    v_mfma_f32_16x16x32_bf16 v[28:31], v[76:79], v[100:103], v[28:31]
    ds_read_b64_tr_b16 v[114:115], v5 offset:4608
    v_mfma_f32_16x16x32_bf16 v[32:35], v[76:79], v[104:107], v[32:35]
    ds_read_b64_tr_b16 v[116:117], v6 offset:4096
    v_mfma_f32_16x16x32_bf16 v[36:39], v[80:83], v[88:91], v[36:39]
    ds_read_b64_tr_b16 v[118:119], v6 offset:4608
    v_mfma_f32_16x16x32_bf16 v[40:43], v[80:83], v[92:95], v[40:43]
    ds_read_b128 v[120:123], v8 offset:0
    v_mfma_f32_16x16x32_bf16 v[44:47], v[80:83], v[96:99], v[44:47]
    ds_read_b128 v[124:127], v8 offset:2048
    v_mfma_f32_16x16x32_bf16 v[48:51], v[80:83], v[100:103], v[48:51]
    ds_read_b128 v[128:131], v8 offset:4096
    v_mfma_f32_16x16x32_bf16 v[52:55], v[80:83], v[104:107], v[52:55]
    ds_read_b128 v[132:135], v8 offset:6144
    v_mfma_f32_16x16x32_bf16 v[56:59], v[84:87], v[88:91], v[56:59]
    ds_read_b128 v[136:139], v8 offset:8192
    v_mfma_f32_16x16x32_bf16 v[60:63], v[84:87], v[92:95], v[60:63]
    v_mfma_f32_16x16x32_bf16 v[64:67], v[84:87], v[96:99], v[64:67]
    v_mfma_f32_16x16x32_bf16 v[68:71], v[84:87], v[100:103], v[68:71]
    v_mfma_f32_16x16x32_bf16 v[72:75], v[84:87], v[104:107], v[72:75]
    s_waitcnt lgkmcnt(0)
    v_mfma_f32_16x16x32_bf16 v[16:19], v[108:111], v[120:123], v[16:19]
    v_mfma_f32_16x16x32_bf16 v[20:23], v[108:111], v[124:127], v[20:23]
    v_mfma_f32_16x16x32_bf16 v[24:27], v[108:111], v[128:131], v[24:27]
    v_mfma_f32_16x16x32_bf16 v[28:31], v[108:111], v[132:135], v[28:31]
    v_mfma_f32_16x16x32_bf16 v[32:35], v[108:111], v[136:139], v[32:35]
    v_mfma_f32_16x16x32_bf16 v[36:39], v[112:115], v[120:123], v[36:39]
    v_mfma_f32_16x16x32_bf16 v[40:43], v[112:115], v[124:127], v[40:43]
    v_mfma_f32_16x16x32_bf16 v[44:47], v[112:115], v[128:131], v[44:47]
    v_mfma_f32_16x16x32_bf16 v[48:51], v[112:115], v[132:135], v[48:51]
    v_mfma_f32_16x16x32_bf16 v[52:55], v[112:115], v[136:139], v[52:55]
    v_mfma_f32_16x16x32_bf16 v[56:59], v[116:119], v[120:123], v[56:59]
    v_mfma_f32_16x16x32_bf16 v[60:63], v[116:119], v[124:127], v[60:63]
    v_mfma_f32_16x16x32_bf16 v[64:67], v[116:119], v[128:131], v[64:67]
    v_mfma_f32_16x16x32_bf16 v[68:71], v[116:119], v[132:135], v[68:71]
    v_mfma_f32_16x16x32_bf16 v[72:75], v[116:119], v[136:139], v[72:75]
    v_and_b32 v1, 15, v0
    v_lshlrev_b32 v1, 4, v1
    v_lshrrev_b32 v2, 5, v0
    v_lshl_add_u32 v1, v2, 8, v1
    v_bfe_u32 v2, v0, 4, 1
    v_lshl_add_u32 v1, v2, 3, v1
    s_mul_i32 s70, s68, 12
    s_mul_i32 s71, s83, 3
    s_add_u32 s70, s70, s71
    s_mul_i32 s72, s67, 5120
    s_add_u32 s71, s70, 0
    s_lshr_b32 s27, s71, 1
    s_mul_i32 s27, s27, 10240
    s_and_b32 s71, s71, 1
    s_lshl_b32 s71, s71, 9
    s_add_u32 s27, s27, s71
    s_add_u32 s27, s27, s72
    v_cvt_pk_bf16_f32 v76, v16, v17
    v_cvt_pk_bf16_f32 v77, v18, v19
    buffer_store_dwordx2 v[76:77], v1, s[12:15], s27 offen offset:0 sc1
    v_cvt_pk_bf16_f32 v78, v20, v21
    v_cvt_pk_bf16_f32 v79, v22, v23
    buffer_store_dwordx2 v[78:79], v1, s[12:15], s27 offen offset:1024 sc1
    v_cvt_pk_bf16_f32 v80, v24, v25
    v_cvt_pk_bf16_f32 v81, v26, v27
    buffer_store_dwordx2 v[80:81], v1, s[12:15], s27 offen offset:2048 sc1
    v_cvt_pk_bf16_f32 v82, v28, v29
    v_cvt_pk_bf16_f32 v83, v30, v31
    buffer_store_dwordx2 v[82:83], v1, s[12:15], s27 offen offset:3072 sc1
    v_cvt_pk_bf16_f32 v84, v32, v33
    v_cvt_pk_bf16_f32 v85, v34, v35
    s_add_u32 s27, s27, 4096
    buffer_store_dwordx2 v[84:85], v1, s[12:15], s27 offen offset:0 sc1
    s_add_u32 s71, s70, 1
    s_lshr_b32 s27, s71, 1
    s_mul_i32 s27, s27, 10240
    s_and_b32 s71, s71, 1
    s_lshl_b32 s71, s71, 9
    s_add_u32 s27, s27, s71
    s_add_u32 s27, s27, s72
    v_cvt_pk_bf16_f32 v86, v36, v37
    v_cvt_pk_bf16_f32 v87, v38, v39
    buffer_store_dwordx2 v[86:87], v1, s[12:15], s27 offen offset:0 sc1
    v_cvt_pk_bf16_f32 v88, v40, v41
    v_cvt_pk_bf16_f32 v89, v42, v43
    buffer_store_dwordx2 v[88:89], v1, s[12:15], s27 offen offset:1024 sc1
    v_cvt_pk_bf16_f32 v90, v44, v45
    v_cvt_pk_bf16_f32 v91, v46, v47
    buffer_store_dwordx2 v[90:91], v1, s[12:15], s27 offen offset:2048 sc1
    v_cvt_pk_bf16_f32 v92, v48, v49
    v_cvt_pk_bf16_f32 v93, v50, v51
    buffer_store_dwordx2 v[92:93], v1, s[12:15], s27 offen offset:3072 sc1
    v_cvt_pk_bf16_f32 v94, v52, v53
    v_cvt_pk_bf16_f32 v95, v54, v55
    s_add_u32 s27, s27, 4096
    buffer_store_dwordx2 v[94:95], v1, s[12:15], s27 offen offset:0 sc1
    s_add_u32 s71, s70, 2
    s_lshr_b32 s27, s71, 1
    s_mul_i32 s27, s27, 10240
    s_and_b32 s71, s71, 1
    s_lshl_b32 s71, s71, 9
    s_add_u32 s27, s27, s71
    s_add_u32 s27, s27, s72
    v_cvt_pk_bf16_f32 v96, v56, v57
    v_cvt_pk_bf16_f32 v97, v58, v59
    buffer_store_dwordx2 v[96:97], v1, s[12:15], s27 offen offset:0 sc1
    v_cvt_pk_bf16_f32 v98, v60, v61
    v_cvt_pk_bf16_f32 v99, v62, v63
    buffer_store_dwordx2 v[98:99], v1, s[12:15], s27 offen offset:1024 sc1
    v_cvt_pk_bf16_f32 v100, v64, v65
    v_cvt_pk_bf16_f32 v101, v66, v67
    buffer_store_dwordx2 v[100:101], v1, s[12:15], s27 offen offset:2048 sc1
    v_cvt_pk_bf16_f32 v102, v68, v69
    v_cvt_pk_bf16_f32 v103, v70, v71
    buffer_store_dwordx2 v[102:103], v1, s[12:15], s27 offen offset:3072 sc1
    v_cvt_pk_bf16_f32 v104, v72, v73
    v_cvt_pk_bf16_f32 v105, v74, v75
    s_add_u32 s27, s27, 4096
    buffer_store_dwordx2 v[104:105], v1, s[12:15], s27 offen offset:0 sc1
    s_mov_b64 exec, -1
    s_lshl_b32 s27, s78, 7
    v_mov_b32 v8, 0
    v_mov_b32 v9, 1
    s_cmp_lg_u32 s3, 0
    s_waitcnt vmcnt(0)
    s_barrier
    s_cbranch_scc1 sig_46
    s_mov_b64 exec, 1
    buffer_store_dword v9, v8, s[36:39], s27 offen sc1
    s_mov_b64 exec, -1
sig_46:
kvc_exit_47:
    s_mov_b64 exec, -1
    s_branch next_task
kvc_loader_43:
    s_and_b32 s82, s3, 1
    s_cmp_ge_u32 s3, 6
    s_cbranch_scc1 kvc_loaderB_44
    s_lshl_b32 s27, s82, 2
    v_bfe_u32 v2, v0, 4, 1
    v_lshlrev_b32 v2, 1, v2
    v_or_b32 v2, s27, v2
    v_and_b32 v1, 7, v0
    v_xor_b32 v1, v1, v2
    v_lshlrev_b32 v1, 4, v1
    s_lshl_b32 s27, s82, 3
    v_lshrrev_b32 v2, 3, v0
    v_add_u32 v2, s27, v2
    s_mov_b32 s27, 4608
    v_mad_u32_u24 v1, v2, s27, v1
    s_mov_b32 s31, s24
    s_lshl_b32 s32, s82, 10
    s_add_u32 s32, s32, 0
    s_mov_b32 m0, s32
    s_nop 0
    buffer_load_dwordx4 v1, s[4:7], s31 offen lds
    s_add_u32 m0, s32, 2048
    s_add_u32 s27, s31, 73728
    buffer_load_dwordx4 v1, s[4:7], s27 offen lds
    s_add_u32 m0, s32, 4096
    s_add_u32 s27, s31, 147456
    buffer_load_dwordx4 v1, s[4:7], s27 offen lds
    s_add_u32 m0, s32, 6144
    s_add_u32 s27, s31, 221184
    buffer_load_dwordx4 v1, s[4:7], s27 offen lds
    s_add_u32 m0, s32, 8192
    s_add_u32 s27, s31, 128
    buffer_load_dwordx4 v1, s[4:7], s27 offen lds
    s_add_u32 m0, s32, 10240
    s_add_u32 s27, s31, 73856
    buffer_load_dwordx4 v1, s[4:7], s27 offen lds
    s_add_u32 m0, s32, 12288
    s_add_u32 s27, s31, 147584
    buffer_load_dwordx4 v1, s[4:7], s27 offen lds
    s_add_u32 m0, s32, 14336
    s_add_u32 s27, s31, 221312
    buffer_load_dwordx4 v1, s[4:7], s27 offen lds
    s_add_u32 m0, s32, 16384
    s_add_u32 s27, s31, 256
    buffer_load_dwordx4 v1, s[4:7], s27 offen lds
    s_add_u32 m0, s32, 18432
    s_add_u32 s27, s31, 73984
    buffer_load_dwordx4 v1, s[4:7], s27 offen lds
    s_add_u32 m0, s32, 20480
    s_add_u32 s27, s31, 147712
    buffer_load_dwordx4 v1, s[4:7], s27 offen lds
    s_add_u32 m0, s32, 22528
    s_add_u32 s27, s31, 221440
    buffer_load_dwordx4 v1, s[4:7], s27 offen lds
    s_add_u32 s31, s31, 294912
    s_add_u32 m0, s32, 24576
    s_nop 0
    buffer_load_dwordx4 v1, s[4:7], s31 offen lds
    s_add_u32 m0, s32, 26624
    s_add_u32 s27, s31, 73728
    buffer_load_dwordx4 v1, s[4:7], s27 offen lds
    s_add_u32 m0, s32, 28672
    s_add_u32 s27, s31, 147456
    buffer_load_dwordx4 v1, s[4:7], s27 offen lds
    s_add_u32 m0, s32, 30720
    s_add_u32 s27, s31, 221184
    buffer_load_dwordx4 v1, s[4:7], s27 offen lds
    s_add_u32 m0, s32, 32768
    s_add_u32 s27, s31, 128
    buffer_load_dwordx4 v1, s[4:7], s27 offen lds
    s_add_u32 m0, s32, 34816
    s_add_u32 s27, s31, 73856
    buffer_load_dwordx4 v1, s[4:7], s27 offen lds
    s_add_u32 m0, s32, 36864
    s_add_u32 s27, s31, 147584
    buffer_load_dwordx4 v1, s[4:7], s27 offen lds
    s_add_u32 m0, s32, 38912
    s_add_u32 s27, s31, 221312
    buffer_load_dwordx4 v1, s[4:7], s27 offen lds
    s_add_u32 m0, s32, 40960
    s_add_u32 s27, s31, 256
    buffer_load_dwordx4 v1, s[4:7], s27 offen lds
    s_add_u32 m0, s32, 43008
    s_add_u32 s27, s31, 73984
    buffer_load_dwordx4 v1, s[4:7], s27 offen lds
    s_add_u32 m0, s32, 45056
    s_add_u32 s27, s31, 147712
    buffer_load_dwordx4 v1, s[4:7], s27 offen lds
    s_add_u32 m0, s32, 47104
    s_add_u32 s27, s31, 221440
    buffer_load_dwordx4 v1, s[4:7], s27 offen lds
    s_add_u32 s31, s31, 294912
    s_add_u32 m0, s32, 49152
    s_nop 0
    buffer_load_dwordx4 v1, s[4:7], s31 offen lds
    s_add_u32 m0, s32, 51200
    s_add_u32 s27, s31, 73728
    buffer_load_dwordx4 v1, s[4:7], s27 offen lds
    s_add_u32 m0, s32, 53248
    s_add_u32 s27, s31, 147456
    buffer_load_dwordx4 v1, s[4:7], s27 offen lds
    s_add_u32 m0, s32, 55296
    s_add_u32 s27, s31, 221184
    buffer_load_dwordx4 v1, s[4:7], s27 offen lds
    s_add_u32 m0, s32, 57344
    s_add_u32 s27, s31, 128
    buffer_load_dwordx4 v1, s[4:7], s27 offen lds
    s_add_u32 m0, s32, 59392
    s_add_u32 s27, s31, 73856
    buffer_load_dwordx4 v1, s[4:7], s27 offen lds
    s_add_u32 m0, s32, 61440
    s_add_u32 s27, s31, 147584
    buffer_load_dwordx4 v1, s[4:7], s27 offen lds
    s_add_u32 m0, s32, 63488
    s_add_u32 s27, s31, 221312
    buffer_load_dwordx4 v1, s[4:7], s27 offen lds
    s_add_u32 m0, s32, 65536
    s_add_u32 s27, s31, 256
    buffer_load_dwordx4 v1, s[4:7], s27 offen lds
    s_add_u32 m0, s32, 67584
    s_add_u32 s27, s31, 73984
    buffer_load_dwordx4 v1, s[4:7], s27 offen lds
    s_add_u32 m0, s32, 69632
    s_add_u32 s27, s31, 147712
    buffer_load_dwordx4 v1, s[4:7], s27 offen lds
    s_add_u32 m0, s32, 71680
    s_add_u32 s27, s31, 221440
    buffer_load_dwordx4 v1, s[4:7], s27 offen lds
    s_add_u32 s31, s31, 294912
    s_waitcnt vmcnt(24)
    s_barrier
    s_add_u32 m0, s32, 73728
    s_nop 0
    buffer_load_dwordx4 v1, s[4:7], s31 offen lds
    s_add_u32 m0, s32, 75776
    s_add_u32 s27, s31, 73728
    buffer_load_dwordx4 v1, s[4:7], s27 offen lds
    s_add_u32 m0, s32, 77824
    s_add_u32 s27, s31, 147456
    buffer_load_dwordx4 v1, s[4:7], s27 offen lds
    s_add_u32 m0, s32, 79872
    s_add_u32 s27, s31, 221184
    buffer_load_dwordx4 v1, s[4:7], s27 offen lds
    s_add_u32 m0, s32, 81920
    s_add_u32 s27, s31, 128
    buffer_load_dwordx4 v1, s[4:7], s27 offen lds
    s_add_u32 m0, s32, 83968
    s_add_u32 s27, s31, 73856
    buffer_load_dwordx4 v1, s[4:7], s27 offen lds
    s_add_u32 m0, s32, 86016
    s_add_u32 s27, s31, 147584
    buffer_load_dwordx4 v1, s[4:7], s27 offen lds
    s_add_u32 m0, s32, 88064
    s_add_u32 s27, s31, 221312
    buffer_load_dwordx4 v1, s[4:7], s27 offen lds
    s_add_u32 m0, s32, 90112
    s_add_u32 s27, s31, 256
    buffer_load_dwordx4 v1, s[4:7], s27 offen lds
    s_add_u32 m0, s32, 92160
    s_add_u32 s27, s31, 73984
    buffer_load_dwordx4 v1, s[4:7], s27 offen lds
    s_add_u32 m0, s32, 94208
    s_add_u32 s27, s31, 147712
    buffer_load_dwordx4 v1, s[4:7], s27 offen lds
    s_add_u32 m0, s32, 96256
    s_add_u32 s27, s31, 221440
    buffer_load_dwordx4 v1, s[4:7], s27 offen lds
    s_add_u32 s31, s31, 294912
    s_mov_b32 s33, 0
    s_mov_b32 s34, 14
kvc_ld_48:
    s_waitcnt vmcnt(24)
    s_barrier
    s_add_u32 s28, s32, s33
    s_mov_b32 m0, s28
    s_nop 0
    buffer_load_dwordx4 v1, s[4:7], s31 offen lds
    s_add_u32 m0, s28, 2048
    s_add_u32 s27, s31, 73728
    buffer_load_dwordx4 v1, s[4:7], s27 offen lds
    s_add_u32 m0, s28, 4096
    s_add_u32 s27, s31, 147456
    buffer_load_dwordx4 v1, s[4:7], s27 offen lds
    s_add_u32 m0, s28, 6144
    s_add_u32 s27, s31, 221184
    buffer_load_dwordx4 v1, s[4:7], s27 offen lds
    s_add_u32 m0, s28, 8192
    s_add_u32 s27, s31, 128
    buffer_load_dwordx4 v1, s[4:7], s27 offen lds
    s_add_u32 m0, s28, 10240
    s_add_u32 s27, s31, 73856
    buffer_load_dwordx4 v1, s[4:7], s27 offen lds
    s_add_u32 m0, s28, 12288
    s_add_u32 s27, s31, 147584
    buffer_load_dwordx4 v1, s[4:7], s27 offen lds
    s_add_u32 m0, s28, 14336
    s_add_u32 s27, s31, 221312
    buffer_load_dwordx4 v1, s[4:7], s27 offen lds
    s_add_u32 m0, s28, 16384
    s_add_u32 s27, s31, 256
    buffer_load_dwordx4 v1, s[4:7], s27 offen lds
    s_add_u32 m0, s28, 18432
    s_add_u32 s27, s31, 73984
    buffer_load_dwordx4 v1, s[4:7], s27 offen lds
    s_add_u32 m0, s28, 20480
    s_add_u32 s27, s31, 147712
    buffer_load_dwordx4 v1, s[4:7], s27 offen lds
    s_add_u32 m0, s28, 22528
    s_add_u32 s27, s31, 221440
    buffer_load_dwordx4 v1, s[4:7], s27 offen lds
    s_add_u32 s31, s31, 294912
    s_add_u32 s33, s33, 24576
    s_cmp_eq_u32 s33, 98304
    s_cselect_b32 s33, 0, s33
    s_sub_u32 s34, s34, 1
    s_cmp_lg_u32 s34, 0
    s_cbranch_scc1 kvc_ld_48
    s_waitcnt vmcnt(24)
    s_barrier
    s_waitcnt vmcnt(12)
    s_barrier
    s_waitcnt vmcnt(0)
    s_barrier
    v_min_u32 v8, 11, v0
    v_and_b32 v9, 1, v8
    v_lshlrev_b32 v9, 7, v9
    v_lshl_add_u32 v8, v8, 2, v9
    s_mov_b32 s34, 131072
wi_49:
    global_load_dword v9, v8, s[60:61] sc1
    s_sub_u32 s34, s34, 1
    s_waitcnt vmcnt(0)
    v_cmp_ne_u32 vcc, 1, v9
    s_cmp_eq_u32 s34, 0
    s_cbranch_scc1 wid_50
    s_cmp_eq_u64 vcc, 0
    s_cbranch_scc1 wid_50
    s_sleep 3
    s_branch wi_49
wid_50:
    s_barrier
    s_branch kvc_exit_47
kvc_loaderB_44:
    s_lshl_b32 s27, s82, 2
    v_lshrrev_b32 v2, 4, v0
    v_add_u32 v2, s27, v2
    v_and_b32 v1, 7, v0
    v_xor_b32 v1, v1, v2
    v_lshlrev_b32 v1, 4, v1
    s_lshl_b32 s27, s82, 3
    v_lshrrev_b32 v2, 3, v0
    v_add_u32 v2, s27, v2
    s_mov_b32 s27, 2304
    v_mad_u32_u24 v1, v2, s27, v1
    s_mov_b32 s31, s25
    s_lshl_b32 s32, s82, 10
    s_add_u32 s32, s32, 98304
    s_mov_b32 m0, s32
    s_nop 0
    buffer_load_dwordx4 v1, s[8:11], s31 offen lds
    s_add_u32 m0, s32, 2048
    s_add_u32 s27, s31, 36864
    buffer_load_dwordx4 v1, s[8:11], s27 offen lds
    s_add_u32 m0, s32, 4096
    s_add_u32 s27, s31, 73728
    buffer_load_dwordx4 v1, s[8:11], s27 offen lds
    s_add_u32 m0, s32, 6144
    s_add_u32 s27, s31, 110592
    buffer_load_dwordx4 v1, s[8:11], s27 offen lds
    s_add_u32 m0, s32, 8192
    s_add_u32 s27, s31, 147456
    buffer_load_dwordx4 v1, s[8:11], s27 offen lds
    s_add_u32 s31, s31, 128
    s_add_u32 m0, s32, 10240
    s_nop 0
    buffer_load_dwordx4 v1, s[8:11], s31 offen lds
    s_add_u32 m0, s32, 12288
    s_add_u32 s27, s31, 36864
    buffer_load_dwordx4 v1, s[8:11], s27 offen lds
    s_add_u32 m0, s32, 14336
    s_add_u32 s27, s31, 73728
    buffer_load_dwordx4 v1, s[8:11], s27 offen lds
    s_add_u32 m0, s32, 16384
    s_add_u32 s27, s31, 110592
    buffer_load_dwordx4 v1, s[8:11], s27 offen lds
    s_add_u32 m0, s32, 18432
    s_add_u32 s27, s31, 147456
    buffer_load_dwordx4 v1, s[8:11], s27 offen lds
    s_add_u32 s31, s31, 128
    s_add_u32 m0, s32, 20480
    s_nop 0
    buffer_load_dwordx4 v1, s[8:11], s31 offen lds
    s_add_u32 m0, s32, 22528
    s_add_u32 s27, s31, 36864
    buffer_load_dwordx4 v1, s[8:11], s27 offen lds
    s_add_u32 m0, s32, 24576
    s_add_u32 s27, s31, 73728
    buffer_load_dwordx4 v1, s[8:11], s27 offen lds
    s_add_u32 m0, s32, 26624
    s_add_u32 s27, s31, 110592
    buffer_load_dwordx4 v1, s[8:11], s27 offen lds
    s_add_u32 m0, s32, 28672
    s_add_u32 s27, s31, 147456
    buffer_load_dwordx4 v1, s[8:11], s27 offen lds
    s_add_u32 s31, s31, 128
    s_waitcnt vmcnt(10)
    s_barrier
    s_add_u32 m0, s32, 30720
    s_nop 0
    buffer_load_dwordx4 v1, s[8:11], s31 offen lds
    s_add_u32 m0, s32, 32768
    s_add_u32 s27, s31, 36864
    buffer_load_dwordx4 v1, s[8:11], s27 offen lds
    s_add_u32 m0, s32, 34816
    s_add_u32 s27, s31, 73728
    buffer_load_dwordx4 v1, s[8:11], s27 offen lds
    s_add_u32 m0, s32, 36864
    s_add_u32 s27, s31, 110592
    buffer_load_dwordx4 v1, s[8:11], s27 offen lds
    s_add_u32 m0, s32, 38912
    s_add_u32 s27, s31, 147456
    buffer_load_dwordx4 v1, s[8:11], s27 offen lds
    s_add_u32 s31, s31, 128
    s_mov_b32 s33, 0
    s_mov_b32 s34, 14
kvc_ld_51:
    s_waitcnt vmcnt(10)
    s_barrier
    s_add_u32 s28, s32, s33
    s_mov_b32 m0, s28
    s_nop 0
    buffer_load_dwordx4 v1, s[8:11], s31 offen lds
    s_add_u32 m0, s28, 2048
    s_add_u32 s27, s31, 36864
    buffer_load_dwordx4 v1, s[8:11], s27 offen lds
    s_add_u32 m0, s28, 4096
    s_add_u32 s27, s31, 73728
    buffer_load_dwordx4 v1, s[8:11], s27 offen lds
    s_add_u32 m0, s28, 6144
    s_add_u32 s27, s31, 110592
    buffer_load_dwordx4 v1, s[8:11], s27 offen lds
    s_add_u32 m0, s28, 8192
    s_add_u32 s27, s31, 147456
    buffer_load_dwordx4 v1, s[8:11], s27 offen lds
    s_add_u32 s31, s31, 128
    s_add_u32 s33, s33, 10240
    s_cmp_eq_u32 s33, 40960
    s_cselect_b32 s33, 0, s33
    s_sub_u32 s34, s34, 1
    s_cmp_lg_u32 s34, 0
    s_cbranch_scc1 kvc_ld_51
    s_waitcnt vmcnt(10)
    s_barrier
    s_waitcnt vmcnt(5)
    s_barrier
    s_waitcnt vmcnt(0)
    s_barrier
    s_barrier
    s_branch kvc_exit_47
role_gate:
    s_mov_b32 s73, s67
    s_mov_b32 s72, s68
pb_gate:
    s_lshl_b32 s31, s73, 7
    s_add_u32 s31, s31, 4608
    s_mov_b32 s4, s56
    s_mov_b32 s5, s57
    s_mov_b32 s6, 15925248
    s_mov_b32 s7, 0x00020000
    s_mov_b32 s8, s42
    s_mov_b32 s9, s43
    s_mov_b32 s10, 4608
    s_mov_b32 s11, 0x00020000
    s_lshl_b32 s27, s3, 10
    v_lshl_add_u32 v3, v0, 4, s27
    buffer_load_dwordx4 v[148:151], v3, s[8:11], 0 offen
    s_lshl_b32 s27, s3, 3
    v_lshrrev_b32 v4, 3, v0
    v_add_u32 v4, s27, v4
    v_and_b32 v5, 7, v0
    v_lshlrev_b32 v5, 4, v5
    s_mov_b32 s27, 13824
    v_mad_u32_u24 v5, v4, s27, v5
    buffer_load_dwordx4 v[16:19], v5, s[4:7], s31 offen
    s_add_u32 s31, s31, 884736
    buffer_load_dwordx4 v[20:23], v5, s[4:7], s31 offen
    s_add_u32 s31, s31, 884736
    buffer_load_dwordx4 v[24:27], v5, s[4:7], s31 offen
    s_add_u32 s31, s31, 884736
    buffer_load_dwordx4 v[28:31], v5, s[4:7], s31 offen
    s_add_u32 s31, s31, 884736
    buffer_load_dwordx4 v[32:35], v5, s[4:7], s31 offen
    s_add_u32 s31, s31, 884736
    buffer_load_dwordx4 v[36:39], v5, s[4:7], s31 offen
    s_add_u32 s31, s31, 884736
    buffer_load_dwordx4 v[40:43], v5, s[4:7], s31 offen
    s_add_u32 s31, s31, 884736
    buffer_load_dwordx4 v[44:47], v5, s[4:7], s31 offen
    s_add_u32 s31, s31, 884736
    buffer_load_dwordx4 v[48:51], v5, s[4:7], s31 offen
    s_add_u32 s31, s31, 884736
    buffer_load_dwordx4 v[52:55], v5, s[4:7], s31 offen
    s_add_u32 s31, s31, 884736
    buffer_load_dwordx4 v[56:59], v5, s[4:7], s31 offen
    s_add_u32 s31, s31, 884736
    buffer_load_dwordx4 v[60:63], v5, s[4:7], s31 offen
    s_add_u32 s31, s31, 884736
    buffer_load_dwordx4 v[64:67], v5, s[4:7], s31 offen
    s_add_u32 s31, s31, 884736
    buffer_load_dwordx4 v[68:71], v5, s[4:7], s31 offen
    s_add_u32 s31, s31, 884736
    buffer_load_dwordx4 v[72:75], v5, s[4:7], s31 offen
    s_add_u32 s31, s31, 884736
    buffer_load_dwordx4 v[76:79], v5, s[4:7], s31 offen
    s_add_u32 s31, s31, 884736
    buffer_load_dwordx4 v[80:83], v5, s[4:7], s31 offen
    s_add_u32 s31, s31, 884736
    buffer_load_dwordx4 v[84:87], v5, s[4:7], s31 offen
    v_lshlrev_b32 v4, 2, v4
    s_waitcnt vmcnt(18)
    v_lshlrev_b32 v152, 16, v148
    v_and_b32 v153, 0xffff0000, v148
    v_lshlrev_b32 v154, 16, v149
    v_and_b32 v155, 0xffff0000, v149
    v_lshlrev_b32 v156, 16, v150
    v_and_b32 v157, 0xffff0000, v150
    v_lshlrev_b32 v158, 16, v151
    v_and_b32 v159, 0xffff0000, v151
    v_mul_f32 v140, 0xbfb8aa3b, v152
    v_mul_f32 v141, 0xbfb8aa3b, v153
    v_mul_f32 v142, 0xbfb8aa3b, v154
    v_mul_f32 v143, 0xbfb8aa3b, v155
    v_mul_f32 v144, 0xbfb8aa3b, v156
    v_mul_f32 v145, 0xbfb8aa3b, v157
    v_mul_f32 v146, 0xbfb8aa3b, v158
    v_mul_f32 v147, 0xbfb8aa3b, v159
    v_exp_f32 v140, v140
    v_exp_f32 v141, v141
    v_exp_f32 v142, v142
    v_exp_f32 v143, v143
    v_exp_f32 v144, v144
    v_exp_f32 v145, v145
    v_exp_f32 v146, v146
    v_exp_f32 v147, v147
    v_add_f32 v140, 1.0, v140
    v_add_f32 v141, 1.0, v141
    v_add_f32 v142, 1.0, v142
    v_add_f32 v143, 1.0, v143
    v_add_f32 v144, 1.0, v144
    v_add_f32 v145, 1.0, v145
    v_add_f32 v146, 1.0, v146
    v_add_f32 v147, 1.0, v147
    v_rcp_f32 v140, v140
    v_rcp_f32 v141, v141
    v_rcp_f32 v142, v142
    v_rcp_f32 v143, v143
    v_rcp_f32 v144, v144
    v_rcp_f32 v145, v145
    v_rcp_f32 v146, v146
    v_rcp_f32 v147, v147
    v_mul_f32 v152, v140, v152
    v_mul_f32 v153, v141, v153
    v_mul_f32 v154, v142, v154
    v_mul_f32 v155, v143, v155
    v_mul_f32 v156, v144, v156
    v_mul_f32 v157, v145, v157
    v_mul_f32 v158, v146, v158
    v_mul_f32 v159, v147, v159
    v_lshlrev_b32 v8, 1, v3
    v_cmp_gt_u32 vcc, 9216, v8
    s_mov_b64 exec, vcc
    ds_write_b128 v8, v[152:155] offset:0
    ds_write_b128 v8, v[156:159] offset:16
    s_mov_b64 exec, -1
    s_waitcnt lgkmcnt(0)
    s_barrier
    ds_read2st64_b32 v[88:89], v4 offset0:0 offset1:18
    ds_read2st64_b32 v[90:91], v4 offset0:1 offset1:19
    ds_read2st64_b32 v[92:93], v4 offset0:2 offset1:20
    ds_read2st64_b32 v[94:95], v4 offset0:3 offset1:21
    ds_read2st64_b32 v[96:97], v4 offset0:4 offset1:22
    ds_read2st64_b32 v[98:99], v4 offset0:5 offset1:23
    ds_read2st64_b32 v[100:101], v4 offset0:6 offset1:24
    ds_read2st64_b32 v[102:103], v4 offset0:7 offset1:25
    ds_read2st64_b32 v[104:105], v4 offset0:8 offset1:26
    ds_read2st64_b32 v[106:107], v4 offset0:9 offset1:27
    ds_read2st64_b32 v[108:109], v4 offset0:10 offset1:28
    ds_read2st64_b32 v[110:111], v4 offset0:11 offset1:29
    ds_read2st64_b32 v[112:113], v4 offset0:12 offset1:30
    ds_read2st64_b32 v[114:115], v4 offset0:13 offset1:31
    ds_read2st64_b32 v[116:117], v4 offset0:14 offset1:32
    ds_read2st64_b32 v[118:119], v4 offset0:15 offset1:33
    ds_read2st64_b32 v[120:121], v4 offset0:16 offset1:34
    ds_read2st64_b32 v[122:123], v4 offset0:17 offset1:35
    v_bfe_u32 v6, v0, 1, 2
    v_lshlrev_b32 v6, 7, v6
    v_lshrrev_b32 v7, 3, v0
    v_lshl_add_u32 v6, v7, 4, v6
    v_and_b32 v7, 1, v0
    v_lshl_add_u32 v6, v7, 3, v6
    v_lshrrev_b32 v7, 4, v0
    v_lshlrev_b32 v7, 7, v7
    v_and_b32 v9, 7, v0
    v_lshl_add_u32 v7, v9, 4, v7
    s_lshl_b32 s27, s3, 9
    v_add_u32 v7, s27, v7
    v_lshlrev_b32 v9, 2, v0
    v_mov_b32 v124, 0
    v_mov_b32 v125, 0
    v_mov_b32 v126, 0
    v_mov_b32 v127, 0
    v_mov_b32 v128, 0
    v_mov_b32 v129, 0
    v_mov_b32 v130, 0
    v_mov_b32 v131, 0
    v_mov_b32 v132, 0
    v_mov_b32 v133, 0
    v_mov_b32 v134, 0
    v_mov_b32 v135, 0
    v_mov_b32 v136, 0
    v_mov_b32 v137, 0
    v_mov_b32 v138, 0
    v_mov_b32 v139, 0
    s_waitcnt lgkmcnt(0)
    s_waitcnt vmcnt(17)
    v_lshlrev_b32 v140, 16, v16
    v_and_b32 v141, 0xffff0000, v16
    v_lshlrev_b32 v142, 16, v17
    v_and_b32 v143, 0xffff0000, v17
    v_lshlrev_b32 v144, 16, v18
    v_and_b32 v145, 0xffff0000, v18
    v_lshlrev_b32 v146, 16, v19
    v_and_b32 v147, 0xffff0000, v19
    v_pk_fma_f32 v[124:125], v[88:89], v[140:141], v[124:125] op_sel:[0,0,0] op_sel_hi:[1,0,1]
    v_pk_fma_f32 v[126:127], v[88:89], v[140:141], v[126:127] op_sel:[0,1,0] op_sel_hi:[1,1,1]
    v_pk_fma_f32 v[128:129], v[88:89], v[142:143], v[128:129] op_sel:[0,0,0] op_sel_hi:[1,0,1]
    v_pk_fma_f32 v[130:131], v[88:89], v[142:143], v[130:131] op_sel:[0,1,0] op_sel_hi:[1,1,1]
    v_pk_fma_f32 v[132:133], v[88:89], v[144:145], v[132:133] op_sel:[0,0,0] op_sel_hi:[1,0,1]
    v_pk_fma_f32 v[134:135], v[88:89], v[144:145], v[134:135] op_sel:[0,1,0] op_sel_hi:[1,1,1]
    v_pk_fma_f32 v[136:137], v[88:89], v[146:147], v[136:137] op_sel:[0,0,0] op_sel_hi:[1,0,1]
    v_pk_fma_f32 v[138:139], v[88:89], v[146:147], v[138:139] op_sel:[0,1,0] op_sel_hi:[1,1,1]
    s_waitcnt vmcnt(16)
    v_lshlrev_b32 v140, 16, v20
    v_and_b32 v141, 0xffff0000, v20
    v_lshlrev_b32 v142, 16, v21
    v_and_b32 v143, 0xffff0000, v21
    v_lshlrev_b32 v144, 16, v22
    v_and_b32 v145, 0xffff0000, v22
    v_lshlrev_b32 v146, 16, v23
    v_and_b32 v147, 0xffff0000, v23
    v_pk_fma_f32 v[124:125], v[90:91], v[140:141], v[124:125] op_sel:[0,0,0] op_sel_hi:[1,0,1]
    v_pk_fma_f32 v[126:127], v[90:91], v[140:141], v[126:127] op_sel:[0,1,0] op_sel_hi:[1,1,1]
    v_pk_fma_f32 v[128:129], v[90:91], v[142:143], v[128:129] op_sel:[0,0,0] op_sel_hi:[1,0,1]
    v_pk_fma_f32 v[130:131], v[90:91], v[142:143], v[130:131] op_sel:[0,1,0] op_sel_hi:[1,1,1]
    v_pk_fma_f32 v[132:133], v[90:91], v[144:145], v[132:133] op_sel:[0,0,0] op_sel_hi:[1,0,1]
    v_pk_fma_f32 v[134:135], v[90:91], v[144:145], v[134:135] op_sel:[0,1,0] op_sel_hi:[1,1,1]
    v_pk_fma_f32 v[136:137], v[90:91], v[146:147], v[136:137] op_sel:[0,0,0] op_sel_hi:[1,0,1]
    v_pk_fma_f32 v[138:139], v[90:91], v[146:147], v[138:139] op_sel:[0,1,0] op_sel_hi:[1,1,1]
    s_waitcnt vmcnt(15)
    v_lshlrev_b32 v140, 16, v24
    v_and_b32 v141, 0xffff0000, v24
    v_lshlrev_b32 v142, 16, v25
    v_and_b32 v143, 0xffff0000, v25
    v_lshlrev_b32 v144, 16, v26
    v_and_b32 v145, 0xffff0000, v26
    v_lshlrev_b32 v146, 16, v27
    v_and_b32 v147, 0xffff0000, v27
    v_pk_fma_f32 v[124:125], v[92:93], v[140:141], v[124:125] op_sel:[0,0,0] op_sel_hi:[1,0,1]
    v_pk_fma_f32 v[126:127], v[92:93], v[140:141], v[126:127] op_sel:[0,1,0] op_sel_hi:[1,1,1]
    v_pk_fma_f32 v[128:129], v[92:93], v[142:143], v[128:129] op_sel:[0,0,0] op_sel_hi:[1,0,1]
    v_pk_fma_f32 v[130:131], v[92:93], v[142:143], v[130:131] op_sel:[0,1,0] op_sel_hi:[1,1,1]
    v_pk_fma_f32 v[132:133], v[92:93], v[144:145], v[132:133] op_sel:[0,0,0] op_sel_hi:[1,0,1]
    v_pk_fma_f32 v[134:135], v[92:93], v[144:145], v[134:135] op_sel:[0,1,0] op_sel_hi:[1,1,1]
    v_pk_fma_f32 v[136:137], v[92:93], v[146:147], v[136:137] op_sel:[0,0,0] op_sel_hi:[1,0,1]
    v_pk_fma_f32 v[138:139], v[92:93], v[146:147], v[138:139] op_sel:[0,1,0] op_sel_hi:[1,1,1]
    s_waitcnt vmcnt(14)
    v_lshlrev_b32 v140, 16, v28
    v_and_b32 v141, 0xffff0000, v28
    v_lshlrev_b32 v142, 16, v29
    v_and_b32 v143, 0xffff0000, v29
    v_lshlrev_b32 v144, 16, v30
    v_and_b32 v145, 0xffff0000, v30
    v_lshlrev_b32 v146, 16, v31
    v_and_b32 v147, 0xffff0000, v31
    v_pk_fma_f32 v[124:125], v[94:95], v[140:141], v[124:125] op_sel:[0,0,0] op_sel_hi:[1,0,1]
    v_pk_fma_f32 v[126:127], v[94:95], v[140:141], v[126:127] op_sel:[0,1,0] op_sel_hi:[1,1,1]
    v_pk_fma_f32 v[128:129], v[94:95], v[142:143], v[128:129] op_sel:[0,0,0] op_sel_hi:[1,0,1]
    v_pk_fma_f32 v[130:131], v[94:95], v[142:143], v[130:131] op_sel:[0,1,0] op_sel_hi:[1,1,1]
    v_pk_fma_f32 v[132:133], v[94:95], v[144:145], v[132:133] op_sel:[0,0,0] op_sel_hi:[1,0,1]
    v_pk_fma_f32 v[134:135], v[94:95], v[144:145], v[134:135] op_sel:[0,1,0] op_sel_hi:[1,1,1]
    v_pk_fma_f32 v[136:137], v[94:95], v[146:147], v[136:137] op_sel:[0,0,0] op_sel_hi:[1,0,1]
    v_pk_fma_f32 v[138:139], v[94:95], v[146:147], v[138:139] op_sel:[0,1,0] op_sel_hi:[1,1,1]
    s_waitcnt vmcnt(13)
    v_lshlrev_b32 v140, 16, v32
    v_and_b32 v141, 0xffff0000, v32
    v_lshlrev_b32 v142, 16, v33
    v_and_b32 v143, 0xffff0000, v33
    v_lshlrev_b32 v144, 16, v34
    v_and_b32 v145, 0xffff0000, v34
    v_lshlrev_b32 v146, 16, v35
    v_and_b32 v147, 0xffff0000, v35
    v_pk_fma_f32 v[124:125], v[96:97], v[140:141], v[124:125] op_sel:[0,0,0] op_sel_hi:[1,0,1]
    v_pk_fma_f32 v[126:127], v[96:97], v[140:141], v[126:127] op_sel:[0,1,0] op_sel_hi:[1,1,1]
    v_pk_fma_f32 v[128:129], v[96:97], v[142:143], v[128:129] op_sel:[0,0,0] op_sel_hi:[1,0,1]
    v_pk_fma_f32 v[130:131], v[96:97], v[142:143], v[130:131] op_sel:[0,1,0] op_sel_hi:[1,1,1]
    v_pk_fma_f32 v[132:133], v[96:97], v[144:145], v[132:133] op_sel:[0,0,0] op_sel_hi:[1,0,1]
    v_pk_fma_f32 v[134:135], v[96:97], v[144:145], v[134:135] op_sel:[0,1,0] op_sel_hi:[1,1,1]
    v_pk_fma_f32 v[136:137], v[96:97], v[146:147], v[136:137] op_sel:[0,0,0] op_sel_hi:[1,0,1]
    v_pk_fma_f32 v[138:139], v[96:97], v[146:147], v[138:139] op_sel:[0,1,0] op_sel_hi:[1,1,1]
    s_waitcnt vmcnt(12)
    v_lshlrev_b32 v140, 16, v36
    v_and_b32 v141, 0xffff0000, v36
    v_lshlrev_b32 v142, 16, v37
    v_and_b32 v143, 0xffff0000, v37
    v_lshlrev_b32 v144, 16, v38
    v_and_b32 v145, 0xffff0000, v38
    v_lshlrev_b32 v146, 16, v39
    v_and_b32 v147, 0xffff0000, v39
    v_pk_fma_f32 v[124:125], v[98:99], v[140:141], v[124:125] op_sel:[0,0,0] op_sel_hi:[1,0,1]
    v_pk_fma_f32 v[126:127], v[98:99], v[140:141], v[126:127] op_sel:[0,1,0] op_sel_hi:[1,1,1]
    v_pk_fma_f32 v[128:129], v[98:99], v[142:143], v[128:129] op_sel:[0,0,0] op_sel_hi:[1,0,1]
    v_pk_fma_f32 v[130:131], v[98:99], v[142:143], v[130:131] op_sel:[0,1,0] op_sel_hi:[1,1,1]
    v_pk_fma_f32 v[132:133], v[98:99], v[144:145], v[132:133] op_sel:[0,0,0] op_sel_hi:[1,0,1]
    v_pk_fma_f32 v[134:135], v[98:99], v[144:145], v[134:135] op_sel:[0,1,0] op_sel_hi:[1,1,1]
    v_pk_fma_f32 v[136:137], v[98:99], v[146:147], v[136:137] op_sel:[0,0,0] op_sel_hi:[1,0,1]
    v_pk_fma_f32 v[138:139], v[98:99], v[146:147], v[138:139] op_sel:[0,1,0] op_sel_hi:[1,1,1]
    s_waitcnt vmcnt(11)
    v_lshlrev_b32 v140, 16, v40
    v_and_b32 v141, 0xffff0000, v40
    v_lshlrev_b32 v142, 16, v41
    v_and_b32 v143, 0xffff0000, v41
    v_lshlrev_b32 v144, 16, v42
    v_and_b32 v145, 0xffff0000, v42
    v_lshlrev_b32 v146, 16, v43
    v_and_b32 v147, 0xffff0000, v43
    v_pk_fma_f32 v[124:125], v[100:101], v[140:141], v[124:125] op_sel:[0,0,0] op_sel_hi:[1,0,1]
    v_pk_fma_f32 v[126:127], v[100:101], v[140:141], v[126:127] op_sel:[0,1,0] op_sel_hi:[1,1,1]
    v_pk_fma_f32 v[128:129], v[100:101], v[142:143], v[128:129] op_sel:[0,0,0] op_sel_hi:[1,0,1]
    v_pk_fma_f32 v[130:131], v[100:101], v[142:143], v[130:131] op_sel:[0,1,0] op_sel_hi:[1,1,1]
    v_pk_fma_f32 v[132:133], v[100:101], v[144:145], v[132:133] op_sel:[0,0,0] op_sel_hi:[1,0,1]
    v_pk_fma_f32 v[134:135], v[100:101], v[144:145], v[134:135] op_sel:[0,1,0] op_sel_hi:[1,1,1]
    v_pk_fma_f32 v[136:137], v[100:101], v[146:147], v[136:137] op_sel:[0,0,0] op_sel_hi:[1,0,1]
    v_pk_fma_f32 v[138:139], v[100:101], v[146:147], v[138:139] op_sel:[0,1,0] op_sel_hi:[1,1,1]
    s_waitcnt vmcnt(10)
    v_lshlrev_b32 v140, 16, v44
    v_and_b32 v141, 0xffff0000, v44
    v_lshlrev_b32 v142, 16, v45
    v_and_b32 v143, 0xffff0000, v45
    v_lshlrev_b32 v144, 16, v46
    v_and_b32 v145, 0xffff0000, v46
    v_lshlrev_b32 v146, 16, v47
    v_and_b32 v147, 0xffff0000, v47
    v_pk_fma_f32 v[124:125], v[102:103], v[140:141], v[124:125] op_sel:[0,0,0] op_sel_hi:[1,0,1]
    v_pk_fma_f32 v[126:127], v[102:103], v[140:141], v[126:127] op_sel:[0,1,0] op_sel_hi:[1,1,1]
    v_pk_fma_f32 v[128:129], v[102:103], v[142:143], v[128:129] op_sel:[0,0,0] op_sel_hi:[1,0,1]
    v_pk_fma_f32 v[130:131], v[102:103], v[142:143], v[130:131] op_sel:[0,1,0] op_sel_hi:[1,1,1]
    v_pk_fma_f32 v[132:133], v[102:103], v[144:145], v[132:133] op_sel:[0,0,0] op_sel_hi:[1,0,1]
    v_pk_fma_f32 v[134:135], v[102:103], v[144:145], v[134:135] op_sel:[0,1,0] op_sel_hi:[1,1,1]
    v_pk_fma_f32 v[136:137], v[102:103], v[146:147], v[136:137] op_sel:[0,0,0] op_sel_hi:[1,0,1]
    v_pk_fma_f32 v[138:139], v[102:103], v[146:147], v[138:139] op_sel:[0,1,0] op_sel_hi:[1,1,1]
    s_waitcnt vmcnt(9)
    v_lshlrev_b32 v140, 16, v48
    v_and_b32 v141, 0xffff0000, v48
    v_lshlrev_b32 v142, 16, v49
    v_and_b32 v143, 0xffff0000, v49
    v_lshlrev_b32 v144, 16, v50
    v_and_b32 v145, 0xffff0000, v50
    v_lshlrev_b32 v146, 16, v51
    v_and_b32 v147, 0xffff0000, v51
    v_pk_fma_f32 v[124:125], v[104:105], v[140:141], v[124:125] op_sel:[0,0,0] op_sel_hi:[1,0,1]
    v_pk_fma_f32 v[126:127], v[104:105], v[140:141], v[126:127] op_sel:[0,1,0] op_sel_hi:[1,1,1]
    v_pk_fma_f32 v[128:129], v[104:105], v[142:143], v[128:129] op_sel:[0,0,0] op_sel_hi:[1,0,1]
    v_pk_fma_f32 v[130:131], v[104:105], v[142:143], v[130:131] op_sel:[0,1,0] op_sel_hi:[1,1,1]
    v_pk_fma_f32 v[132:133], v[104:105], v[144:145], v[132:133] op_sel:[0,0,0] op_sel_hi:[1,0,1]
    v_pk_fma_f32 v[134:135], v[104:105], v[144:145], v[134:135] op_sel:[0,1,0] op_sel_hi:[1,1,1]
    v_pk_fma_f32 v[136:137], v[104:105], v[146:147], v[136:137] op_sel:[0,0,0] op_sel_hi:[1,0,1]
    v_pk_fma_f32 v[138:139], v[104:105], v[146:147], v[138:139] op_sel:[0,1,0] op_sel_hi:[1,1,1]
    s_waitcnt vmcnt(8)
    v_lshlrev_b32 v140, 16, v52
    v_and_b32 v141, 0xffff0000, v52
    v_lshlrev_b32 v142, 16, v53
    v_and_b32 v143, 0xffff0000, v53
    v_lshlrev_b32 v144, 16, v54
    v_and_b32 v145, 0xffff0000, v54
    v_lshlrev_b32 v146, 16, v55
    v_and_b32 v147, 0xffff0000, v55
    v_pk_fma_f32 v[124:125], v[106:107], v[140:141], v[124:125] op_sel:[0,0,0] op_sel_hi:[1,0,1]
    v_pk_fma_f32 v[126:127], v[106:107], v[140:141], v[126:127] op_sel:[0,1,0] op_sel_hi:[1,1,1]
    v_pk_fma_f32 v[128:129], v[106:107], v[142:143], v[128:129] op_sel:[0,0,0] op_sel_hi:[1,0,1]
    v_pk_fma_f32 v[130:131], v[106:107], v[142:143], v[130:131] op_sel:[0,1,0] op_sel_hi:[1,1,1]
    v_pk_fma_f32 v[132:133], v[106:107], v[144:145], v[132:133] op_sel:[0,0,0] op_sel_hi:[1,0,1]
    v_pk_fma_f32 v[134:135], v[106:107], v[144:145], v[134:135] op_sel:[0,1,0] op_sel_hi:[1,1,1]
    v_pk_fma_f32 v[136:137], v[106:107], v[146:147], v[136:137] op_sel:[0,0,0] op_sel_hi:[1,0,1]
    v_pk_fma_f32 v[138:139], v[106:107], v[146:147], v[138:139] op_sel:[0,1,0] op_sel_hi:[1,1,1]
    s_waitcnt vmcnt(7)
    v_lshlrev_b32 v140, 16, v56
    v_and_b32 v141, 0xffff0000, v56
    v_lshlrev_b32 v142, 16, v57
    v_and_b32 v143, 0xffff0000, v57
    v_lshlrev_b32 v144, 16, v58
    v_and_b32 v145, 0xffff0000, v58
    v_lshlrev_b32 v146, 16, v59
    v_and_b32 v147, 0xffff0000, v59
    v_pk_fma_f32 v[124:125], v[108:109], v[140:141], v[124:125] op_sel:[0,0,0] op_sel_hi:[1,0,1]
    v_pk_fma_f32 v[126:127], v[108:109], v[140:141], v[126:127] op_sel:[0,1,0] op_sel_hi:[1,1,1]
    v_pk_fma_f32 v[128:129], v[108:109], v[142:143], v[128:129] op_sel:[0,0,0] op_sel_hi:[1,0,1]
    v_pk_fma_f32 v[130:131], v[108:109], v[142:143], v[130:131] op_sel:[0,1,0] op_sel_hi:[1,1,1]
    v_pk_fma_f32 v[132:133], v[108:109], v[144:145], v[132:133] op_sel:[0,0,0] op_sel_hi:[1,0,1]
    v_pk_fma_f32 v[134:135], v[108:109], v[144:145], v[134:135] op_sel:[0,1,0] op_sel_hi:[1,1,1]
    v_pk_fma_f32 v[136:137], v[108:109], v[146:147], v[136:137] op_sel:[0,0,0] op_sel_hi:[1,0,1]
    v_pk_fma_f32 v[138:139], v[108:109], v[146:147], v[138:139] op_sel:[0,1,0] op_sel_hi:[1,1,1]
    s_waitcnt vmcnt(6)
    v_lshlrev_b32 v140, 16, v60
    v_and_b32 v141, 0xffff0000, v60
    v_lshlrev_b32 v142, 16, v61
    v_and_b32 v143, 0xffff0000, v61
    v_lshlrev_b32 v144, 16, v62
    v_and_b32 v145, 0xffff0000, v62
    v_lshlrev_b32 v146, 16, v63
    v_and_b32 v147, 0xffff0000, v63
    v_pk_fma_f32 v[124:125], v[110:111], v[140:141], v[124:125] op_sel:[0,0,0] op_sel_hi:[1,0,1]
    v_pk_fma_f32 v[126:127], v[110:111], v[140:141], v[126:127] op_sel:[0,1,0] op_sel_hi:[1,1,1]
    v_pk_fma_f32 v[128:129], v[110:111], v[142:143], v[128:129] op_sel:[0,0,0] op_sel_hi:[1,0,1]
    v_pk_fma_f32 v[130:131], v[110:111], v[142:143], v[130:131] op_sel:[0,1,0] op_sel_hi:[1,1,1]
    v_pk_fma_f32 v[132:133], v[110:111], v[144:145], v[132:133] op_sel:[0,0,0] op_sel_hi:[1,0,1]
    v_pk_fma_f32 v[134:135], v[110:111], v[144:145], v[134:135] op_sel:[0,1,0] op_sel_hi:[1,1,1]
    v_pk_fma_f32 v[136:137], v[110:111], v[146:147], v[136:137] op_sel:[0,0,0] op_sel_hi:[1,0,1]
    v_pk_fma_f32 v[138:139], v[110:111], v[146:147], v[138:139] op_sel:[0,1,0] op_sel_hi:[1,1,1]
    s_waitcnt vmcnt(5)
    v_lshlrev_b32 v140, 16, v64
    v_and_b32 v141, 0xffff0000, v64
    v_lshlrev_b32 v142, 16, v65
    v_and_b32 v143, 0xffff0000, v65
    v_lshlrev_b32 v144, 16, v66
    v_and_b32 v145, 0xffff0000, v66
    v_lshlrev_b32 v146, 16, v67
    v_and_b32 v147, 0xffff0000, v67
    v_pk_fma_f32 v[124:125], v[112:113], v[140:141], v[124:125] op_sel:[0,0,0] op_sel_hi:[1,0,1]
    v_pk_fma_f32 v[126:127], v[112:113], v[140:141], v[126:127] op_sel:[0,1,0] op_sel_hi:[1,1,1]
    v_pk_fma_f32 v[128:129], v[112:113], v[142:143], v[128:129] op_sel:[0,0,0] op_sel_hi:[1,0,1]
    v_pk_fma_f32 v[130:131], v[112:113], v[142:143], v[130:131] op_sel:[0,1,0] op_sel_hi:[1,1,1]
    v_pk_fma_f32 v[132:133], v[112:113], v[144:145], v[132:133] op_sel:[0,0,0] op_sel_hi:[1,0,1]
    v_pk_fma_f32 v[134:135], v[112:113], v[144:145], v[134:135] op_sel:[0,1,0] op_sel_hi:[1,1,1]
    v_pk_fma_f32 v[136:137], v[112:113], v[146:147], v[136:137] op_sel:[0,0,0] op_sel_hi:[1,0,1]
    v_pk_fma_f32 v[138:139], v[112:113], v[146:147], v[138:139] op_sel:[0,1,0] op_sel_hi:[1,1,1]
    s_waitcnt vmcnt(4)
    v_lshlrev_b32 v140, 16, v68
    v_and_b32 v141, 0xffff0000, v68
    v_lshlrev_b32 v142, 16, v69
    v_and_b32 v143, 0xffff0000, v69
    v_lshlrev_b32 v144, 16, v70
    v_and_b32 v145, 0xffff0000, v70
    v_lshlrev_b32 v146, 16, v71
    v_and_b32 v147, 0xffff0000, v71
    v_pk_fma_f32 v[124:125], v[114:115], v[140:141], v[124:125] op_sel:[0,0,0] op_sel_hi:[1,0,1]
    v_pk_fma_f32 v[126:127], v[114:115], v[140:141], v[126:127] op_sel:[0,1,0] op_sel_hi:[1,1,1]
    v_pk_fma_f32 v[128:129], v[114:115], v[142:143], v[128:129] op_sel:[0,0,0] op_sel_hi:[1,0,1]
    v_pk_fma_f32 v[130:131], v[114:115], v[142:143], v[130:131] op_sel:[0,1,0] op_sel_hi:[1,1,1]
    v_pk_fma_f32 v[132:133], v[114:115], v[144:145], v[132:133] op_sel:[0,0,0] op_sel_hi:[1,0,1]
    v_pk_fma_f32 v[134:135], v[114:115], v[144:145], v[134:135] op_sel:[0,1,0] op_sel_hi:[1,1,1]
    v_pk_fma_f32 v[136:137], v[114:115], v[146:147], v[136:137] op_sel:[0,0,0] op_sel_hi:[1,0,1]
    v_pk_fma_f32 v[138:139], v[114:115], v[146:147], v[138:139] op_sel:[0,1,0] op_sel_hi:[1,1,1]
    s_waitcnt vmcnt(3)
    v_lshlrev_b32 v140, 16, v72
    v_and_b32 v141, 0xffff0000, v72
    v_lshlrev_b32 v142, 16, v73
    v_and_b32 v143, 0xffff0000, v73
    v_lshlrev_b32 v144, 16, v74
    v_and_b32 v145, 0xffff0000, v74
    v_lshlrev_b32 v146, 16, v75
    v_and_b32 v147, 0xffff0000, v75
    v_pk_fma_f32 v[124:125], v[116:117], v[140:141], v[124:125] op_sel:[0,0,0] op_sel_hi:[1,0,1]
    v_pk_fma_f32 v[126:127], v[116:117], v[140:141], v[126:127] op_sel:[0,1,0] op_sel_hi:[1,1,1]
    v_pk_fma_f32 v[128:129], v[116:117], v[142:143], v[128:129] op_sel:[0,0,0] op_sel_hi:[1,0,1]
    v_pk_fma_f32 v[130:131], v[116:117], v[142:143], v[130:131] op_sel:[0,1,0] op_sel_hi:[1,1,1]
    v_pk_fma_f32 v[132:133], v[116:117], v[144:145], v[132:133] op_sel:[0,0,0] op_sel_hi:[1,0,1]
    v_pk_fma_f32 v[134:135], v[116:117], v[144:145], v[134:135] op_sel:[0,1,0] op_sel_hi:[1,1,1]
    v_pk_fma_f32 v[136:137], v[116:117], v[146:147], v[136:137] op_sel:[0,0,0] op_sel_hi:[1,0,1]
    v_pk_fma_f32 v[138:139], v[116:117], v[146:147], v[138:139] op_sel:[0,1,0] op_sel_hi:[1,1,1]
    s_waitcnt vmcnt(2)
    v_lshlrev_b32 v140, 16, v76
    v_and_b32 v141, 0xffff0000, v76
    v_lshlrev_b32 v142, 16, v77
    v_and_b32 v143, 0xffff0000, v77
    v_lshlrev_b32 v144, 16, v78
    v_and_b32 v145, 0xffff0000, v78
    v_lshlrev_b32 v146, 16, v79
    v_and_b32 v147, 0xffff0000, v79
    v_pk_fma_f32 v[124:125], v[118:119], v[140:141], v[124:125] op_sel:[0,0,0] op_sel_hi:[1,0,1]
    v_pk_fma_f32 v[126:127], v[118:119], v[140:141], v[126:127] op_sel:[0,1,0] op_sel_hi:[1,1,1]
    v_pk_fma_f32 v[128:129], v[118:119], v[142:143], v[128:129] op_sel:[0,0,0] op_sel_hi:[1,0,1]
    v_pk_fma_f32 v[130:131], v[118:119], v[142:143], v[130:131] op_sel:[0,1,0] op_sel_hi:[1,1,1]
    v_pk_fma_f32 v[132:133], v[118:119], v[144:145], v[132:133] op_sel:[0,0,0] op_sel_hi:[1,0,1]
    v_pk_fma_f32 v[134:135], v[118:119], v[144:145], v[134:135] op_sel:[0,1,0] op_sel_hi:[1,1,1]
    v_pk_fma_f32 v[136:137], v[118:119], v[146:147], v[136:137] op_sel:[0,0,0] op_sel_hi:[1,0,1]
    v_pk_fma_f32 v[138:139], v[118:119], v[146:147], v[138:139] op_sel:[0,1,0] op_sel_hi:[1,1,1]
    s_waitcnt vmcnt(1)
    v_lshlrev_b32 v140, 16, v80
    v_and_b32 v141, 0xffff0000, v80
    v_lshlrev_b32 v142, 16, v81
    v_and_b32 v143, 0xffff0000, v81
    v_lshlrev_b32 v144, 16, v82
    v_and_b32 v145, 0xffff0000, v82
    v_lshlrev_b32 v146, 16, v83
    v_and_b32 v147, 0xffff0000, v83
    v_pk_fma_f32 v[124:125], v[120:121], v[140:141], v[124:125] op_sel:[0,0,0] op_sel_hi:[1,0,1]
    v_pk_fma_f32 v[126:127], v[120:121], v[140:141], v[126:127] op_sel:[0,1,0] op_sel_hi:[1,1,1]
    v_pk_fma_f32 v[128:129], v[120:121], v[142:143], v[128:129] op_sel:[0,0,0] op_sel_hi:[1,0,1]
    v_pk_fma_f32 v[130:131], v[120:121], v[142:143], v[130:131] op_sel:[0,1,0] op_sel_hi:[1,1,1]
    v_pk_fma_f32 v[132:133], v[120:121], v[144:145], v[132:133] op_sel:[0,0,0] op_sel_hi:[1,0,1]
    v_pk_fma_f32 v[134:135], v[120:121], v[144:145], v[134:135] op_sel:[0,1,0] op_sel_hi:[1,1,1]
    v_pk_fma_f32 v[136:137], v[120:121], v[146:147], v[136:137] op_sel:[0,0,0] op_sel_hi:[1,0,1]
    v_pk_fma_f32 v[138:139], v[120:121], v[146:147], v[138:139] op_sel:[0,1,0] op_sel_hi:[1,1,1]
    s_waitcnt vmcnt(0)
    v_lshlrev_b32 v140, 16, v84
    v_and_b32 v141, 0xffff0000, v84
    v_lshlrev_b32 v142, 16, v85
    v_and_b32 v143, 0xffff0000, v85
    v_lshlrev_b32 v144, 16, v86
    v_and_b32 v145, 0xffff0000, v86
    v_lshlrev_b32 v146, 16, v87
    v_and_b32 v147, 0xffff0000, v87
    v_pk_fma_f32 v[124:125], v[122:123], v[140:141], v[124:125] op_sel:[0,0,0] op_sel_hi:[1,0,1]
    v_pk_fma_f32 v[126:127], v[122:123], v[140:141], v[126:127] op_sel:[0,1,0] op_sel_hi:[1,1,1]
    v_pk_fma_f32 v[128:129], v[122:123], v[142:143], v[128:129] op_sel:[0,0,0] op_sel_hi:[1,0,1]
    v_pk_fma_f32 v[130:131], v[122:123], v[142:143], v[130:131] op_sel:[0,1,0] op_sel_hi:[1,1,1]
    v_pk_fma_f32 v[132:133], v[122:123], v[144:145], v[132:133] op_sel:[0,0,0] op_sel_hi:[1,0,1]
    v_pk_fma_f32 v[134:135], v[122:123], v[144:145], v[134:135] op_sel:[0,1,0] op_sel_hi:[1,1,1]
    v_pk_fma_f32 v[136:137], v[122:123], v[146:147], v[136:137] op_sel:[0,0,0] op_sel_hi:[1,0,1]
    v_pk_fma_f32 v[138:139], v[122:123], v[146:147], v[138:139] op_sel:[0,1,0] op_sel_hi:[1,1,1]
    s_nop 1
    v_permlane32_swap_b32 v124, v132
    v_permlane32_swap_b32 v125, v133
    v_permlane32_swap_b32 v126, v134
    v_permlane32_swap_b32 v127, v135
    v_permlane32_swap_b32 v128, v136
    v_permlane32_swap_b32 v129, v137
    v_permlane32_swap_b32 v130, v138
    v_permlane32_swap_b32 v131, v139
    v_add_f32 v124, v124, v132
    v_add_f32 v125, v125, v133
    v_add_f32 v126, v126, v134
    v_add_f32 v127, v127, v135
    v_add_f32 v128, v128, v136
    v_add_f32 v129, v129, v137
    v_add_f32 v130, v130, v138
    v_add_f32 v131, v131, v139
    s_nop 1
    v_permlane16_swap_b32 v124, v128
    v_permlane16_swap_b32 v125, v129
    v_permlane16_swap_b32 v126, v130
    v_permlane16_swap_b32 v127, v131
    v_add_f32 v128, v124, v128
    v_add_f32 v129, v125, v129
    v_add_f32 v130, v126, v130
    v_add_f32 v131, v127, v131
    s_nop 1
    v_add_f32_dpp v124, v128, v128 row_ror:8 row_mask:0xf bank_mask:0xf
    v_add_f32_dpp v125, v129, v129 row_ror:8 row_mask:0xf bank_mask:0xf
    v_add_f32_dpp v126, v130, v130 row_ror:8 row_mask:0xf bank_mask:0xf
    v_add_f32_dpp v127, v131, v131 row_ror:8 row_mask:0xf bank_mask:0xf
    ds_write_b128 v7, v[124:127] offset:9216
    s_waitcnt lgkmcnt(0)
    s_barrier
    s_cmp_lg_u32 s3, 0
    s_cbranch_scc1 gv_noredg
    ds_read_b64 v[124:125], v6 offset:9216
    ds_read_b64 v[126:127], v6 offset:9728
    ds_read_b64 v[128:129], v6 offset:10240
    ds_read_b64 v[130:131], v6 offset:10752
    ds_read_b64 v[132:133], v6 offset:11264
    ds_read_b64 v[134:135], v6 offset:11776
    ds_read_b64 v[136:137], v6 offset:12288
    ds_read_b64 v[138:139], v6 offset:12800
    s_waitcnt lgkmcnt(0)
    v_pk_add_f32 v[124:125], v[124:125], v[132:133]
    v_pk_add_f32 v[126:127], v[126:127], v[134:135]
    v_pk_add_f32 v[128:129], v[128:129], v[136:137]
    v_pk_add_f32 v[130:131], v[130:131], v[138:139]
    v_pk_add_f32 v[124:125], v[124:125], v[128:129]
    v_pk_add_f32 v[126:127], v[126:127], v[130:131]
    v_pk_add_f32 v[124:125], v[124:125], v[126:127]
    s_add_u32 s12, s62, 167936
    s_addc_u32 s13, s63, 0
    s_mov_b32 s14, 9216
    s_mov_b32 s15, 0x00020000
    s_lshl_b32 s28, s73, 8
    s_add_u32 s29, s28, 4608
    buffer_store_dword v124, v9, s[12:15], s28 offen sc1
    buffer_store_dword v125, v9, s[12:15], s29 offen sc1
    v_min_u32 v12, 11, v0
    v_and_b32 v13, 1, v12
    v_lshlrev_b32 v13, 7, v13
    v_lshl_add_u32 v12, v12, 2, v13
    s_mov_b32 s34, 131072
wi_52:
    global_load_dword v13, v12, s[60:61] sc1
    s_sub_u32 s34, s34, 1
    s_waitcnt vmcnt(0)
    v_cmp_ne_u32 vcc, 1, v13
    s_cmp_eq_u32 s34, 0
    s_cbranch_scc1 wid_53
    s_cmp_eq_u64 vcc, 0
    s_cbranch_scc1 wid_53
    s_sleep 3
    s_branch wi_52
wid_53:
    s_add_u32 s85, s73, 72
    s_lshl_b32 s27, s85, 7
    v_mov_b32 v12, 0
    v_mov_b32 v13, 1
    s_mov_b64 exec, 1
    buffer_store_dword v13, v12, s[36:39], s27 offen sc1
    s_mov_b64 exec, -1
gv_noredg:
    s_barrier
    s_add_u32 s73, s73, 1
    s_sub_u32 s72, s72, 1
    s_cmp_lg_u32 s72, 0
    s_cbranch_scc1 pb_gate
    s_mov_b64 exec, -1
    s_branch next_task
role_pf:
    s_sub_u32 s79, s67, 24
    s_lshl_b32 s79, s79, 3
    s_add_u32 s79, s79, s3
    s_mov_b32 s20, s52
    s_mov_b32 s21, s53
    s_mov_b32 s22, 5308416
    s_mov_b32 s23, 0x00020000
    v_lshlrev_b32 v8, 7, v0
    s_lshl_b32 s27, s79, 13
    buffer_load_dword v14, v8, s[20:23], s27 offen
    s_add_u32 s27, s27, 262144
    buffer_load_dword v14, v8, s[20:23], s27 offen
    s_add_u32 s27, s27, 262144
    buffer_load_dword v14, v8, s[20:23], s27 offen
    s_mov_b64 exec, -1
    s_branch next_task
side_x:
    s_and_b32 s85, s0, 15
    s_bfe_u32 s76, s0, 0x50004
    s_bfe_u32 s77, s0, 0x50009
    s_mov_b32 s20, s40
    s_mov_b32 s21, s41
    s_mov_b32 s22, 4718592
    s_mov_b32 s23, 0x00020000
    s_cmp_lg_u32 s85, 7
    s_cselect_b32 s22, 0, s22
    v_lshrrev_b32 v1, 2, v0
    s_mov_b32 s27, 2304
    v_mul_u32_u24 v1, s27, v1
    v_and_b32 v2, 3, v0
    v_lshl_add_u32 v1, v2, 4, v1
    s_sub_u32 s75, s3, 4
    s_lshl_b32 s27, s76, 2
    s_add_u32 s27, s27, s75
    s_mul_i32 s31, s27, 73728
    s_mul_i32 s28, s77, 192
    s_add_u32 s31, s31, s28
    s_mul_i32 s75, s75, 6144
    s_add_u32 m0, s75, 135168
    s_add_u32 s27, s31, 0
    buffer_load_dwordx4 v1, s[20:23], s27 offen lds
    s_add_u32 m0, s75, 136192
    s_add_u32 s27, s31, 36864
    buffer_load_dwordx4 v1, s[20:23], s27 offen lds
    s_add_u32 m0, s75, 137216
    s_add_u32 s27, s31, 64
    buffer_load_dwordx4 v1, s[20:23], s27 offen lds
    s_add_u32 m0, s75, 138240
    s_add_u32 s27, s31, 36928
    buffer_load_dwordx4 v1, s[20:23], s27 offen lds
    s_add_u32 m0, s75, 139264
    s_add_u32 s27, s31, 128
    buffer_load_dwordx4 v1, s[20:23], s27 offen lds
    s_add_u32 m0, s75, 140288
    s_add_u32 s27, s31, 36992
    buffer_load_dwordx4 v1, s[20:23], s27 offen lds
    s_setpc_b64 s[78:79]
side_g:
    s_and_b32 s85, s0, 15
    s_cmp_lg_u32 s85, 7
    s_cbranch_scc1 side_ret
    s_cmp_lg_u32 s3, 4
    s_cbranch_scc1 side_ret
    s_mov_b32 s85, 72
    v_min_u32 v252, 17, v0
    v_lshlrev_b32 v252, 7, v252
    s_lshl_b32 s27, s85, 7
    s_mov_b32 s34, 131072
    s_mov_b64 exec, 0x3ffff
poll_54:
    buffer_load_dword v253, v252, s[36:39], s27 offen sc1
    s_sub_u32 s34, s34, 1
    s_waitcnt vmcnt(0)
    v_cmp_ne_u32 vcc, 1, v253
    s_cmp_eq_u32 s34, 0
    s_cbranch_scc1 polled_55
    s_cmp_eq_u64 vcc, 0
    s_cbranch_scc1 polled_55
    s_sleep 3
    s_branch poll_54
polled_55:
    s_mov_b64 exec, -1
    s_add_u32 s20, s62, 167936
    s_addc_u32 s21, s63, 0
    s_mov_b32 s22, 9216
    s_mov_b32 s23, 0x00020000
    v_lshlrev_b32 v1, 4, v0
    s_lshr_b32 s76, s76, 3
    s_mul_i32 s27, s76, 4608
    s_mul_i32 s28, s77, 384
    s_add_u32 s27, s27, s28
    s_mov_b32 m0, 159744
    s_mov_b64 exec, 0xffffff
    buffer_load_dwordx4 v1, s[20:23], s27 offen sc1 lds
    s_mov_b64 exec, -1
side_ret:
    s_setpc_b64 s[78:79]
role_S:
    s_mov_b32 s70, s67
    s_lshr_b32 s66, s70, 3
    s_and_b32 s67, s70, 7
    s_lshl_b32 s69, s66, 3
    s_add_u32 s71, s69, s68
    s_lshl_b32 s24, s71, 13
    s_lshl_b32 s25, s70, 13
    s_lshl_b32 s75, s68, 2
    s_lshl_b32 s76, s67, 3
    s_lshl_b32 s77, s66, 21
    s_lshl_b32 s72, s70, 3
    s_add_u32 s72, s72, s68
    s_add_u32 s72, s72, 511
    s_add_u32 s4, s62, 311296
    s_addc_u32 s5, s63, 0
    s_mov_b32 s6, 4718592
    s_mov_b32 s7, 0x00020000
    s_add_u32 s8, s62, 10338304
    s_addc_u32 s9, s63, 0
    s_mov_b32 s10, 4718592
    s_mov_b32 s11, 0x00020000
    s_add_u32 s12, s62, 19775488
    s_addc_u32 s13, s63, 0
    s_mov_b32 s14, 4194304
    s_mov_b32 s15, 0x00020000
    s_add_u32 s16, s62, 180224
    s_addc_u32 s17, s63, 0
    s_mov_b32 s18, 131072
    s_mov_b32 s19, 0x00020000
    s_cmp_ge_u32 s3, 4
    s_cbranch_scc1 ss_loader_56
    s_and_b32 s84, s3, 3
    s_lshr_b32 s83, s3, 2
    s_mul_i32 s27, s83, 8192
    s_add_u32 s27, s27, 0
    v_lshlrev_b32 v4, 4, v0
    v_add_u32 v4, s27, v4
    s_mul_i32 s27, s84, 2048
    s_add_u32 s27, s27, 49152
    v_lshlrev_b32 v5, 4, v0
    v_add_u32 v5, s27, v5
    v_mov_b32 v16, 0
    v_mov_b32 v17, 0
    v_mov_b32 v18, 0
    v_mov_b32 v19, 0
    v_mov_b32 v20, 0
    v_mov_b32 v21, 0
    v_mov_b32 v22, 0
    v_mov_b32 v23, 0
    v_mov_b32 v24, 0
    v_mov_b32 v25, 0
    v_mov_b32 v26, 0
    v_mov_b32 v27, 0
    v_mov_b32 v28, 0
    v_mov_b32 v29, 0
    v_mov_b32 v30, 0
    v_mov_b32 v31, 0
    v_mov_b32 v32, 0
    v_mov_b32 v33, 0
    v_mov_b32 v34, 0
    v_mov_b32 v35, 0
    v_mov_b32 v36, 0
    v_mov_b32 v37, 0
    v_mov_b32 v38, 0
    v_mov_b32 v39, 0
    v_mov_b32 v40, 0
    v_mov_b32 v41, 0
    v_mov_b32 v42, 0
    v_mov_b32 v43, 0
    v_mov_b32 v44, 0
    v_mov_b32 v45, 0
    v_mov_b32 v46, 0
    v_mov_b32 v47, 0
    v_mov_b32 v48, 0
    v_mov_b32 v49, 0
    v_mov_b32 v50, 0
    v_mov_b32 v51, 0
    v_mov_b32 v52, 0
    v_mov_b32 v53, 0
    v_mov_b32 v54, 0
    v_mov_b32 v55, 0
    v_mov_b32 v56, 0
    v_mov_b32 v57, 0
    v_mov_b32 v58, 0
    v_mov_b32 v59, 0
    v_mov_b32 v60, 0
    v_mov_b32 v61, 0
    v_mov_b32 v62, 0
    v_mov_b32 v63, 0
    v_mov_b32 v64, 0
    v_mov_b32 v65, 0
    v_mov_b32 v66, 0
    v_mov_b32 v67, 0
    v_mov_b32 v68, 0
    v_mov_b32 v69, 0
    v_mov_b32 v70, 0
    v_mov_b32 v71, 0
    v_mov_b32 v72, 0
    v_mov_b32 v73, 0
    v_mov_b32 v74, 0
    v_mov_b32 v75, 0
    v_mov_b32 v76, 0
    v_mov_b32 v77, 0
    v_mov_b32 v78, 0
    v_mov_b32 v79, 0
    s_mov_b32 s33, 0
    s_mov_b32 s31, 0
    s_mov_b32 s30, 16384
    s_mov_b32 s32, 16384
    s_mov_b32 s34, 17
    s_barrier
    ds_read_b128 v[112:115], v5 offset:0
    ds_read_b128 v[116:119], v5 offset:1024
    ds_read_b128 v[80:83], v4 offset:0
    ds_read_b128 v[84:87], v4 offset:1024
    ds_read_b128 v[88:91], v4 offset:2048
    ds_read_b128 v[92:95], v4 offset:3072
    ds_read_b128 v[96:99], v4 offset:4096
    ds_read_b128 v[100:103], v4 offset:5120
    ds_read_b128 v[104:107], v4 offset:6144
    ds_read_b128 v[108:111], v4 offset:7168
    s_waitcnt lgkmcnt(0)
ss_mm_58:
    v_mfma_f32_16x16x32_bf16 v[16:19], v[80:83], v[112:115], v[16:19]
    ds_read_b128 v[152:155], v5 offset:8192
    v_mfma_f32_16x16x32_bf16 v[20:23], v[80:83], v[116:119], v[20:23]
    ds_read_b128 v[156:159], v5 offset:9216
    v_mfma_f32_16x16x32_bf16 v[24:27], v[84:87], v[112:115], v[24:27]
    ds_read_b128 v[120:123], v4 offset:8192
    v_mfma_f32_16x16x32_bf16 v[28:31], v[84:87], v[116:119], v[28:31]
    ds_read_b128 v[124:127], v4 offset:9216
    v_mfma_f32_16x16x32_bf16 v[32:35], v[88:91], v[112:115], v[32:35]
    ds_read_b128 v[128:131], v4 offset:10240
    v_mfma_f32_16x16x32_bf16 v[36:39], v[88:91], v[116:119], v[36:39]
    ds_read_b128 v[132:135], v4 offset:11264
    v_mfma_f32_16x16x32_bf16 v[40:43], v[92:95], v[112:115], v[40:43]
    ds_read_b128 v[136:139], v4 offset:12288
    v_mfma_f32_16x16x32_bf16 v[44:47], v[92:95], v[116:119], v[44:47]
    ds_read_b128 v[140:143], v4 offset:13312
    v_mfma_f32_16x16x32_bf16 v[48:51], v[96:99], v[112:115], v[48:51]
    ds_read_b128 v[144:147], v4 offset:14336
    v_mfma_f32_16x16x32_bf16 v[52:55], v[96:99], v[116:119], v[52:55]
    ds_read_b128 v[148:151], v4 offset:15360
    v_mfma_f32_16x16x32_bf16 v[56:59], v[100:103], v[112:115], v[56:59]
    s_add_u32 s33, s33, 1
    v_mfma_f32_16x16x32_bf16 v[60:63], v[100:103], v[116:119], v[60:63]
    s_cmp_eq_u32 s33, 3
    v_mfma_f32_16x16x32_bf16 v[64:67], v[104:107], v[112:115], v[64:67]
    s_cselect_b32 s35, 4294934528, s30
    v_mfma_f32_16x16x32_bf16 v[68:71], v[104:107], v[116:119], v[68:71]
    s_cselect_b32 s29, 4294934528, s32
    v_mfma_f32_16x16x32_bf16 v[72:75], v[108:111], v[112:115], v[72:75]
    s_cselect_b32 s33, 0, s33
    v_mfma_f32_16x16x32_bf16 v[76:79], v[108:111], v[116:119], v[76:79]
    v_add_u32 v4, s35, v4
    v_add_u32 v5, s29, v5
    s_waitcnt lgkmcnt(0)
    s_barrier
    v_mfma_f32_16x16x32_bf16 v[16:19], v[120:123], v[152:155], v[16:19]
    ds_read_b128 v[112:115], v5 offset:0
    v_mfma_f32_16x16x32_bf16 v[20:23], v[120:123], v[156:159], v[20:23]
    ds_read_b128 v[116:119], v5 offset:1024
    v_mfma_f32_16x16x32_bf16 v[24:27], v[124:127], v[152:155], v[24:27]
    ds_read_b128 v[80:83], v4 offset:0
    v_mfma_f32_16x16x32_bf16 v[28:31], v[124:127], v[156:159], v[28:31]
    ds_read_b128 v[84:87], v4 offset:1024
    v_mfma_f32_16x16x32_bf16 v[32:35], v[128:131], v[152:155], v[32:35]
    ds_read_b128 v[88:91], v4 offset:2048
    v_mfma_f32_16x16x32_bf16 v[36:39], v[128:131], v[156:159], v[36:39]
    ds_read_b128 v[92:95], v4 offset:3072
    v_mfma_f32_16x16x32_bf16 v[40:43], v[132:135], v[152:155], v[40:43]
    ds_read_b128 v[96:99], v4 offset:4096
    v_mfma_f32_16x16x32_bf16 v[44:47], v[132:135], v[156:159], v[44:47]
    ds_read_b128 v[100:103], v4 offset:5120
    v_mfma_f32_16x16x32_bf16 v[48:51], v[136:139], v[152:155], v[48:51]
    ds_read_b128 v[104:107], v4 offset:6144
    v_mfma_f32_16x16x32_bf16 v[52:55], v[136:139], v[156:159], v[52:55]
    ds_read_b128 v[108:111], v4 offset:7168
    v_mfma_f32_16x16x32_bf16 v[56:59], v[140:143], v[152:155], v[56:59]
    s_sub_u32 s34, s34, 1
    v_mfma_f32_16x16x32_bf16 v[60:63], v[140:143], v[156:159], v[60:63]
    s_cmp_lg_u32 s34, 0
    v_mfma_f32_16x16x32_bf16 v[64:67], v[144:147], v[152:155], v[64:67]
    v_mfma_f32_16x16x32_bf16 v[68:71], v[144:147], v[156:159], v[68:71]
    v_mfma_f32_16x16x32_bf16 v[72:75], v[148:151], v[152:155], v[72:75]
    v_mfma_f32_16x16x32_bf16 v[76:79], v[148:151], v[156:159], v[76:79]
    s_waitcnt lgkmcnt(0)
    s_cbranch_scc1 ss_mm_58
    v_mfma_f32_16x16x32_bf16 v[16:19], v[80:83], v[112:115], v[16:19]
    ds_read_b128 v[152:155], v5 offset:8192
    v_mfma_f32_16x16x32_bf16 v[20:23], v[80:83], v[116:119], v[20:23]
    ds_read_b128 v[156:159], v5 offset:9216
    v_mfma_f32_16x16x32_bf16 v[24:27], v[84:87], v[112:115], v[24:27]
    ds_read_b128 v[120:123], v4 offset:8192
    v_mfma_f32_16x16x32_bf16 v[28:31], v[84:87], v[116:119], v[28:31]
    ds_read_b128 v[124:127], v4 offset:9216
    v_mfma_f32_16x16x32_bf16 v[32:35], v[88:91], v[112:115], v[32:35]
    ds_read_b128 v[128:131], v4 offset:10240
    v_mfma_f32_16x16x32_bf16 v[36:39], v[88:91], v[116:119], v[36:39]
    ds_read_b128 v[132:135], v4 offset:11264
    v_mfma_f32_16x16x32_bf16 v[40:43], v[92:95], v[112:115], v[40:43]
    ds_read_b128 v[136:139], v4 offset:12288
    v_mfma_f32_16x16x32_bf16 v[44:47], v[92:95], v[116:119], v[44:47]
    ds_read_b128 v[140:143], v4 offset:13312
    v_mfma_f32_16x16x32_bf16 v[48:51], v[96:99], v[112:115], v[48:51]
    ds_read_b128 v[144:147], v4 offset:14336
    v_mfma_f32_16x16x32_bf16 v[52:55], v[96:99], v[116:119], v[52:55]
    ds_read_b128 v[148:151], v4 offset:15360
    v_mfma_f32_16x16x32_bf16 v[56:59], v[100:103], v[112:115], v[56:59]
    v_mfma_f32_16x16x32_bf16 v[60:63], v[100:103], v[116:119], v[60:63]
    v_mfma_f32_16x16x32_bf16 v[64:67], v[104:107], v[112:115], v[64:67]
    v_mfma_f32_16x16x32_bf16 v[68:71], v[104:107], v[116:119], v[68:71]
    v_mfma_f32_16x16x32_bf16 v[72:75], v[108:111], v[112:115], v[72:75]
    v_mfma_f32_16x16x32_bf16 v[76:79], v[108:111], v[116:119], v[76:79]
    s_waitcnt lgkmcnt(0)
    v_mfma_f32_16x16x32_bf16 v[16:19], v[120:123], v[152:155], v[16:19]
    v_mfma_f32_16x16x32_bf16 v[20:23], v[120:123], v[156:159], v[20:23]
    v_mfma_f32_16x16x32_bf16 v[24:27], v[124:127], v[152:155], v[24:27]
    v_mfma_f32_16x16x32_bf16 v[28:31], v[124:127], v[156:159], v[28:31]
    v_mfma_f32_16x16x32_bf16 v[32:35], v[128:131], v[152:155], v[32:35]
    v_mfma_f32_16x16x32_bf16 v[36:39], v[128:131], v[156:159], v[36:39]
    v_mfma_f32_16x16x32_bf16 v[40:43], v[132:135], v[152:155], v[40:43]
    v_mfma_f32_16x16x32_bf16 v[44:47], v[132:135], v[156:159], v[44:47]
    v_mfma_f32_16x16x32_bf16 v[48:51], v[136:139], v[152:155], v[48:51]
    v_mfma_f32_16x16x32_bf16 v[52:55], v[136:139], v[156:159], v[52:55]
    v_mfma_f32_16x16x32_bf16 v[56:59], v[140:143], v[152:155], v[56:59]
    v_mfma_f32_16x16x32_bf16 v[60:63], v[140:143], v[156:159], v[60:63]
    v_mfma_f32_16x16x32_bf16 v[64:67], v[144:147], v[152:155], v[64:67]
    v_mfma_f32_16x16x32_bf16 v[68:71], v[144:147], v[156:159], v[68:71]
    v_mfma_f32_16x16x32_bf16 v[72:75], v[148:151], v[152:155], v[72:75]
    v_mfma_f32_16x16x32_bf16 v[76:79], v[148:151], v[156:159], v[76:79]
    s_mov_b32 s78, 0x3d2e1a93
    s_mov_b32 s79, 0x3f803f80
    s_lshl_b32 s27, s75, 6
    s_add_u32 s27, s27, s76
    s_lshl_b32 s28, s84, 1
    s_add_u32 s27, s27, s28
    s_lshl_b32 s26, s27, 10
    s_add_u32 s26, s26, s77
    v_lshlrev_b32 v1, 4, v0
    v_mov_b32 v168, s79
    v_mov_b32 v169, s79
    v_mov_b32 v170, s79
    v_mov_b32 v171, s79
    v_mov_b32 v180, s78
    v_mov_b32 v181, s78
    v_max3_f32 v160, v16, v17, v18
    v_max3_f32 v164, v19, v24, v25
    v_max3_f32 v160, v160, v26, v27
    v_max3_f32 v164, v164, v32, v33
    v_max3_f32 v160, v160, v34, v35
    v_max3_f32 v164, v164, v40, v41
    v_max3_f32 v160, v160, v42, v43
    v_max3_f32 v164, v164, v48, v49
    v_max3_f32 v160, v160, v50, v51
    v_max3_f32 v164, v164, v56, v57
    v_max3_f32 v160, v160, v58, v59
    v_max3_f32 v164, v164, v64, v65
    v_max3_f32 v160, v160, v66, v67
    v_max3_f32 v164, v164, v72, v73
    v_max3_f32 v160, v160, v74, v75
    v_max_f32 v160, v160, v164
    v_max3_f32 v161, v20, v21, v22
    v_max3_f32 v165, v23, v28, v29
    v_max3_f32 v161, v161, v30, v31
    v_max3_f32 v165, v165, v36, v37
    v_max3_f32 v161, v161, v38, v39
    v_max3_f32 v165, v165, v44, v45
    v_max3_f32 v161, v161, v46, v47
    v_max3_f32 v165, v165, v52, v53
    v_max3_f32 v161, v161, v54, v55
    v_max3_f32 v165, v165, v60, v61
    v_max3_f32 v161, v161, v62, v63
    v_max3_f32 v165, v165, v68, v69
    v_max3_f32 v161, v161, v70, v71
    v_max3_f32 v165, v165, v76, v77
    v_max3_f32 v161, v161, v78, v79
    v_max_f32 v161, v161, v165
    v_mov_b32 v164, v160
    v_mov_b32 v165, v161
    s_nop 0
    v_permlane32_swap_b32 v160, v164
    v_permlane32_swap_b32 v161, v165
    s_nop 0
    v_max_f32 v160, v160, v164
    v_max_f32 v161, v161, v165
    v_mov_b32 v164, v160
    v_mov_b32 v165, v161
    s_nop 0
    v_permlane16_swap_b32 v160, v164
    v_permlane16_swap_b32 v161, v165
    s_nop 0
    v_max_f32 v160, v160, v164
    v_max_f32 v161, v161, v165
    v_mul_f32 v160, s78, v160
    v_mul_f32 v161, s78, v161
    v_pk_fma_f32 v[16:17], v[16:17], v[180:181], v[160:161] op_sel:[0,0,0] op_sel_hi:[1,1,0] neg_lo:[0,0,1] neg_hi:[0,0,1]
    v_pk_fma_f32 v[18:19], v[18:19], v[180:181], v[160:161] op_sel:[0,0,0] op_sel_hi:[1,1,0] neg_lo:[0,0,1] neg_hi:[0,0,1]
    v_pk_fma_f32 v[24:25], v[24:25], v[180:181], v[160:161] op_sel:[0,0,0] op_sel_hi:[1,1,0] neg_lo:[0,0,1] neg_hi:[0,0,1]
    v_pk_fma_f32 v[26:27], v[26:27], v[180:181], v[160:161] op_sel:[0,0,0] op_sel_hi:[1,1,0] neg_lo:[0,0,1] neg_hi:[0,0,1]
    v_exp_f32 v16, v16
    v_exp_f32 v17, v17
    v_exp_f32 v18, v18
    v_exp_f32 v19, v19
    v_exp_f32 v24, v24
    v_exp_f32 v25, v25
    v_exp_f32 v26, v26
    v_exp_f32 v27, v27
    s_add_u32 s27, s26, 0
    v_cvt_pk_bf16_f32 v80, v16, v17
    v_cvt_pk_bf16_f32 v81, v18, v19
    v_cvt_pk_bf16_f32 v82, v24, v25
    v_cvt_pk_bf16_f32 v83, v26, v27
    buffer_store_dwordx4 v[80:83], v1, s[12:15], s27 offen offset:0 sc1
    v_pk_fma_f32 v[20:21], v[20:21], v[180:181], v[160:161] op_sel:[0,0,1] op_sel_hi:[1,1,1] neg_lo:[0,0,1] neg_hi:[0,0,1]
    v_pk_fma_f32 v[22:23], v[22:23], v[180:181], v[160:161] op_sel:[0,0,1] op_sel_hi:[1,1,1] neg_lo:[0,0,1] neg_hi:[0,0,1]
    v_pk_fma_f32 v[28:29], v[28:29], v[180:181], v[160:161] op_sel:[0,0,1] op_sel_hi:[1,1,1] neg_lo:[0,0,1] neg_hi:[0,0,1]
    v_pk_fma_f32 v[30:31], v[30:31], v[180:181], v[160:161] op_sel:[0,0,1] op_sel_hi:[1,1,1] neg_lo:[0,0,1] neg_hi:[0,0,1]
    v_mfma_f32_16x16x32_bf16 v[172:175], v[168:171], v[80:83], 0
    v_exp_f32 v20, v20
    v_exp_f32 v21, v21
    v_exp_f32 v22, v22
    v_exp_f32 v23, v23
    v_exp_f32 v28, v28
    v_exp_f32 v29, v29
    v_exp_f32 v30, v30
    v_exp_f32 v31, v31
    s_add_u32 s27, s26, 0
    v_cvt_pk_bf16_f32 v84, v20, v21
    v_cvt_pk_bf16_f32 v85, v22, v23
    v_cvt_pk_bf16_f32 v86, v28, v29
    v_cvt_pk_bf16_f32 v87, v30, v31
    buffer_store_dwordx4 v[84:87], v1, s[12:15], s27 offen offset:1024 sc1
    v_pk_fma_f32 v[32:33], v[32:33], v[180:181], v[160:161] op_sel:[0,0,0] op_sel_hi:[1,1,0] neg_lo:[0,0,1] neg_hi:[0,0,1]
    v_pk_fma_f32 v[34:35], v[34:35], v[180:181], v[160:161] op_sel:[0,0,0] op_sel_hi:[1,1,0] neg_lo:[0,0,1] neg_hi:[0,0,1]
    v_pk_fma_f32 v[40:41], v[40:41], v[180:181], v[160:161] op_sel:[0,0,0] op_sel_hi:[1,1,0] neg_lo:[0,0,1] neg_hi:[0,0,1]
    v_pk_fma_f32 v[42:43], v[42:43], v[180:181], v[160:161] op_sel:[0,0,0] op_sel_hi:[1,1,0] neg_lo:[0,0,1] neg_hi:[0,0,1]
    v_mfma_f32_16x16x32_bf16 v[176:179], v[168:171], v[84:87], 0
    v_exp_f32 v32, v32
    v_exp_f32 v33, v33
    v_exp_f32 v34, v34
    v_exp_f32 v35, v35
    v_exp_f32 v40, v40
    v_exp_f32 v41, v41
    v_exp_f32 v42, v42
    v_exp_f32 v43, v43
    s_add_u32 s27, s26, 65536
    v_cvt_pk_bf16_f32 v88, v32, v33
    v_cvt_pk_bf16_f32 v89, v34, v35
    v_cvt_pk_bf16_f32 v90, v40, v41
    v_cvt_pk_bf16_f32 v91, v42, v43
    buffer_store_dwordx4 v[88:91], v1, s[12:15], s27 offen offset:0 sc1
    v_pk_fma_f32 v[36:37], v[36:37], v[180:181], v[160:161] op_sel:[0,0,1] op_sel_hi:[1,1,1] neg_lo:[0,0,1] neg_hi:[0,0,1]
    v_pk_fma_f32 v[38:39], v[38:39], v[180:181], v[160:161] op_sel:[0,0,1] op_sel_hi:[1,1,1] neg_lo:[0,0,1] neg_hi:[0,0,1]
    v_pk_fma_f32 v[44:45], v[44:45], v[180:181], v[160:161] op_sel:[0,0,1] op_sel_hi:[1,1,1] neg_lo:[0,0,1] neg_hi:[0,0,1]
    v_pk_fma_f32 v[46:47], v[46:47], v[180:181], v[160:161] op_sel:[0,0,1] op_sel_hi:[1,1,1] neg_lo:[0,0,1] neg_hi:[0,0,1]
    v_mfma_f32_16x16x32_bf16 v[172:175], v[168:171], v[88:91], v[172:175]
    v_exp_f32 v36, v36
    v_exp_f32 v37, v37
    v_exp_f32 v38, v38
    v_exp_f32 v39, v39
    v_exp_f32 v44, v44
    v_exp_f32 v45, v45
    v_exp_f32 v46, v46
    v_exp_f32 v47, v47
    s_add_u32 s27, s26, 65536
    v_cvt_pk_bf16_f32 v92, v36, v37
    v_cvt_pk_bf16_f32 v93, v38, v39
    v_cvt_pk_bf16_f32 v94, v44, v45
    v_cvt_pk_bf16_f32 v95, v46, v47
    buffer_store_dwordx4 v[92:95], v1, s[12:15], s27 offen offset:1024 sc1
    v_pk_fma_f32 v[48:49], v[48:49], v[180:181], v[160:161] op_sel:[0,0,0] op_sel_hi:[1,1,0] neg_lo:[0,0,1] neg_hi:[0,0,1]
    v_pk_fma_f32 v[50:51], v[50:51], v[180:181], v[160:161] op_sel:[0,0,0] op_sel_hi:[1,1,0] neg_lo:[0,0,1] neg_hi:[0,0,1]
    v_pk_fma_f32 v[56:57], v[56:57], v[180:181], v[160:161] op_sel:[0,0,0] op_sel_hi:[1,1,0] neg_lo:[0,0,1] neg_hi:[0,0,1]
    v_pk_fma_f32 v[58:59], v[58:59], v[180:181], v[160:161] op_sel:[0,0,0] op_sel_hi:[1,1,0] neg_lo:[0,0,1] neg_hi:[0,0,1]
    v_mfma_f32_16x16x32_bf16 v[176:179], v[168:171], v[92:95], v[176:179]
    v_exp_f32 v48, v48
    v_exp_f32 v49, v49
    v_exp_f32 v50, v50
    v_exp_f32 v51, v51
    v_exp_f32 v56, v56
    v_exp_f32 v57, v57
    v_exp_f32 v58, v58
    v_exp_f32 v59, v59
    s_add_u32 s27, s26, 131072
    v_cvt_pk_bf16_f32 v96, v48, v49
    v_cvt_pk_bf16_f32 v97, v50, v51
    v_cvt_pk_bf16_f32 v98, v56, v57
    v_cvt_pk_bf16_f32 v99, v58, v59
    buffer_store_dwordx4 v[96:99], v1, s[12:15], s27 offen offset:0 sc1
    v_pk_fma_f32 v[52:53], v[52:53], v[180:181], v[160:161] op_sel:[0,0,1] op_sel_hi:[1,1,1] neg_lo:[0,0,1] neg_hi:[0,0,1]
    v_pk_fma_f32 v[54:55], v[54:55], v[180:181], v[160:161] op_sel:[0,0,1] op_sel_hi:[1,1,1] neg_lo:[0,0,1] neg_hi:[0,0,1]
    v_pk_fma_f32 v[60:61], v[60:61], v[180:181], v[160:161] op_sel:[0,0,1] op_sel_hi:[1,1,1] neg_lo:[0,0,1] neg_hi:[0,0,1]
    v_pk_fma_f32 v[62:63], v[62:63], v[180:181], v[160:161] op_sel:[0,0,1] op_sel_hi:[1,1,1] neg_lo:[0,0,1] neg_hi:[0,0,1]
    v_mfma_f32_16x16x32_bf16 v[172:175], v[168:171], v[96:99], v[172:175]
    v_exp_f32 v52, v52
    v_exp_f32 v53, v53
    v_exp_f32 v54, v54
    v_exp_f32 v55, v55
    v_exp_f32 v60, v60
    v_exp_f32 v61, v61
    v_exp_f32 v62, v62
    v_exp_f32 v63, v63
    s_add_u32 s27, s26, 131072
    v_cvt_pk_bf16_f32 v100, v52, v53
    v_cvt_pk_bf16_f32 v101, v54, v55
    v_cvt_pk_bf16_f32 v102, v60, v61
    v_cvt_pk_bf16_f32 v103, v62, v63
    buffer_store_dwordx4 v[100:103], v1, s[12:15], s27 offen offset:1024 sc1
    v_pk_fma_f32 v[64:65], v[64:65], v[180:181], v[160:161] op_sel:[0,0,0] op_sel_hi:[1,1,0] neg_lo:[0,0,1] neg_hi:[0,0,1]
    v_pk_fma_f32 v[66:67], v[66:67], v[180:181], v[160:161] op_sel:[0,0,0] op_sel_hi:[1,1,0] neg_lo:[0,0,1] neg_hi:[0,0,1]
    v_pk_fma_f32 v[72:73], v[72:73], v[180:181], v[160:161] op_sel:[0,0,0] op_sel_hi:[1,1,0] neg_lo:[0,0,1] neg_hi:[0,0,1]
    v_pk_fma_f32 v[74:75], v[74:75], v[180:181], v[160:161] op_sel:[0,0,0] op_sel_hi:[1,1,0] neg_lo:[0,0,1] neg_hi:[0,0,1]
    v_mfma_f32_16x16x32_bf16 v[176:179], v[168:171], v[100:103], v[176:179]
    v_exp_f32 v64, v64
    v_exp_f32 v65, v65
    v_exp_f32 v66, v66
    v_exp_f32 v67, v67
    v_exp_f32 v72, v72
    v_exp_f32 v73, v73
    v_exp_f32 v74, v74
    v_exp_f32 v75, v75
    s_add_u32 s27, s26, 196608
    v_cvt_pk_bf16_f32 v104, v64, v65
    v_cvt_pk_bf16_f32 v105, v66, v67
    v_cvt_pk_bf16_f32 v106, v72, v73
    v_cvt_pk_bf16_f32 v107, v74, v75
    buffer_store_dwordx4 v[104:107], v1, s[12:15], s27 offen offset:0 sc1
    v_pk_fma_f32 v[68:69], v[68:69], v[180:181], v[160:161] op_sel:[0,0,1] op_sel_hi:[1,1,1] neg_lo:[0,0,1] neg_hi:[0,0,1]
    v_pk_fma_f32 v[70:71], v[70:71], v[180:181], v[160:161] op_sel:[0,0,1] op_sel_hi:[1,1,1] neg_lo:[0,0,1] neg_hi:[0,0,1]
    v_pk_fma_f32 v[76:77], v[76:77], v[180:181], v[160:161] op_sel:[0,0,1] op_sel_hi:[1,1,1] neg_lo:[0,0,1] neg_hi:[0,0,1]
    v_pk_fma_f32 v[78:79], v[78:79], v[180:181], v[160:161] op_sel:[0,0,1] op_sel_hi:[1,1,1] neg_lo:[0,0,1] neg_hi:[0,0,1]
    v_mfma_f32_16x16x32_bf16 v[172:175], v[168:171], v[104:107], v[172:175]
    v_exp_f32 v68, v68
    v_exp_f32 v69, v69
    v_exp_f32 v70, v70
    v_exp_f32 v71, v71
    v_exp_f32 v76, v76
    v_exp_f32 v77, v77
    v_exp_f32 v78, v78
    v_exp_f32 v79, v79
    s_add_u32 s27, s26, 196608
    v_cvt_pk_bf16_f32 v108, v68, v69
    v_cvt_pk_bf16_f32 v109, v70, v71
    v_cvt_pk_bf16_f32 v110, v76, v77
    v_cvt_pk_bf16_f32 v111, v78, v79
    buffer_store_dwordx4 v[108:111], v1, s[12:15], s27 offen offset:1024 sc1
    s_nop 0
    v_mfma_f32_16x16x32_bf16 v[176:179], v[168:171], v[108:111], v[176:179]
    s_lshl_b32 s27, s70, 2
    s_add_u32 s27, s27, s84
    s_lshl_b32 s27, s27, 3
    s_add_u32 s27, s27, s68
    s_lshl_b32 s27, s27, 8
    v_mov_b32 v162, v172
    s_nop 1
    v_mov_b32 v163, v176
    s_mov_b64 exec, 0xffff
    buffer_store_dwordx4 v[160:163], v1, s[16:19], s27 offen sc1
    s_mov_b64 exec, -1
    s_mov_b64 exec, -1
    s_lshl_b32 s27, s72, 7
    v_mov_b32 v8, 0
    v_mov_b32 v9, 1
    s_cmp_lg_u32 s3, 0
    s_waitcnt vmcnt(0)
    s_barrier
    s_cbranch_scc1 sig_59
    s_mov_b64 exec, 1
    buffer_store_dword v9, v8, s[36:39], s27 offen sc1
    s_mov_b64 exec, -1
sig_59:
ss_exit_60:
    s_mov_b64 exec, -1
    s_branch next_task
ss_loader_56:
    s_and_b32 s82, s3, 1
    s_cmp_ge_u32 s3, 6
    s_cbranch_scc1 ss_loaderB_57
    v_lshlrev_b32 v1, 4, v0
    s_mul_i32 s31, s82, 131072
    s_add_u32 s31, s31, s24
    s_mul_i32 s32, s82, 8192
    s_add_u32 s32, s32, 0
    s_mul_i32 s85, s71, 4
    s_add_u32 s85, s85, 90
    v_min_u32 v252, 3, v0
    v_lshlrev_b32 v252, 7, v252
    s_lshl_b32 s27, s85, 7
    s_mov_b32 s34, 131072
    s_mov_b64 exec, 0xf
poll_61:
    buffer_load_dword v253, v252, s[36:39], s27 offen sc1
    s_sub_u32 s34, s34, 1
    s_waitcnt vmcnt(0)
    v_cmp_ne_u32 vcc, 1, v253
    s_cmp_eq_u32 s34, 0
    s_cbranch_scc1 polled_62
    s_cmp_eq_u64 vcc, 0
    s_cbranch_scc1 polled_62
    s_sleep 3
    s_branch poll_61
polled_62:
    s_mov_b64 exec, -1
    s_mov_b32 m0, s32
    s_nop 0
    buffer_load_dwordx4 v1, s[4:7], s31 offen sc1 lds
    buffer_load_dwordx4 v1, s[4:7], s31 offen offset:1024 sc1 lds
    buffer_load_dwordx4 v1, s[4:7], s31 offen offset:2048 sc1 lds
    buffer_load_dwordx4 v1, s[4:7], s31 offen offset:3072 sc1 lds
    s_add_u32 m0, s32, 4096
    s_add_u32 s27, s31, 4096
    buffer_load_dwordx4 v1, s[4:7], s27 offen sc1 lds
    buffer_load_dwordx4 v1, s[4:7], s27 offen offset:1024 sc1 lds
    buffer_load_dwordx4 v1, s[4:7], s27 offen offset:2048 sc1 lds
    buffer_load_dwordx4 v1, s[4:7], s27 offen offset:3072 sc1 lds
    s_add_u32 s31, s31, 262144
    s_add_u32 m0, s32, 16384
    s_nop 0
    buffer_load_dwordx4 v1, s[4:7], s31 offen sc1 lds
    buffer_load_dwordx4 v1, s[4:7], s31 offen offset:1024 sc1 lds
    buffer_load_dwordx4 v1, s[4:7], s31 offen offset:2048 sc1 lds
    buffer_load_dwordx4 v1, s[4:7], s31 offen offset:3072 sc1 lds
    s_add_u32 m0, s32, 20480
    s_add_u32 s27, s31, 4096
    buffer_load_dwordx4 v1, s[4:7], s27 offen sc1 lds
    buffer_load_dwordx4 v1, s[4:7], s27 offen offset:1024 sc1 lds
    buffer_load_dwordx4 v1, s[4:7], s27 offen offset:2048 sc1 lds
    buffer_load_dwordx4 v1, s[4:7], s27 offen offset:3072 sc1 lds
    s_add_u32 s31, s31, 262144
    s_add_u32 m0, s32, 32768
    s_nop 0
    buffer_load_dwordx4 v1, s[4:7], s31 offen sc1 lds
    buffer_load_dwordx4 v1, s[4:7], s31 offen offset:1024 sc1 lds
    buffer_load_dwordx4 v1, s[4:7], s31 offen offset:2048 sc1 lds
    buffer_load_dwordx4 v1, s[4:7], s31 offen offset:3072 sc1 lds
    s_add_u32 m0, s32, 36864
    s_add_u32 s27, s31, 4096
    buffer_load_dwordx4 v1, s[4:7], s27 offen sc1 lds
    buffer_load_dwordx4 v1, s[4:7], s27 offen offset:1024 sc1 lds
    buffer_load_dwordx4 v1, s[4:7], s27 offen offset:2048 sc1 lds
    buffer_load_dwordx4 v1, s[4:7], s27 offen offset:3072 sc1 lds
    s_add_u32 s31, s31, 262144
    s_waitcnt vmcnt(16)
    s_barrier
    s_mov_b32 s33, 0
    s_mov_b32 s34, 15
ss_ld_63:
    s_waitcnt vmcnt(8)
    s_barrier
    s_add_u32 s28, s32, s33
    s_mov_b32 m0, s28
    s_nop 0
    buffer_load_dwordx4 v1, s[4:7], s31 offen sc1 lds
    buffer_load_dwordx4 v1, s[4:7], s31 offen offset:1024 sc1 lds
    buffer_load_dwordx4 v1, s[4:7], s31 offen offset:2048 sc1 lds
    buffer_load_dwordx4 v1, s[4:7], s31 offen offset:3072 sc1 lds
    s_add_u32 m0, s28, 4096
    s_add_u32 s27, s31, 4096
    buffer_load_dwordx4 v1, s[4:7], s27 offen sc1 lds
    buffer_load_dwordx4 v1, s[4:7], s27 offen offset:1024 sc1 lds
    buffer_load_dwordx4 v1, s[4:7], s27 offen offset:2048 sc1 lds
    buffer_load_dwordx4 v1, s[4:7], s27 offen offset:3072 sc1 lds
    s_add_u32 s31, s31, 262144
    s_add_u32 s33, s33, 16384
    s_cmp_eq_u32 s33, 49152
    s_cselect_b32 s33, 0, s33
    s_sub_u32 s34, s34, 1
    s_cmp_lg_u32 s34, 0
    s_cbranch_scc1 ss_ld_63
    s_call_b64 s[78:79], side_x
    s_waitcnt vmcnt(14)
    s_barrier
    s_waitcnt vmcnt(6)
    s_barrier
    s_call_b64 s[78:79], side_g
    s_waitcnt vmcnt(0)
    s_barrier
    s_branch ss_exit_60
ss_loaderB_57:
    v_lshlrev_b32 v1, 4, v0
    s_mul_i32 s31, s82, 131072
    s_add_u32 s31, s31, s25
    s_mul_i32 s32, s82, 8192
    s_add_u32 s32, s32, 49152
    s_mul_i32 s85, s70, 9
    s_add_u32 s85, s85, 262
    v_min_u32 v252, 8, v0
    v_lshlrev_b32 v252, 7, v252
    s_lshl_b32 s27, s85, 7
    s_mov_b32 s34, 131072
    s_mov_b64 exec, 0x1ff
poll_64:
    buffer_load_dword v253, v252, s[36:39], s27 offen sc1
    s_sub_u32 s34, s34, 1
    s_waitcnt vmcnt(0)
    v_cmp_ne_u32 vcc, 1, v253
    s_cmp_eq_u32 s34, 0
    s_cbranch_scc1 polled_65
    s_cmp_eq_u64 vcc, 0
    s_cbranch_scc1 polled_65
    s_sleep 3
    s_branch poll_64
polled_65:
    s_mov_b64 exec, -1
    s_mov_b32 m0, s32
    s_nop 0
    buffer_load_dwordx4 v1, s[8:11], s31 offen sc1 lds
    buffer_load_dwordx4 v1, s[8:11], s31 offen offset:1024 sc1 lds
    buffer_load_dwordx4 v1, s[8:11], s31 offen offset:2048 sc1 lds
    buffer_load_dwordx4 v1, s[8:11], s31 offen offset:3072 sc1 lds
    s_add_u32 m0, s32, 4096
    s_add_u32 s27, s31, 4096
    buffer_load_dwordx4 v1, s[8:11], s27 offen sc1 lds
    buffer_load_dwordx4 v1, s[8:11], s27 offen offset:1024 sc1 lds
    buffer_load_dwordx4 v1, s[8:11], s27 offen offset:2048 sc1 lds
    buffer_load_dwordx4 v1, s[8:11], s27 offen offset:3072 sc1 lds
    s_add_u32 s31, s31, 262144
    s_add_u32 m0, s32, 16384
    s_nop 0
    buffer_load_dwordx4 v1, s[8:11], s31 offen sc1 lds
    buffer_load_dwordx4 v1, s[8:11], s31 offen offset:1024 sc1 lds
    buffer_load_dwordx4 v1, s[8:11], s31 offen offset:2048 sc1 lds
    buffer_load_dwordx4 v1, s[8:11], s31 offen offset:3072 sc1 lds
    s_add_u32 m0, s32, 20480
    s_add_u32 s27, s31, 4096
    buffer_load_dwordx4 v1, s[8:11], s27 offen sc1 lds
    buffer_load_dwordx4 v1, s[8:11], s27 offen offset:1024 sc1 lds
    buffer_load_dwordx4 v1, s[8:11], s27 offen offset:2048 sc1 lds
    buffer_load_dwordx4 v1, s[8:11], s27 offen offset:3072 sc1 lds
    s_add_u32 s31, s31, 262144
    s_add_u32 m0, s32, 32768
    s_nop 0
    buffer_load_dwordx4 v1, s[8:11], s31 offen sc1 lds
    buffer_load_dwordx4 v1, s[8:11], s31 offen offset:1024 sc1 lds
    buffer_load_dwordx4 v1, s[8:11], s31 offen offset:2048 sc1 lds
    buffer_load_dwordx4 v1, s[8:11], s31 offen offset:3072 sc1 lds
    s_add_u32 m0, s32, 36864
    s_add_u32 s27, s31, 4096
    buffer_load_dwordx4 v1, s[8:11], s27 offen sc1 lds
    buffer_load_dwordx4 v1, s[8:11], s27 offen offset:1024 sc1 lds
    buffer_load_dwordx4 v1, s[8:11], s27 offen offset:2048 sc1 lds
    buffer_load_dwordx4 v1, s[8:11], s27 offen offset:3072 sc1 lds
    s_add_u32 s31, s31, 262144
    s_waitcnt vmcnt(16)
    s_barrier
    s_mov_b32 s33, 0
    s_mov_b32 s34, 15
ss_ld_66:
    s_waitcnt vmcnt(8)
    s_barrier
    s_add_u32 s28, s32, s33
    s_mov_b32 m0, s28
    s_nop 0
    buffer_load_dwordx4 v1, s[8:11], s31 offen sc1 lds
    buffer_load_dwordx4 v1, s[8:11], s31 offen offset:1024 sc1 lds
    buffer_load_dwordx4 v1, s[8:11], s31 offen offset:2048 sc1 lds
    buffer_load_dwordx4 v1, s[8:11], s31 offen offset:3072 sc1 lds
    s_add_u32 m0, s28, 4096
    s_add_u32 s27, s31, 4096
    buffer_load_dwordx4 v1, s[8:11], s27 offen sc1 lds
    buffer_load_dwordx4 v1, s[8:11], s27 offen offset:1024 sc1 lds
    buffer_load_dwordx4 v1, s[8:11], s27 offen offset:2048 sc1 lds
    buffer_load_dwordx4 v1, s[8:11], s27 offen offset:3072 sc1 lds
    s_add_u32 s31, s31, 262144
    s_add_u32 s33, s33, 16384
    s_cmp_eq_u32 s33, 49152
    s_cselect_b32 s33, 0, s33
    s_sub_u32 s34, s34, 1
    s_cmp_lg_u32 s34, 0
    s_cbranch_scc1 ss_ld_66
    s_call_b64 s[78:79], side_x
    s_waitcnt vmcnt(14)
    s_barrier
    s_waitcnt vmcnt(6)
    s_barrier
    s_call_b64 s[78:79], side_g
    s_waitcnt vmcnt(0)
    s_barrier
    s_branch ss_exit_60
role_V:
    s_mov_b32 s66, s67
    s_mov_b32 s67, s68
    s_lshl_b32 s24, s66, 13
    s_mul_i32 s25, s67, 9216
    s_lshl_b32 s75, s66, 2
    s_mul_i32 s76, s67, 9
    s_lshr_b32 s72, s66, 3
    s_lshl_b32 s72, s72, 3
    s_add_u32 s72, s72, s67
    s_lshl_b32 s72, s72, 3
    s_and_b32 s73, s66, 7
    s_add_u32 s72, s72, s73
    s_add_u32 s72, s72, 639
    s_add_u32 s4, s62, 311296
    s_addc_u32 s5, s63, 0
    s_mov_b32 s6, 4718592
    s_mov_b32 s7, 0x00020000
    s_add_u32 s8, s62, 7684096
    s_addc_u32 s9, s63, 0
    s_mov_b32 s10, 2654208
    s_mov_b32 s11, 0x00020000
    s_add_u32 s12, s62, 15056896
    s_addc_u32 s13, s63, 0
    s_mov_b32 s14, 4718592
    s_mov_b32 s15, 0x00020000
    s_cmp_ge_u32 s3, 4
    s_cbranch_scc1 vv_loader_67
    s_and_b32 s84, s3, 0
    s_lshr_b32 s83, s3, 0
    s_mul_i32 s27, s83, 2048
    s_add_u32 s27, s27, 0
    v_lshlrev_b32 v4, 4, v0
    v_add_u32 v4, s27, v4
    s_mul_i32 s27, s84, 9216
    s_add_u32 s27, s27, 49152
    v_lshlrev_b32 v5, 4, v0
    v_add_u32 v5, s27, v5
    v_mov_b32 v16, 0
    v_mov_b32 v17, 0
    v_mov_b32 v18, 0
    v_mov_b32 v19, 0
    v_mov_b32 v20, 0
    v_mov_b32 v21, 0
    v_mov_b32 v22, 0
    v_mov_b32 v23, 0
    v_mov_b32 v24, 0
    v_mov_b32 v25, 0
    v_mov_b32 v26, 0
    v_mov_b32 v27, 0
    v_mov_b32 v28, 0
    v_mov_b32 v29, 0
    v_mov_b32 v30, 0
    v_mov_b32 v31, 0
    v_mov_b32 v32, 0
    v_mov_b32 v33, 0
    v_mov_b32 v34, 0
    v_mov_b32 v35, 0
    v_mov_b32 v36, 0
    v_mov_b32 v37, 0
    v_mov_b32 v38, 0
    v_mov_b32 v39, 0
    v_mov_b32 v40, 0
    v_mov_b32 v41, 0
    v_mov_b32 v42, 0
    v_mov_b32 v43, 0
    v_mov_b32 v44, 0
    v_mov_b32 v45, 0
    v_mov_b32 v46, 0
    v_mov_b32 v47, 0
    v_mov_b32 v48, 0
    v_mov_b32 v49, 0
    v_mov_b32 v50, 0
    v_mov_b32 v51, 0
    v_mov_b32 v52, 0
    v_mov_b32 v53, 0
    v_mov_b32 v54, 0
    v_mov_b32 v55, 0
    v_mov_b32 v56, 0
    v_mov_b32 v57, 0
    v_mov_b32 v58, 0
    v_mov_b32 v59, 0
    v_mov_b32 v60, 0
    v_mov_b32 v61, 0
    v_mov_b32 v62, 0
    v_mov_b32 v63, 0
    v_mov_b32 v64, 0
    v_mov_b32 v65, 0
    v_mov_b32 v66, 0
    v_mov_b32 v67, 0
    v_mov_b32 v68, 0
    v_mov_b32 v69, 0
    v_mov_b32 v70, 0
    v_mov_b32 v71, 0
    v_mov_b32 v72, 0
    v_mov_b32 v73, 0
    v_mov_b32 v74, 0
    v_mov_b32 v75, 0
    v_mov_b32 v76, 0
    v_mov_b32 v77, 0
    v_mov_b32 v78, 0
    v_mov_b32 v79, 0
    v_mov_b32 v80, 0
    v_mov_b32 v81, 0
    v_mov_b32 v82, 0
    v_mov_b32 v83, 0
    v_mov_b32 v84, 0
    v_mov_b32 v85, 0
    v_mov_b32 v86, 0
    v_mov_b32 v87, 0
    s_mov_b32 s33, 0
    s_mov_b32 s31, 0
    s_mov_b32 s30, 16384
    s_mov_b32 s32, 18432
    s_mov_b32 s34, 17
    s_barrier
    ds_read_b128 v[88:91], v4 offset:0
    ds_read_b128 v[92:95], v4 offset:1024
    ds_read_b128 v[96:99], v5 offset:0
    ds_read_b128 v[100:103], v5 offset:1024
    ds_read_b128 v[104:107], v5 offset:2048
    ds_read_b128 v[108:111], v5 offset:3072
    ds_read_b128 v[112:115], v5 offset:4096
    ds_read_b128 v[116:119], v5 offset:5120
    ds_read_b128 v[120:123], v5 offset:6144
    ds_read_b128 v[124:127], v5 offset:7168
    ds_read_b128 v[128:131], v5 offset:8192
    s_waitcnt lgkmcnt(0)
vv_mm_69:
    v_mfma_f32_16x16x32_bf16 v[16:19], v[88:91], v[96:99], v[16:19]
    ds_read_b128 v[132:135], v4 offset:8192
    v_mfma_f32_16x16x32_bf16 v[20:23], v[88:91], v[100:103], v[20:23]
    ds_read_b128 v[136:139], v4 offset:9216
    v_mfma_f32_16x16x32_bf16 v[24:27], v[88:91], v[104:107], v[24:27]
    ds_read_b128 v[140:143], v5 offset:9216
    v_mfma_f32_16x16x32_bf16 v[28:31], v[88:91], v[108:111], v[28:31]
    ds_read_b128 v[144:147], v5 offset:10240
    v_mfma_f32_16x16x32_bf16 v[32:35], v[88:91], v[112:115], v[32:35]
    ds_read_b128 v[148:151], v5 offset:11264
    v_mfma_f32_16x16x32_bf16 v[36:39], v[88:91], v[116:119], v[36:39]
    ds_read_b128 v[152:155], v5 offset:12288
    v_mfma_f32_16x16x32_bf16 v[40:43], v[88:91], v[120:123], v[40:43]
    ds_read_b128 v[156:159], v5 offset:13312
    v_mfma_f32_16x16x32_bf16 v[44:47], v[88:91], v[124:127], v[44:47]
    ds_read_b128 v[160:163], v5 offset:14336
    v_mfma_f32_16x16x32_bf16 v[48:51], v[88:91], v[128:131], v[48:51]
    ds_read_b128 v[164:167], v5 offset:15360
    v_mfma_f32_16x16x32_bf16 v[52:55], v[92:95], v[96:99], v[52:55]
    ds_read_b128 v[168:171], v5 offset:16384
    v_mfma_f32_16x16x32_bf16 v[56:59], v[92:95], v[100:103], v[56:59]
    ds_read_b128 v[172:175], v5 offset:17408
    v_mfma_f32_16x16x32_bf16 v[60:63], v[92:95], v[104:107], v[60:63]
    s_add_u32 s33, s33, 1
    v_mfma_f32_16x16x32_bf16 v[64:67], v[92:95], v[108:111], v[64:67]
    s_cmp_eq_u32 s33, 3
    v_mfma_f32_16x16x32_bf16 v[68:71], v[92:95], v[112:115], v[68:71]
    s_cselect_b32 s35, 4294934528, s30
    v_mfma_f32_16x16x32_bf16 v[72:75], v[92:95], v[116:119], v[72:75]
    s_cselect_b32 s29, 4294930432, s32
    v_mfma_f32_16x16x32_bf16 v[76:79], v[92:95], v[120:123], v[76:79]
    s_cselect_b32 s33, 0, s33
    v_mfma_f32_16x16x32_bf16 v[80:83], v[92:95], v[124:127], v[80:83]
    v_add_u32 v4, s35, v4
    v_mfma_f32_16x16x32_bf16 v[84:87], v[92:95], v[128:131], v[84:87]
    v_add_u32 v5, s29, v5
    s_waitcnt lgkmcnt(0)
    s_barrier
    v_mfma_f32_16x16x32_bf16 v[16:19], v[132:135], v[140:143], v[16:19]
    ds_read_b128 v[88:91], v4 offset:0
    v_mfma_f32_16x16x32_bf16 v[20:23], v[132:135], v[144:147], v[20:23]
    ds_read_b128 v[92:95], v4 offset:1024
    v_mfma_f32_16x16x32_bf16 v[24:27], v[132:135], v[148:151], v[24:27]
    ds_read_b128 v[96:99], v5 offset:0
    v_mfma_f32_16x16x32_bf16 v[28:31], v[132:135], v[152:155], v[28:31]
    ds_read_b128 v[100:103], v5 offset:1024
    v_mfma_f32_16x16x32_bf16 v[32:35], v[132:135], v[156:159], v[32:35]
    ds_read_b128 v[104:107], v5 offset:2048
    v_mfma_f32_16x16x32_bf16 v[36:39], v[132:135], v[160:163], v[36:39]
    ds_read_b128 v[108:111], v5 offset:3072
    v_mfma_f32_16x16x32_bf16 v[40:43], v[132:135], v[164:167], v[40:43]
    ds_read_b128 v[112:115], v5 offset:4096
    v_mfma_f32_16x16x32_bf16 v[44:47], v[132:135], v[168:171], v[44:47]
    ds_read_b128 v[116:119], v5 offset:5120
    v_mfma_f32_16x16x32_bf16 v[48:51], v[132:135], v[172:175], v[48:51]
    ds_read_b128 v[120:123], v5 offset:6144
    v_mfma_f32_16x16x32_bf16 v[52:55], v[136:139], v[140:143], v[52:55]
    ds_read_b128 v[124:127], v5 offset:7168
    v_mfma_f32_16x16x32_bf16 v[56:59], v[136:139], v[144:147], v[56:59]
    ds_read_b128 v[128:131], v5 offset:8192
    v_mfma_f32_16x16x32_bf16 v[60:63], v[136:139], v[148:151], v[60:63]
    s_sub_u32 s34, s34, 1
    v_mfma_f32_16x16x32_bf16 v[64:67], v[136:139], v[152:155], v[64:67]
    s_cmp_lg_u32 s34, 0
    v_mfma_f32_16x16x32_bf16 v[68:71], v[136:139], v[156:159], v[68:71]
    v_mfma_f32_16x16x32_bf16 v[72:75], v[136:139], v[160:163], v[72:75]
    v_mfma_f32_16x16x32_bf16 v[76:79], v[136:139], v[164:167], v[76:79]
    v_mfma_f32_16x16x32_bf16 v[80:83], v[136:139], v[168:171], v[80:83]
    v_mfma_f32_16x16x32_bf16 v[84:87], v[136:139], v[172:175], v[84:87]
    s_waitcnt lgkmcnt(0)
    s_cbranch_scc1 vv_mm_69
    v_mfma_f32_16x16x32_bf16 v[16:19], v[88:91], v[96:99], v[16:19]
    ds_read_b128 v[132:135], v4 offset:8192
    v_mfma_f32_16x16x32_bf16 v[20:23], v[88:91], v[100:103], v[20:23]
    ds_read_b128 v[136:139], v4 offset:9216
    v_mfma_f32_16x16x32_bf16 v[24:27], v[88:91], v[104:107], v[24:27]
    ds_read_b128 v[140:143], v5 offset:9216
    v_mfma_f32_16x16x32_bf16 v[28:31], v[88:91], v[108:111], v[28:31]
    ds_read_b128 v[144:147], v5 offset:10240
    v_mfma_f32_16x16x32_bf16 v[32:35], v[88:91], v[112:115], v[32:35]
    ds_read_b128 v[148:151], v5 offset:11264
    v_mfma_f32_16x16x32_bf16 v[36:39], v[88:91], v[116:119], v[36:39]
    ds_read_b128 v[152:155], v5 offset:12288
    v_mfma_f32_16x16x32_bf16 v[40:43], v[88:91], v[120:123], v[40:43]
    ds_read_b128 v[156:159], v5 offset:13312
    v_mfma_f32_16x16x32_bf16 v[44:47], v[88:91], v[124:127], v[44:47]
    ds_read_b128 v[160:163], v5 offset:14336
    v_mfma_f32_16x16x32_bf16 v[48:51], v[88:91], v[128:131], v[48:51]
    ds_read_b128 v[164:167], v5 offset:15360
    v_mfma_f32_16x16x32_bf16 v[52:55], v[92:95], v[96:99], v[52:55]
    ds_read_b128 v[168:171], v5 offset:16384
    v_mfma_f32_16x16x32_bf16 v[56:59], v[92:95], v[100:103], v[56:59]
    ds_read_b128 v[172:175], v5 offset:17408
    v_mfma_f32_16x16x32_bf16 v[60:63], v[92:95], v[104:107], v[60:63]
    v_mfma_f32_16x16x32_bf16 v[64:67], v[92:95], v[108:111], v[64:67]
    v_mfma_f32_16x16x32_bf16 v[68:71], v[92:95], v[112:115], v[68:71]
    v_mfma_f32_16x16x32_bf16 v[72:75], v[92:95], v[116:119], v[72:75]
    v_mfma_f32_16x16x32_bf16 v[76:79], v[92:95], v[120:123], v[76:79]
    v_mfma_f32_16x16x32_bf16 v[80:83], v[92:95], v[124:127], v[80:83]
    v_mfma_f32_16x16x32_bf16 v[84:87], v[92:95], v[128:131], v[84:87]
    s_waitcnt lgkmcnt(0)
    v_mfma_f32_16x16x32_bf16 v[16:19], v[132:135], v[140:143], v[16:19]
    v_mfma_f32_16x16x32_bf16 v[20:23], v[132:135], v[144:147], v[20:23]
    v_mfma_f32_16x16x32_bf16 v[24:27], v[132:135], v[148:151], v[24:27]
    v_mfma_f32_16x16x32_bf16 v[28:31], v[132:135], v[152:155], v[28:31]
    v_mfma_f32_16x16x32_bf16 v[32:35], v[132:135], v[156:159], v[32:35]
    v_mfma_f32_16x16x32_bf16 v[36:39], v[132:135], v[160:163], v[36:39]
    v_mfma_f32_16x16x32_bf16 v[40:43], v[132:135], v[164:167], v[40:43]
    v_mfma_f32_16x16x32_bf16 v[44:47], v[132:135], v[168:171], v[44:47]
    v_mfma_f32_16x16x32_bf16 v[48:51], v[132:135], v[172:175], v[48:51]
    v_mfma_f32_16x16x32_bf16 v[52:55], v[136:139], v[140:143], v[52:55]
    v_mfma_f32_16x16x32_bf16 v[56:59], v[136:139], v[144:147], v[56:59]
    v_mfma_f32_16x16x32_bf16 v[60:63], v[136:139], v[148:151], v[60:63]
    v_mfma_f32_16x16x32_bf16 v[64:67], v[136:139], v[152:155], v[64:67]
    v_mfma_f32_16x16x32_bf16 v[68:71], v[136:139], v[156:159], v[68:71]
    v_mfma_f32_16x16x32_bf16 v[72:75], v[136:139], v[160:163], v[72:75]
    v_mfma_f32_16x16x32_bf16 v[76:79], v[136:139], v[164:167], v[76:79]
    v_mfma_f32_16x16x32_bf16 v[80:83], v[136:139], v[168:171], v[80:83]
    v_mfma_f32_16x16x32_bf16 v[84:87], v[136:139], v[172:175], v[84:87]
    s_mul_i32 s27, s83, 1
    s_add_u32 s27, s27, s75
    s_mul_i32 s27, s27, 72
    s_mul_i32 s28, s84, 9
    s_add_u32 s27, s27, s28
    s_add_u32 s27, s27, s76
    s_lshl_b32 s26, s27, 10
    v_lshlrev_b32 v1, 4, v0
    s_nop 1
    v_cvt_pk_bf16_f32 v88, v16, v17
    v_cvt_pk_bf16_f32 v89, v18, v19
    v_cvt_pk_bf16_f32 v90, v52, v53
    v_cvt_pk_bf16_f32 v91, v54, v55
    s_add_u32 s27, s26, 0
    buffer_store_dwordx4 v[88:91], v1, s[12:15], s27 offen offset:0 sc1
    v_cvt_pk_bf16_f32 v92, v20, v21
    v_cvt_pk_bf16_f32 v93, v22, v23
    v_cvt_pk_bf16_f32 v94, v56, v57
    v_cvt_pk_bf16_f32 v95, v58, v59
    s_add_u32 s27, s26, 0
    buffer_store_dwordx4 v[92:95], v1, s[12:15], s27 offen offset:1024 sc1
    v_cvt_pk_bf16_f32 v96, v24, v25
    v_cvt_pk_bf16_f32 v97, v26, v27
    v_cvt_pk_bf16_f32 v98, v60, v61
    v_cvt_pk_bf16_f32 v99, v62, v63
    s_add_u32 s27, s26, 0
    buffer_store_dwordx4 v[96:99], v1, s[12:15], s27 offen offset:2048 sc1
    v_cvt_pk_bf16_f32 v100, v28, v29
    v_cvt_pk_bf16_f32 v101, v30, v31
    v_cvt_pk_bf16_f32 v102, v64, v65
    v_cvt_pk_bf16_f32 v103, v66, v67
    s_add_u32 s27, s26, 0
    buffer_store_dwordx4 v[100:103], v1, s[12:15], s27 offen offset:3072 sc1
    v_cvt_pk_bf16_f32 v104, v32, v33
    v_cvt_pk_bf16_f32 v105, v34, v35
    v_cvt_pk_bf16_f32 v106, v68, v69
    v_cvt_pk_bf16_f32 v107, v70, v71
    s_add_u32 s27, s26, 4096
    buffer_store_dwordx4 v[104:107], v1, s[12:15], s27 offen offset:0 sc1
    v_cvt_pk_bf16_f32 v108, v36, v37
    v_cvt_pk_bf16_f32 v109, v38, v39
    v_cvt_pk_bf16_f32 v110, v72, v73
    v_cvt_pk_bf16_f32 v111, v74, v75
    s_add_u32 s27, s26, 4096
    buffer_store_dwordx4 v[108:111], v1, s[12:15], s27 offen offset:1024 sc1
    v_cvt_pk_bf16_f32 v112, v40, v41
    v_cvt_pk_bf16_f32 v113, v42, v43
    v_cvt_pk_bf16_f32 v114, v76, v77
    v_cvt_pk_bf16_f32 v115, v78, v79
    s_add_u32 s27, s26, 4096
    buffer_store_dwordx4 v[112:115], v1, s[12:15], s27 offen offset:2048 sc1
    v_cvt_pk_bf16_f32 v116, v44, v45
    v_cvt_pk_bf16_f32 v117, v46, v47
    v_cvt_pk_bf16_f32 v118, v80, v81
    v_cvt_pk_bf16_f32 v119, v82, v83
    s_add_u32 s27, s26, 4096
    buffer_store_dwordx4 v[116:119], v1, s[12:15], s27 offen offset:3072 sc1
    v_cvt_pk_bf16_f32 v120, v48, v49
    v_cvt_pk_bf16_f32 v121, v50, v51
    v_cvt_pk_bf16_f32 v122, v84, v85
    v_cvt_pk_bf16_f32 v123, v86, v87
    s_add_u32 s27, s26, 8192
    buffer_store_dwordx4 v[120:123], v1, s[12:15], s27 offen offset:0 sc1
    s_mov_b64 exec, -1
    s_lshl_b32 s27, s72, 7
    v_mov_b32 v8, 0
    v_mov_b32 v9, 1
    s_cmp_lg_u32 s3, 0
    s_waitcnt vmcnt(0)
    s_barrier
    s_cbranch_scc1 sig_70
    s_mov_b64 exec, 1
    buffer_store_dword v9, v8, s[36:39], s27 offen sc1
    s_mov_b64 exec, -1
sig_70:
vv_exit_71:
    s_mov_b64 exec, -1
    s_branch next_task
vv_loader_67:
    s_and_b32 s82, s3, 1
    s_cmp_ge_u32 s3, 6
    s_cbranch_scc1 vv_loaderB_68
    v_lshlrev_b32 v1, 4, v0
    s_mul_i32 s31, s82, 131072
    s_add_u32 s31, s31, s24
    s_mul_i32 s32, s82, 8192
    s_add_u32 s32, s32, 0
    s_mul_i32 s85, s66, 4
    s_add_u32 s85, s85, 90
    v_min_u32 v252, 3, v0
    v_lshlrev_b32 v252, 7, v252
    s_lshl_b32 s27, s85, 7
    s_mov_b32 s34, 131072
    s_mov_b64 exec, 0xf
poll_72:
    buffer_load_dword v253, v252, s[36:39], s27 offen sc1
    s_sub_u32 s34, s34, 1
    s_waitcnt vmcnt(0)
    v_cmp_ne_u32 vcc, 1, v253
    s_cmp_eq_u32 s34, 0
    s_cbranch_scc1 polled_73
    s_cmp_eq_u64 vcc, 0
    s_cbranch_scc1 polled_73
    s_sleep 3
    s_branch poll_72
polled_73:
    s_mov_b64 exec, -1
    s_mov_b32 m0, s32
    s_nop 0
    buffer_load_dwordx4 v1, s[4:7], s31 offen sc1 lds
    buffer_load_dwordx4 v1, s[4:7], s31 offen offset:1024 sc1 lds
    buffer_load_dwordx4 v1, s[4:7], s31 offen offset:2048 sc1 lds
    buffer_load_dwordx4 v1, s[4:7], s31 offen offset:3072 sc1 lds
    s_add_u32 m0, s32, 4096
    s_add_u32 s27, s31, 4096
    buffer_load_dwordx4 v1, s[4:7], s27 offen sc1 lds
    buffer_load_dwordx4 v1, s[4:7], s27 offen offset:1024 sc1 lds
    buffer_load_dwordx4 v1, s[4:7], s27 offen offset:2048 sc1 lds
    buffer_load_dwordx4 v1, s[4:7], s27 offen offset:3072 sc1 lds
    s_add_u32 s31, s31, 262144
    s_add_u32 m0, s32, 16384
    s_nop 0
    buffer_load_dwordx4 v1, s[4:7], s31 offen sc1 lds
    buffer_load_dwordx4 v1, s[4:7], s31 offen offset:1024 sc1 lds
    buffer_load_dwordx4 v1, s[4:7], s31 offen offset:2048 sc1 lds
    buffer_load_dwordx4 v1, s[4:7], s31 offen offset:3072 sc1 lds
    s_add_u32 m0, s32, 20480
    s_add_u32 s27, s31, 4096
    buffer_load_dwordx4 v1, s[4:7], s27 offen sc1 lds
    buffer_load_dwordx4 v1, s[4:7], s27 offen offset:1024 sc1 lds
    buffer_load_dwordx4 v1, s[4:7], s27 offen offset:2048 sc1 lds
    buffer_load_dwordx4 v1, s[4:7], s27 offen offset:3072 sc1 lds
    s_add_u32 s31, s31, 262144
    s_add_u32 m0, s32, 32768
    s_nop 0
    buffer_load_dwordx4 v1, s[4:7], s31 offen sc1 lds
    buffer_load_dwordx4 v1, s[4:7], s31 offen offset:1024 sc1 lds
    buffer_load_dwordx4 v1, s[4:7], s31 offen offset:2048 sc1 lds
    buffer_load_dwordx4 v1, s[4:7], s31 offen offset:3072 sc1 lds
    s_add_u32 m0, s32, 36864
    s_add_u32 s27, s31, 4096
    buffer_load_dwordx4 v1, s[4:7], s27 offen sc1 lds
    buffer_load_dwordx4 v1, s[4:7], s27 offen offset:1024 sc1 lds
    buffer_load_dwordx4 v1, s[4:7], s27 offen offset:2048 sc1 lds
    buffer_load_dwordx4 v1, s[4:7], s27 offen offset:3072 sc1 lds
    s_add_u32 s31, s31, 262144
    s_waitcnt vmcnt(16)
    s_barrier
    s_mov_b32 s33, 0
    s_mov_b32 s34, 15
vv_ld_74:
    s_waitcnt vmcnt(8)
    s_barrier
    s_add_u32 s28, s32, s33
    s_mov_b32 m0, s28
    s_nop 0
    buffer_load_dwordx4 v1, s[4:7], s31 offen sc1 lds
    buffer_load_dwordx4 v1, s[4:7], s31 offen offset:1024 sc1 lds
    buffer_load_dwordx4 v1, s[4:7], s31 offen offset:2048 sc1 lds
    buffer_load_dwordx4 v1, s[4:7], s31 offen offset:3072 sc1 lds
    s_add_u32 m0, s28, 4096
    s_add_u32 s27, s31, 4096
    buffer_load_dwordx4 v1, s[4:7], s27 offen sc1 lds
    buffer_load_dwordx4 v1, s[4:7], s27 offen offset:1024 sc1 lds
    buffer_load_dwordx4 v1, s[4:7], s27 offen offset:2048 sc1 lds
    buffer_load_dwordx4 v1, s[4:7], s27 offen offset:3072 sc1 lds
    s_add_u32 s31, s31, 262144
    s_add_u32 s33, s33, 16384
    s_cmp_eq_u32 s33, 49152
    s_cselect_b32 s33, 0, s33
    s_sub_u32 s34, s34, 1
    s_cmp_lg_u32 s34, 0
    s_cbranch_scc1 vv_ld_74
    s_call_b64 s[78:79], side_x
    s_waitcnt vmcnt(14)
    s_barrier
    s_waitcnt vmcnt(6)
    s_barrier
    s_call_b64 s[78:79], side_g
    s_waitcnt vmcnt(0)
    s_barrier
    s_branch vv_exit_71
vv_loaderB_68:
    v_lshlrev_b32 v1, 4, v0
    s_mul_i32 s31, s82, 73728
    s_add_u32 s31, s31, s25
    s_mul_i32 s32, s82, 9216
    s_add_u32 s32, s32, 49152
    s_mul_i32 s85, s67, 9
    s_add_u32 s85, s85, 406
    v_min_u32 v252, 17, v0
    v_lshlrev_b32 v252, 7, v252
    s_lshl_b32 s27, s85, 7
    s_mov_b32 s34, 131072
    s_mov_b64 exec, 0x3ffff
poll_75:
    buffer_load_dword v253, v252, s[36:39], s27 offen sc1
    s_sub_u32 s34, s34, 1
    s_waitcnt vmcnt(0)
    v_cmp_ne_u32 vcc, 1, v253
    s_cmp_eq_u32 s34, 0
    s_cbranch_scc1 polled_76
    s_cmp_eq_u64 vcc, 0
    s_cbranch_scc1 polled_76
    s_sleep 3
    s_branch poll_75
polled_76:
    s_mov_b64 exec, -1
    s_mov_b32 m0, s32
    s_nop 0
    buffer_load_dwordx4 v1, s[8:11], s31 offen sc1 lds
    buffer_load_dwordx4 v1, s[8:11], s31 offen offset:1024 sc1 lds
    buffer_load_dwordx4 v1, s[8:11], s31 offen offset:2048 sc1 lds
    buffer_load_dwordx4 v1, s[8:11], s31 offen offset:3072 sc1 lds
    s_add_u32 m0, s32, 4096
    s_add_u32 s27, s31, 4096
    buffer_load_dwordx4 v1, s[8:11], s27 offen sc1 lds
    buffer_load_dwordx4 v1, s[8:11], s27 offen offset:1024 sc1 lds
    buffer_load_dwordx4 v1, s[8:11], s27 offen offset:2048 sc1 lds
    buffer_load_dwordx4 v1, s[8:11], s27 offen offset:3072 sc1 lds
    s_add_u32 m0, s32, 8192
    s_add_u32 s27, s31, 8192
    buffer_load_dwordx4 v1, s[8:11], s27 offen sc1 lds
    s_add_u32 s31, s31, 147456
    s_add_u32 m0, s32, 18432
    s_nop 0
    buffer_load_dwordx4 v1, s[8:11], s31 offen sc1 lds
    buffer_load_dwordx4 v1, s[8:11], s31 offen offset:1024 sc1 lds
    buffer_load_dwordx4 v1, s[8:11], s31 offen offset:2048 sc1 lds
    buffer_load_dwordx4 v1, s[8:11], s31 offen offset:3072 sc1 lds
    s_add_u32 m0, s32, 22528
    s_add_u32 s27, s31, 4096
    buffer_load_dwordx4 v1, s[8:11], s27 offen sc1 lds
    buffer_load_dwordx4 v1, s[8:11], s27 offen offset:1024 sc1 lds
    buffer_load_dwordx4 v1, s[8:11], s27 offen offset:2048 sc1 lds
    buffer_load_dwordx4 v1, s[8:11], s27 offen offset:3072 sc1 lds
    s_add_u32 m0, s32, 26624
    s_add_u32 s27, s31, 8192
    buffer_load_dwordx4 v1, s[8:11], s27 offen sc1 lds
    s_add_u32 s31, s31, 147456
    s_add_u32 m0, s32, 36864
    s_nop 0
    buffer_load_dwordx4 v1, s[8:11], s31 offen sc1 lds
    buffer_load_dwordx4 v1, s[8:11], s31 offen offset:1024 sc1 lds
    buffer_load_dwordx4 v1, s[8:11], s31 offen offset:2048 sc1 lds
    buffer_load_dwordx4 v1, s[8:11], s31 offen offset:3072 sc1 lds
    s_add_u32 m0, s32, 40960
    s_add_u32 s27, s31, 4096
    buffer_load_dwordx4 v1, s[8:11], s27 offen sc1 lds
    buffer_load_dwordx4 v1, s[8:11], s27 offen offset:1024 sc1 lds
    buffer_load_dwordx4 v1, s[8:11], s27 offen offset:2048 sc1 lds
    buffer_load_dwordx4 v1, s[8:11], s27 offen offset:3072 sc1 lds
    s_add_u32 m0, s32, 45056
    s_add_u32 s27, s31, 8192
    buffer_load_dwordx4 v1, s[8:11], s27 offen sc1 lds
    s_add_u32 s31, s31, 147456
    s_waitcnt vmcnt(18)
    s_barrier
    s_mov_b32 s33, 0
    s_mov_b32 s34, 15
vv_ld_77:
    s_waitcnt vmcnt(9)
    s_barrier
    s_add_u32 s28, s32, s33
    s_mov_b32 m0, s28
    s_nop 0
    buffer_load_dwordx4 v1, s[8:11], s31 offen sc1 lds
    buffer_load_dwordx4 v1, s[8:11], s31 offen offset:1024 sc1 lds
    buffer_load_dwordx4 v1, s[8:11], s31 offen offset:2048 sc1 lds
    buffer_load_dwordx4 v1, s[8:11], s31 offen offset:3072 sc1 lds
    s_add_u32 m0, s28, 4096
    s_add_u32 s27, s31, 4096
    buffer_load_dwordx4 v1, s[8:11], s27 offen sc1 lds
    buffer_load_dwordx4 v1, s[8:11], s27 offen offset:1024 sc1 lds
    buffer_load_dwordx4 v1, s[8:11], s27 offen offset:2048 sc1 lds
    buffer_load_dwordx4 v1, s[8:11], s27 offen offset:3072 sc1 lds
    s_add_u32 m0, s28, 8192
    s_add_u32 s27, s31, 8192
    buffer_load_dwordx4 v1, s[8:11], s27 offen sc1 lds
    s_add_u32 s31, s31, 147456
    s_add_u32 s33, s33, 18432
    s_cmp_eq_u32 s33, 55296
    s_cselect_b32 s33, 0, s33
    s_sub_u32 s34, s34, 1
    s_cmp_lg_u32 s34, 0
    s_cbranch_scc1 vv_ld_77
    s_call_b64 s[78:79], side_x
    s_waitcnt vmcnt(15)
    s_barrier
    s_waitcnt vmcnt(6)
    s_barrier
    s_call_b64 s[78:79], side_g
    s_waitcnt vmcnt(0)
    s_barrier
    s_branch vv_exit_71
role_PV:
    s_lshr_b32 s66, s67, 3
    s_and_b32 s67, s67, 7
    s_mul_i32 s24, s66, 2359296
    s_mul_i32 s69, s68, 6144
    s_add_u32 s24, s24, s69
    s_lshl_b32 s25, s66, 21
    s_lshl_b32 s69, s67, 13
    s_add_u32 s25, s25, s69
    s_lshl_b32 s70, s66, 3
    s_add_u32 s70, s70, s67
    s_mul_i32 s75, s68, 3
    s_lshl_b32 s76, s70, 3
    s_mul_i32 s72, s70, 12
    s_add_u32 s72, s72, s68
    s_add_u32 s72, s72, 767
    s_lshl_b32 s71, s68, 1
    s_mul_i32 s71, s71, 11
    s_lshr_b32 s71, s71, 5
    s_min_u32 s71, s71, 6
    s_lshl_b32 s73, s66, 3
    s_add_u32 s71, s71, s73
    s_add_u32 s4, s62, 15056896
    s_addc_u32 s5, s63, 0
    s_mov_b32 s6, 4718592
    s_mov_b32 s7, 0x00020000
    s_add_u32 s8, s62, 19775488
    s_addc_u32 s9, s63, 0
    s_mov_b32 s10, 4194304
    s_mov_b32 s11, 0x00020000
    s_add_u32 s12, s62, 10338304
    s_addc_u32 s13, s63, 0
    s_mov_b32 s14, 4718592
    s_mov_b32 s15, 0x00020000
    s_cmp_ge_u32 s3, 4
    s_cbranch_scc1 pv_loader_78
    s_and_b32 s84, s3, 3
    s_lshr_b32 s83, s3, 2
    v_and_b32 v212, 15, v0
    v_lshlrev_b32 v212, 4, v212
    s_lshl_b32 s27, s84, 11
    v_add_u32 v212, s27, v212
    s_mov_b32 s77, 0
    s_mov_b32 s73, 0
    s_mul_i32 s27, s83, 6144
    s_add_u32 s27, s27, 8192
    v_lshlrev_b32 v4, 4, v0
    v_add_u32 v4, s27, v4
    s_mul_i32 s27, s84, 2048
    s_add_u32 s27, s27, 57344
    v_lshlrev_b32 v5, 4, v0
    v_add_u32 v5, s27, v5
    v_mov_b32 v16, 0
    v_mov_b32 v17, 0
    v_mov_b32 v18, 0
    v_mov_b32 v19, 0
    v_mov_b32 v20, 0
    v_mov_b32 v21, 0
    v_mov_b32 v22, 0
    v_mov_b32 v23, 0
    v_mov_b32 v24, 0
    v_mov_b32 v25, 0
    v_mov_b32 v26, 0
    v_mov_b32 v27, 0
    v_mov_b32 v28, 0
    v_mov_b32 v29, 0
    v_mov_b32 v30, 0
    v_mov_b32 v31, 0
    v_mov_b32 v32, 0
    v_mov_b32 v33, 0
    v_mov_b32 v34, 0
    v_mov_b32 v35, 0
    v_mov_b32 v36, 0
    v_mov_b32 v37, 0
    v_mov_b32 v38, 0
    v_mov_b32 v39, 0
    v_mov_b32 v40, 0
    v_mov_b32 v41, 0
    v_mov_b32 v42, 0
    v_mov_b32 v43, 0
    v_mov_b32 v44, 0
    v_mov_b32 v45, 0
    v_mov_b32 v46, 0
    v_mov_b32 v47, 0
    v_mov_b32 v48, 0
    v_mov_b32 v49, 0
    v_mov_b32 v50, 0
    v_mov_b32 v51, 0
    v_mov_b32 v52, 0
    v_mov_b32 v53, 0
    v_mov_b32 v54, 0
    v_mov_b32 v55, 0
    v_mov_b32 v56, 0
    v_mov_b32 v57, 0
    v_mov_b32 v58, 0
    v_mov_b32 v59, 0
    v_mov_b32 v60, 0
    v_mov_b32 v61, 0
    v_mov_b32 v62, 0
    v_mov_b32 v63, 0
    v_and_b32 v215, 15, v0
    v_lshlrev_b32 v215, 6, v215
    v_lshrrev_b32 v2, 4, v0
    v_lshl_add_u32 v215, v2, 4, v215
    s_mul_i32 s27, s84, 6144
    s_add_u32 s27, s27, 135168
    v_add_u32 v215, s27, v215
    v_lshlrev_b32 v152, 5, v2
    v_add_u32 v152, 159744, v152
    ds_read_b128 v[176:179], v215 offset:0
    ds_read_b128 v[180:183], v215 offset:1024
    ds_read_b128 v[184:187], v215 offset:2048
    ds_read_b128 v[188:191], v215 offset:3072
    ds_read_b128 v[192:195], v215 offset:4096
    ds_read_b128 v[196:199], v215 offset:5120
    ds_read_b128 v[128:131], v152 offset:0
    ds_read_b128 v[132:135], v152 offset:16
    ds_read_b128 v[136:139], v152 offset:128
    ds_read_b128 v[140:143], v152 offset:144
    ds_read_b128 v[144:147], v152 offset:256
    ds_read_b128 v[148:151], v152 offset:272
    s_waitcnt lgkmcnt(0)
    v_mov_b32 v206, 0xff61b1e6
    v_mov_b32 v207, 0xff61b1e6
    v_mov_b32 v208, 0xff61b1e6
    v_mov_b32 v209, 0xff61b1e6
    v_mov_b32 v210, 0
    v_mov_b32 v211, 0
    s_mov_b32 s78, 0xc2800000
    v_mov_b32 v213, 163776
    ds_write_b32 v213, v210
    s_waitcnt lgkmcnt(0)
    s_mov_b32 s33, 0
    s_mov_b32 s31, 0
    s_mov_b32 s30, 12288
    s_mov_b32 s32, 16384
    s_mov_b32 s34, 8
    s_barrier
    s_add_u32 s27, s77, s73
    s_and_b32 s27, s27, 2047
    s_andn2_b32 s28, s77, 2047
    s_add_u32 s27, s27, s28
    v_add_u32 v213, s27, v212
    ds_read_b128 v[200:203], v213
    s_add_u32 s77, s77, 256
    ds_read_b128 v[88:91], v5 offset:0
    ds_read_b128 v[92:95], v5 offset:1024
    ds_read_b128 v[64:67], v4 offset:0
    ds_read_b128 v[68:71], v4 offset:1024
    ds_read_b128 v[72:75], v4 offset:2048
    ds_read_b128 v[76:79], v4 offset:3072
    ds_read_b128 v[80:83], v4 offset:4096
    ds_read_b128 v[84:87], v4 offset:5120
    s_waitcnt lgkmcnt(8)
    v_max_f32 v206, v206, v200
    v_max_f32 v207, v207, v201
    v_add_f32 v213, s78, v206
    v_add_f32 v214, s78, v207
    v_max_f32 v213, v213, v200
    v_max_f32 v214, v214, v201
    v_sub_f32 v204, v208, v213
    v_sub_f32 v205, v209, v214
    v_exp_f32 v204, v204
    v_exp_f32 v205, v205
    v_mov_b32 v208, v213
    v_mov_b32 v209, v214
    v_fma_f32 v210, v210, v204, v202
    v_fma_f32 v211, v211, v205, v203
    s_waitcnt lgkmcnt(0)
pv_mm_80:
    v_mul_f32 v16, v204, v16
    v_mul_f32 v17, v204, v17
    v_mul_f32 v18, v204, v18
    v_mul_f32 v19, v204, v19
    v_mul_f32 v20, v205, v20
    v_mul_f32 v21, v205, v21
    v_mul_f32 v22, v205, v22
    v_mul_f32 v23, v205, v23
    v_mfma_f32_16x16x32_bf16 v[16:19], v[64:67], v[88:91], v[16:19]
    ds_read_b128 v[120:123], v5 offset:8192
    v_mul_f32 v24, v204, v24
    v_mul_f32 v25, v204, v25
    v_mul_f32 v26, v204, v26
    v_mul_f32 v27, v204, v27
    v_mfma_f32_16x16x32_bf16 v[20:23], v[64:67], v[92:95], v[20:23]
    ds_read_b128 v[124:127], v5 offset:9216
    v_mul_f32 v28, v205, v28
    v_mul_f32 v29, v205, v29
    v_mul_f32 v30, v205, v30
    v_mul_f32 v31, v205, v31
    v_mfma_f32_16x16x32_bf16 v[24:27], v[68:71], v[88:91], v[24:27]
    ds_read_b128 v[96:99], v4 offset:6144
    v_mul_f32 v32, v204, v32
    v_mul_f32 v33, v204, v33
    v_mul_f32 v34, v204, v34
    v_mul_f32 v35, v204, v35
    v_mfma_f32_16x16x32_bf16 v[28:31], v[68:71], v[92:95], v[28:31]
    ds_read_b128 v[100:103], v4 offset:7168
    v_mul_f32 v36, v205, v36
    v_mul_f32 v37, v205, v37
    v_mul_f32 v38, v205, v38
    v_mul_f32 v39, v205, v39
    v_mfma_f32_16x16x32_bf16 v[32:35], v[72:75], v[88:91], v[32:35]
    ds_read_b128 v[104:107], v4 offset:8192
    v_mul_f32 v40, v204, v40
    v_mul_f32 v41, v204, v41
    v_mul_f32 v42, v204, v42
    v_mul_f32 v43, v204, v43
    v_mfma_f32_16x16x32_bf16 v[36:39], v[72:75], v[92:95], v[36:39]
    ds_read_b128 v[108:111], v4 offset:9216
    v_mul_f32 v44, v205, v44
    v_mul_f32 v45, v205, v45
    v_mul_f32 v46, v205, v46
    v_mul_f32 v47, v205, v47
    v_mfma_f32_16x16x32_bf16 v[40:43], v[76:79], v[88:91], v[40:43]
    ds_read_b128 v[112:115], v4 offset:10240
    v_mul_f32 v48, v204, v48
    v_mul_f32 v49, v204, v49
    v_mul_f32 v50, v204, v50
    v_mul_f32 v51, v204, v51
    v_mfma_f32_16x16x32_bf16 v[44:47], v[76:79], v[92:95], v[44:47]
    ds_read_b128 v[116:119], v4 offset:11264
    v_mul_f32 v52, v205, v52
    v_mul_f32 v53, v205, v53
    v_mul_f32 v54, v205, v54
    v_mul_f32 v55, v205, v55
    v_mfma_f32_16x16x32_bf16 v[48:51], v[80:83], v[88:91], v[48:51]
    s_add_u32 s33, s33, 1
    v_mul_f32 v56, v204, v56
    v_mul_f32 v57, v204, v57
    v_mul_f32 v58, v204, v58
    v_mul_f32 v59, v204, v59
    v_mfma_f32_16x16x32_bf16 v[52:55], v[80:83], v[92:95], v[52:55]
    s_cmp_eq_u32 s33, 4
    v_mul_f32 v60, v205, v60
    v_mul_f32 v61, v205, v61
    v_mul_f32 v62, v205, v62
    v_mul_f32 v63, v205, v63
    v_mfma_f32_16x16x32_bf16 v[56:59], v[84:87], v[88:91], v[56:59]
    s_cselect_b32 s35, 4294930432, s30
    s_nop 1
    v_mfma_f32_16x16x32_bf16 v[60:63], v[84:87], v[92:95], v[60:63]
    s_cselect_b32 s29, 4294918144, s32
    s_cselect_b32 s33, 0, s33
    v_add_u32 v4, s35, v4
    v_add_u32 v5, s29, v5
    s_waitcnt lgkmcnt(0)
    s_barrier
    v_mfma_f32_16x16x32_bf16 v[16:19], v[96:99], v[120:123], v[16:19]
    ds_read_b128 v[88:91], v5 offset:0
    v_mfma_f32_16x16x32_bf16 v[20:23], v[96:99], v[124:127], v[20:23]
    ds_read_b128 v[92:95], v5 offset:1024
    v_mfma_f32_16x16x32_bf16 v[24:27], v[100:103], v[120:123], v[24:27]
    ds_read_b128 v[64:67], v4 offset:0
    v_mfma_f32_16x16x32_bf16 v[28:31], v[100:103], v[124:127], v[28:31]
    ds_read_b128 v[68:71], v4 offset:1024
    v_mfma_f32_16x16x32_bf16 v[32:35], v[104:107], v[120:123], v[32:35]
    ds_read_b128 v[72:75], v4 offset:2048
    v_mfma_f32_16x16x32_bf16 v[36:39], v[104:107], v[124:127], v[36:39]
    ds_read_b128 v[76:79], v4 offset:3072
    v_mfma_f32_16x16x32_bf16 v[40:43], v[108:111], v[120:123], v[40:43]
    ds_read_b128 v[80:83], v4 offset:4096
    v_mfma_f32_16x16x32_bf16 v[44:47], v[108:111], v[124:127], v[44:47]
    ds_read_b128 v[84:87], v4 offset:5120
    v_mfma_f32_16x16x32_bf16 v[48:51], v[112:115], v[120:123], v[48:51]
    s_add_u32 s27, s77, s73
    v_mfma_f32_16x16x32_bf16 v[52:55], v[112:115], v[124:127], v[52:55]
    s_and_b32 s27, s27, 2047
    v_mfma_f32_16x16x32_bf16 v[56:59], v[116:119], v[120:123], v[56:59]
    s_andn2_b32 s28, s77, 2047
    v_mfma_f32_16x16x32_bf16 v[60:63], v[116:119], v[124:127], v[60:63]
    s_add_u32 s27, s27, s28
    v_add_u32 v213, s27, v212
    ds_read_b128 v[200:203], v213
    s_add_u32 s77, s77, 256
    s_sub_u32 s34, s34, 1
    s_waitcnt lgkmcnt(0)
    v_mfma_f32_16x16x32_bf16 v[16:19], v[64:67], v[88:91], v[16:19]
    ds_read_b128 v[120:123], v5 offset:8192
    v_mfma_f32_16x16x32_bf16 v[20:23], v[64:67], v[92:95], v[20:23]
    ds_read_b128 v[124:127], v5 offset:9216
    v_mfma_f32_16x16x32_bf16 v[24:27], v[68:71], v[88:91], v[24:27]
    ds_read_b128 v[96:99], v4 offset:6144
    v_mfma_f32_16x16x32_bf16 v[28:31], v[68:71], v[92:95], v[28:31]
    ds_read_b128 v[100:103], v4 offset:7168
    v_mfma_f32_16x16x32_bf16 v[32:35], v[72:75], v[88:91], v[32:35]
    ds_read_b128 v[104:107], v4 offset:8192
    v_mfma_f32_16x16x32_bf16 v[36:39], v[72:75], v[92:95], v[36:39]
    ds_read_b128 v[108:111], v4 offset:9216
    v_mfma_f32_16x16x32_bf16 v[40:43], v[76:79], v[88:91], v[40:43]
    ds_read_b128 v[112:115], v4 offset:10240
    v_mfma_f32_16x16x32_bf16 v[44:47], v[76:79], v[92:95], v[44:47]
    ds_read_b128 v[116:119], v4 offset:11264
    v_mfma_f32_16x16x32_bf16 v[48:51], v[80:83], v[88:91], v[48:51]
    s_add_u32 s33, s33, 1
    v_mfma_f32_16x16x32_bf16 v[52:55], v[80:83], v[92:95], v[52:55]
    s_cmp_eq_u32 s33, 4
    v_mfma_f32_16x16x32_bf16 v[56:59], v[84:87], v[88:91], v[56:59]
    s_cselect_b32 s35, 4294930432, s30
    v_mfma_f32_16x16x32_bf16 v[60:63], v[84:87], v[92:95], v[60:63]
    s_cselect_b32 s29, 4294918144, s32
    s_cselect_b32 s33, 0, s33
    v_add_u32 v4, s35, v4
    v_add_u32 v5, s29, v5
    s_waitcnt lgkmcnt(0)
    s_cmp_eq_u32 s34, 0
    s_cbranch_scc1 pv_last_81
    s_barrier
    v_mfma_f32_16x16x32_bf16 v[16:19], v[96:99], v[120:123], v[16:19]
    ds_read_b128 v[88:91], v5 offset:0
    ds_read_b128 v[92:95], v5 offset:1024
    v_mfma_f32_16x16x32_bf16 v[20:23], v[96:99], v[124:127], v[20:23]
    ds_read_b128 v[64:67], v4 offset:0
    ds_read_b128 v[68:71], v4 offset:1024
    v_mfma_f32_16x16x32_bf16 v[24:27], v[100:103], v[120:123], v[24:27]
    ds_read_b128 v[72:75], v4 offset:2048
    ds_read_b128 v[76:79], v4 offset:3072
    v_mfma_f32_16x16x32_bf16 v[28:31], v[100:103], v[124:127], v[28:31]
    ds_read_b128 v[80:83], v4 offset:4096
    ds_read_b128 v[84:87], v4 offset:5120
    v_mfma_f32_16x16x32_bf16 v[32:35], v[104:107], v[120:123], v[32:35]
    v_max_f32 v206, v206, v200
    v_max_f32 v207, v207, v201
    v_mfma_f32_16x16x32_bf16 v[36:39], v[104:107], v[124:127], v[36:39]
    v_add_f32 v213, s78, v206
    v_add_f32 v214, s78, v207
    v_mfma_f32_16x16x32_bf16 v[40:43], v[108:111], v[120:123], v[40:43]
    v_max_f32 v213, v213, v200
    v_max_f32 v214, v214, v201
    v_mfma_f32_16x16x32_bf16 v[44:47], v[108:111], v[124:127], v[44:47]
    v_sub_f32 v204, v208, v213
    v_sub_f32 v205, v209, v214
    v_mfma_f32_16x16x32_bf16 v[48:51], v[112:115], v[120:123], v[48:51]
    v_exp_f32 v204, v204
    v_exp_f32 v205, v205
    v_mfma_f32_16x16x32_bf16 v[52:55], v[112:115], v[124:127], v[52:55]
    v_mov_b32 v208, v213
    v_mov_b32 v209, v214
    v_mfma_f32_16x16x32_bf16 v[56:59], v[116:119], v[120:123], v[56:59]
    v_fma_f32 v210, v210, v204, v202
    v_fma_f32 v211, v211, v205, v203
    v_mfma_f32_16x16x32_bf16 v[60:63], v[116:119], v[124:127], v[60:63]
    s_waitcnt lgkmcnt(0)
    s_branch pv_mm_80
pv_last_81:
    s_waitcnt vmcnt(0)
    v_mfma_f32_16x16x32_bf16 v[16:19], v[96:99], v[120:123], v[16:19]
    v_rcp_f32 v210, v210
    v_rcp_f32 v211, v211
    v_mfma_f32_16x16x32_bf16 v[20:23], v[96:99], v[124:127], v[20:23]
    v_mfma_f32_16x16x32_bf16 v[24:27], v[100:103], v[120:123], v[24:27]
    v_mfma_f32_16x16x32_bf16 v[28:31], v[100:103], v[124:127], v[28:31]
    v_mfma_f32_16x16x32_bf16 v[32:35], v[104:107], v[120:123], v[32:35]
    v_mfma_f32_16x16x32_bf16 v[36:39], v[104:107], v[124:127], v[36:39]
    v_mfma_f32_16x16x32_bf16 v[40:43], v[108:111], v[120:123], v[40:43]
    v_mfma_f32_16x16x32_bf16 v[44:47], v[108:111], v[124:127], v[44:47]
    v_mfma_f32_16x16x32_bf16 v[48:51], v[112:115], v[120:123], v[48:51]
    v_mfma_f32_16x16x32_bf16 v[52:55], v[112:115], v[124:127], v[52:55]
    v_mfma_f32_16x16x32_bf16 v[56:59], v[116:119], v[120:123], v[56:59]
    v_mfma_f32_16x16x32_bf16 v[60:63], v[116:119], v[124:127], v[60:63]
    s_lshl_b32 s27, s75, 7
    s_add_u32 s27, s27, s76
    s_lshl_b32 s28, s84, 1
    s_add_u32 s27, s27, s28
    s_lshl_b32 s26, s27, 10
    v_lshlrev_b32 v1, 4, v0
    s_waitcnt lgkmcnt(0)
    v_lshlrev_b32 v96, 16, v176
    v_and_b32 v97, 0xffff0000, v176
    v_pk_mul_f32 v[16:17], v[16:17], v[210:211] op_sel:[0,0] op_sel_hi:[1,0]
    v_lshlrev_b32 v98, 16, v177
    v_and_b32 v99, 0xffff0000, v177
    v_pk_mul_f32 v[18:19], v[18:19], v[210:211] op_sel:[0,0] op_sel_hi:[1,0]
    v_lshlrev_b32 v100, 16, v178
    v_and_b32 v101, 0xffff0000, v178
    v_pk_mul_f32 v[24:25], v[24:25], v[210:211] op_sel:[0,0] op_sel_hi:[1,0]
    v_lshlrev_b32 v102, 16, v179
    v_and_b32 v103, 0xffff0000, v179
    v_pk_mul_f32 v[26:27], v[26:27], v[210:211] op_sel:[0,0] op_sel_hi:[1,0]
    v_pk_fma_f32 v[16:17], v[16:17], v[128:129], v[96:97]
    v_pk_fma_f32 v[18:19], v[18:19], v[130:131], v[98:99]
    v_pk_fma_f32 v[24:25], v[24:25], v[132:133], v[100:101]
    v_pk_fma_f32 v[26:27], v[26:27], v[134:135], v[102:103]
    v_cvt_pk_bf16_f32 v64, v16, v17
    v_cvt_pk_bf16_f32 v65, v18, v19
    v_cvt_pk_bf16_f32 v66, v24, v25
    v_cvt_pk_bf16_f32 v67, v26, v27
    s_add_u32 s27, s26, 0
    buffer_store_dwordx4 v[64:67], v1, s[12:15], s27 offen offset:0 sc1
    v_lshlrev_b32 v96, 16, v180
    v_and_b32 v97, 0xffff0000, v180
    v_pk_mul_f32 v[20:21], v[20:21], v[210:211] op_sel:[0,1] op_sel_hi:[1,1]
    v_lshlrev_b32 v98, 16, v181
    v_and_b32 v99, 0xffff0000, v181
    v_pk_mul_f32 v[22:23], v[22:23], v[210:211] op_sel:[0,1] op_sel_hi:[1,1]
    v_lshlrev_b32 v100, 16, v182
    v_and_b32 v101, 0xffff0000, v182
    v_pk_mul_f32 v[28:29], v[28:29], v[210:211] op_sel:[0,1] op_sel_hi:[1,1]
    v_lshlrev_b32 v102, 16, v183
    v_and_b32 v103, 0xffff0000, v183
    v_pk_mul_f32 v[30:31], v[30:31], v[210:211] op_sel:[0,1] op_sel_hi:[1,1]
    v_pk_fma_f32 v[20:21], v[20:21], v[128:129], v[96:97]
    v_pk_fma_f32 v[22:23], v[22:23], v[130:131], v[98:99]
    v_pk_fma_f32 v[28:29], v[28:29], v[132:133], v[100:101]
    v_pk_fma_f32 v[30:31], v[30:31], v[134:135], v[102:103]
    v_cvt_pk_bf16_f32 v68, v20, v21
    v_cvt_pk_bf16_f32 v69, v22, v23
    v_cvt_pk_bf16_f32 v70, v28, v29
    v_cvt_pk_bf16_f32 v71, v30, v31
    s_add_u32 s27, s26, 0
    buffer_store_dwordx4 v[68:71], v1, s[12:15], s27 offen offset:1024 sc1
    v_lshlrev_b32 v96, 16, v184
    v_and_b32 v97, 0xffff0000, v184
    v_pk_mul_f32 v[32:33], v[32:33], v[210:211] op_sel:[0,0] op_sel_hi:[1,0]
    v_lshlrev_b32 v98, 16, v185
    v_and_b32 v99, 0xffff0000, v185
    v_pk_mul_f32 v[34:35], v[34:35], v[210:211] op_sel:[0,0] op_sel_hi:[1,0]
    v_lshlrev_b32 v100, 16, v186
    v_and_b32 v101, 0xffff0000, v186
    v_pk_mul_f32 v[40:41], v[40:41], v[210:211] op_sel:[0,0] op_sel_hi:[1,0]
    v_lshlrev_b32 v102, 16, v187
    v_and_b32 v103, 0xffff0000, v187
    v_pk_mul_f32 v[42:43], v[42:43], v[210:211] op_sel:[0,0] op_sel_hi:[1,0]
    v_pk_fma_f32 v[32:33], v[32:33], v[136:137], v[96:97]
    v_pk_fma_f32 v[34:35], v[34:35], v[138:139], v[98:99]
    v_pk_fma_f32 v[40:41], v[40:41], v[140:141], v[100:101]
    v_pk_fma_f32 v[42:43], v[42:43], v[142:143], v[102:103]
    v_cvt_pk_bf16_f32 v72, v32, v33
    v_cvt_pk_bf16_f32 v73, v34, v35
    v_cvt_pk_bf16_f32 v74, v40, v41
    v_cvt_pk_bf16_f32 v75, v42, v43
    s_add_u32 s27, s26, 131072
    buffer_store_dwordx4 v[72:75], v1, s[12:15], s27 offen offset:0 sc1
    v_lshlrev_b32 v96, 16, v188
    v_and_b32 v97, 0xffff0000, v188
    v_pk_mul_f32 v[36:37], v[36:37], v[210:211] op_sel:[0,1] op_sel_hi:[1,1]
    v_lshlrev_b32 v98, 16, v189
    v_and_b32 v99, 0xffff0000, v189
    v_pk_mul_f32 v[38:39], v[38:39], v[210:211] op_sel:[0,1] op_sel_hi:[1,1]
    v_lshlrev_b32 v100, 16, v190
    v_and_b32 v101, 0xffff0000, v190
    v_pk_mul_f32 v[44:45], v[44:45], v[210:211] op_sel:[0,1] op_sel_hi:[1,1]
    v_lshlrev_b32 v102, 16, v191
    v_and_b32 v103, 0xffff0000, v191
    v_pk_mul_f32 v[46:47], v[46:47], v[210:211] op_sel:[0,1] op_sel_hi:[1,1]
    v_pk_fma_f32 v[36:37], v[36:37], v[136:137], v[96:97]
    v_pk_fma_f32 v[38:39], v[38:39], v[138:139], v[98:99]
    v_pk_fma_f32 v[44:45], v[44:45], v[140:141], v[100:101]
    v_pk_fma_f32 v[46:47], v[46:47], v[142:143], v[102:103]
    v_cvt_pk_bf16_f32 v76, v36, v37
    v_cvt_pk_bf16_f32 v77, v38, v39
    v_cvt_pk_bf16_f32 v78, v44, v45
    v_cvt_pk_bf16_f32 v79, v46, v47
    s_add_u32 s27, s26, 131072
    buffer_store_dwordx4 v[76:79], v1, s[12:15], s27 offen offset:1024 sc1
    v_lshlrev_b32 v96, 16, v192
    v_and_b32 v97, 0xffff0000, v192
    v_pk_mul_f32 v[48:49], v[48:49], v[210:211] op_sel:[0,0] op_sel_hi:[1,0]
    v_lshlrev_b32 v98, 16, v193
    v_and_b32 v99, 0xffff0000, v193
    v_pk_mul_f32 v[50:51], v[50:51], v[210:211] op_sel:[0,0] op_sel_hi:[1,0]
    v_lshlrev_b32 v100, 16, v194
    v_and_b32 v101, 0xffff0000, v194
    v_pk_mul_f32 v[56:57], v[56:57], v[210:211] op_sel:[0,0] op_sel_hi:[1,0]
    v_lshlrev_b32 v102, 16, v195
    v_and_b32 v103, 0xffff0000, v195
    v_pk_mul_f32 v[58:59], v[58:59], v[210:211] op_sel:[0,0] op_sel_hi:[1,0]
    v_pk_fma_f32 v[48:49], v[48:49], v[144:145], v[96:97]
    v_pk_fma_f32 v[50:51], v[50:51], v[146:147], v[98:99]
    v_pk_fma_f32 v[56:57], v[56:57], v[148:149], v[100:101]
    v_pk_fma_f32 v[58:59], v[58:59], v[150:151], v[102:103]
    v_cvt_pk_bf16_f32 v80, v48, v49
    v_cvt_pk_bf16_f32 v81, v50, v51
    v_cvt_pk_bf16_f32 v82, v56, v57
    v_cvt_pk_bf16_f32 v83, v58, v59
    s_add_u32 s27, s26, 262144
    buffer_store_dwordx4 v[80:83], v1, s[12:15], s27 offen offset:0 sc1
    v_lshlrev_b32 v96, 16, v196
    v_and_b32 v97, 0xffff0000, v196
    v_pk_mul_f32 v[52:53], v[52:53], v[210:211] op_sel:[0,1] op_sel_hi:[1,1]
    v_lshlrev_b32 v98, 16, v197
    v_and_b32 v99, 0xffff0000, v197
    v_pk_mul_f32 v[54:55], v[54:55], v[210:211] op_sel:[0,1] op_sel_hi:[1,1]
    v_lshlrev_b32 v100, 16, v198
    v_and_b32 v101, 0xffff0000, v198
    v_pk_mul_f32 v[60:61], v[60:61], v[210:211] op_sel:[0,1] op_sel_hi:[1,1]
    v_lshlrev_b32 v102, 16, v199
    v_and_b32 v103, 0xffff0000, v199
    v_pk_mul_f32 v[62:63], v[62:63], v[210:211] op_sel:[0,1] op_sel_hi:[1,1]
    v_pk_fma_f32 v[52:53], v[52:53], v[144:145], v[96:97]
    v_pk_fma_f32 v[54:55], v[54:55], v[146:147], v[98:99]
    v_pk_fma_f32 v[60:61], v[60:61], v[148:149], v[100:101]
    v_pk_fma_f32 v[62:63], v[62:63], v[150:151], v[102:103]
    v_cvt_pk_bf16_f32 v84, v52, v53
    v_cvt_pk_bf16_f32 v85, v54, v55
    v_cvt_pk_bf16_f32 v86, v60, v61
    v_cvt_pk_bf16_f32 v87, v62, v63
    s_add_u32 s27, s26, 262144
    buffer_store_dwordx4 v[84:87], v1, s[12:15], s27 offen offset:1024 sc1
    s_mov_b64 exec, -1
    s_lshl_b32 s27, s72, 7
    v_mov_b32 v8, 0
    v_mov_b32 v9, 1
    s_cmp_lg_u32 s3, 0
    s_waitcnt vmcnt(0)
    s_barrier
    s_cbranch_scc1 sig_82
    s_mov_b64 exec, 1
    buffer_store_dword v9, v8, s[36:39], s27 offen sc1
    s_mov_b64 exec, -1
sig_82:
pv_exit_83:
    s_mov_b64 exec, -1
    s_branch next_task
pv_loader_78:
    s_and_b32 s82, s3, 1
    s_cmp_ge_u32 s3, 6
    s_cbranch_scc1 pv_loaderB_79
    v_lshlrev_b32 v1, 4, v0
    s_mul_i32 s31, s82, 73728
    s_add_u32 s31, s31, s24
    s_mul_i32 s32, s82, 6144
    s_add_u32 s32, s32, 8192
    s_mul_i32 s85, s71, 8
    s_add_u32 s85, s85, 639
    v_min_u32 v252, 15, v0
    v_lshlrev_b32 v252, 7, v252
    s_lshl_b32 s27, s85, 7
    s_mov_b32 s34, 131072
    s_mov_b64 exec, 0x3f3f
poll_84:
    buffer_load_dword v253, v252, s[36:39], s27 offen sc1
    s_sub_u32 s34, s34, 1
    s_waitcnt vmcnt(0)
    v_cmp_ne_u32 vcc, 1, v253
    s_cmp_eq_u32 s34, 0
    s_cbranch_scc1 polled_85
    s_cmp_eq_u64 vcc, 0
    s_cbranch_scc1 polled_85
    s_sleep 3
    s_branch poll_84
polled_85:
    s_mov_b64 exec, -1
    s_mov_b32 m0, s32
    s_nop 0
    buffer_load_dwordx4 v1, s[4:7], s31 offen sc1 lds
    buffer_load_dwordx4 v1, s[4:7], s31 offen offset:1024 sc1 lds
    buffer_load_dwordx4 v1, s[4:7], s31 offen offset:2048 sc1 lds
    buffer_load_dwordx4 v1, s[4:7], s31 offen offset:3072 sc1 lds
    s_add_u32 m0, s32, 4096
    s_add_u32 s27, s31, 4096
    buffer_load_dwordx4 v1, s[4:7], s27 offen sc1 lds
    buffer_load_dwordx4 v1, s[4:7], s27 offen offset:1024 sc1 lds
    s_add_u32 s31, s31, 147456
    s_add_u32 m0, s32, 12288
    s_nop 0
    buffer_load_dwordx4 v1, s[4:7], s31 offen sc1 lds
    buffer_load_dwordx4 v1, s[4:7], s31 offen offset:1024 sc1 lds
    buffer_load_dwordx4 v1, s[4:7], s31 offen offset:2048 sc1 lds
    buffer_load_dwordx4 v1, s[4:7], s31 offen offset:3072 sc1 lds
    s_add_u32 m0, s32, 16384
    s_add_u32 s27, s31, 4096
    buffer_load_dwordx4 v1, s[4:7], s27 offen sc1 lds
    buffer_load_dwordx4 v1, s[4:7], s27 offen offset:1024 sc1 lds
    s_add_u32 s31, s31, 147456
    s_add_u32 m0, s32, 24576
    s_nop 0
    buffer_load_dwordx4 v1, s[4:7], s31 offen sc1 lds
    buffer_load_dwordx4 v1, s[4:7], s31 offen offset:1024 sc1 lds
    buffer_load_dwordx4 v1, s[4:7], s31 offen offset:2048 sc1 lds
    buffer_load_dwordx4 v1, s[4:7], s31 offen offset:3072 sc1 lds
    s_add_u32 m0, s32, 28672
    s_add_u32 s27, s31, 4096
    buffer_load_dwordx4 v1, s[4:7], s27 offen sc1 lds
    buffer_load_dwordx4 v1, s[4:7], s27 offen offset:1024 sc1 lds
    s_add_u32 s31, s31, 147456
    s_waitcnt vmcnt(12)
    s_barrier
    s_add_u32 m0, s32, 36864
    s_nop 0
    buffer_load_dwordx4 v1, s[4:7], s31 offen sc1 lds
    buffer_load_dwordx4 v1, s[4:7], s31 offen offset:1024 sc1 lds
    buffer_load_dwordx4 v1, s[4:7], s31 offen offset:2048 sc1 lds
    buffer_load_dwordx4 v1, s[4:7], s31 offen offset:3072 sc1 lds
    s_add_u32 m0, s32, 40960
    s_add_u32 s27, s31, 4096
    buffer_load_dwordx4 v1, s[4:7], s27 offen sc1 lds
    buffer_load_dwordx4 v1, s[4:7], s27 offen offset:1024 sc1 lds
    s_add_u32 s31, s31, 147456
    s_mov_b32 s33, 0
    s_mov_b32 s34, 6
pv_ld_86:
    s_waitcnt vmcnt(12)
    s_barrier
    s_add_u32 s28, s32, s33
    s_mov_b32 m0, s28
    s_nop 0
    buffer_load_dwordx4 v1, s[4:7], s31 offen sc1 lds
    buffer_load_dwordx4 v1, s[4:7], s31 offen offset:1024 sc1 lds
    buffer_load_dwordx4 v1, s[4:7], s31 offen offset:2048 sc1 lds
    buffer_load_dwordx4 v1, s[4:7], s31 offen offset:3072 sc1 lds
    s_add_u32 m0, s28, 4096
    s_add_u32 s27, s31, 4096
    buffer_load_dwordx4 v1, s[4:7], s27 offen sc1 lds
    buffer_load_dwordx4 v1, s[4:7], s27 offen offset:1024 sc1 lds
    s_add_u32 s31, s31, 147456
    s_add_u32 s33, s33, 12288
    s_cmp_eq_u32 s33, 49152
    s_cselect_b32 s33, 0, s33
    s_sub_u32 s34, s34, 1
    s_cmp_lg_u32 s34, 0
    s_cbranch_scc1 pv_ld_86
    v_lshlrev_b32 v8, 7, v0
    s_lshl_b32 s85, s71, 3
    s_add_u32 s85, s85, 639
    s_lshl_b32 s27, s85, 7
    s_mov_b64 exec, 0xc0c0
    buffer_load_dword v9, v8, s[36:39], s27 offen sc1
    s_mov_b64 exec, -1
    s_mov_b32 s34, 2
pv_ld_87:
    s_waitcnt vmcnt(12)
    s_barrier
    s_add_u32 s28, s32, s33
    s_mov_b32 m0, s28
    s_nop 0
    buffer_load_dwordx4 v1, s[4:7], s31 offen sc1 lds
    buffer_load_dwordx4 v1, s[4:7], s31 offen offset:1024 sc1 lds
    buffer_load_dwordx4 v1, s[4:7], s31 offen offset:2048 sc1 lds
    buffer_load_dwordx4 v1, s[4:7], s31 offen offset:3072 sc1 lds
    s_add_u32 m0, s28, 4096
    s_add_u32 s27, s31, 4096
    buffer_load_dwordx4 v1, s[4:7], s27 offen sc1 lds
    buffer_load_dwordx4 v1, s[4:7], s27 offen offset:1024 sc1 lds
    s_add_u32 s31, s31, 147456
    s_add_u32 s33, s33, 12288
    s_cmp_eq_u32 s33, 49152
    s_cselect_b32 s33, 0, s33
    s_sub_u32 s34, s34, 1
    s_cmp_lg_u32 s34, 0
    s_cbranch_scc1 pv_ld_87
    s_mov_b64 exec, 0xc0c0
    s_waitcnt vmcnt(12)
    v_cmp_ne_u32 vcc, 1, v9
    s_mov_b64 exec, -1
    s_cmp_eq_u64 vcc, 0
    s_cbranch_scc1 nbv_88
    v_min_u32 v252, 15, v0
    v_lshlrev_b32 v252, 7, v252
    s_lshl_b32 s27, s85, 7
    s_mov_b32 s34, 131072
    s_mov_b64 exec, 0xc0c0
poll_89:
    buffer_load_dword v253, v252, s[36:39], s27 offen sc1
    s_sub_u32 s34, s34, 1
    s_waitcnt vmcnt(0)
    v_cmp_ne_u32 vcc, 1, v253
    s_cmp_eq_u32 s34, 0
    s_cbranch_scc1 polled_90
    s_cmp_eq_u64 vcc, 0
    s_cbranch_scc1 polled_90
    s_sleep 3
    s_branch poll_89
polled_90:
    s_mov_b64 exec, -1
nbv_88:
    s_mov_b32 s34, 4
pv_ld_91:
    s_waitcnt vmcnt(12)
    s_barrier
    s_add_u32 s28, s32, s33
    s_mov_b32 m0, s28
    s_nop 0
    buffer_load_dwordx4 v1, s[4:7], s31 offen sc1 lds
    buffer_load_dwordx4 v1, s[4:7], s31 offen offset:1024 sc1 lds
    buffer_load_dwordx4 v1, s[4:7], s31 offen offset:2048 sc1 lds
    buffer_load_dwordx4 v1, s[4:7], s31 offen offset:3072 sc1 lds
    s_add_u32 m0, s28, 4096
    s_add_u32 s27, s31, 4096
    buffer_load_dwordx4 v1, s[4:7], s27 offen sc1 lds
    buffer_load_dwordx4 v1, s[4:7], s27 offen offset:1024 sc1 lds
    s_add_u32 s31, s31, 147456
    s_add_u32 s33, s33, 12288
    s_cmp_eq_u32 s33, 49152
    s_cselect_b32 s33, 0, s33
    s_sub_u32 s34, s34, 1
    s_cmp_lg_u32 s34, 0
    s_cbranch_scc1 pv_ld_91
    s_waitcnt vmcnt(12)
    s_barrier
    s_waitcnt vmcnt(6)
    s_barrier
    s_waitcnt vmcnt(0)
    s_barrier
    v_lshlrev_b32 v8, 7, v0
    s_lshr_b32 s66, s64, 2
    s_mul_i32 s85, s66, 9
    s_add_u32 s85, s85, 959
    s_lshl_b32 s85, s85, 7
    s_mov_b64 exec, 0x1ff
    buffer_load_dword v9, v8, s[36:39], s85 offen sc1
    s_waitcnt vmcnt(0)
    v_cmp_ne_u32 vcc, 1, v9
    s_nop 0
    s_cmp_eq_u64 vcc, 0
    s_cbranch_scc1 echk_92
echk_92:
    s_mov_b64 exec, -1
    s_cselect_b32 s81, 3, 0
    s_barrier
    s_branch pv_exit_83
pv_loaderB_79:
    v_lshlrev_b32 v1, 4, v0
    s_mul_i32 s31, s82, 65536
    s_add_u32 s31, s31, s25
    s_mul_i32 s32, s82, 8192
    s_add_u32 s32, s32, 57344
    s_mul_i32 s85, s70, 8
    s_add_u32 s85, s85, 511
    v_min_u32 v252, 7, v0
    v_lshlrev_b32 v252, 7, v252
    s_lshl_b32 s27, s85, 7
    s_mov_b32 s34, 131072
    s_mov_b64 exec, 0xff
poll_93:
    buffer_load_dword v253, v252, s[36:39], s27 offen sc1
    s_sub_u32 s34, s34, 1
    s_waitcnt vmcnt(0)
    v_cmp_ne_u32 vcc, 1, v253
    s_cmp_eq_u32 s34, 0
    s_cbranch_scc1 polled_94
    s_cmp_eq_u64 vcc, 0
    s_cbranch_scc1 polled_94
    s_sleep 3
    s_branch poll_93
polled_94:
    s_mov_b64 exec, -1
    s_add_u32 s16, s62, 180224
    s_addc_u32 s17, s63, 0
    s_mov_b32 s18, 131072
    s_mov_b32 s19, 0x00020000
    s_lshl_b32 s28, s82, 12
    s_mov_b32 m0, s28
    s_lshl_b32 s27, s70, 13
    s_add_u32 s27, s27, s28
    buffer_load_dwordx4 v1, s[16:19], s27 offen offset:0 sc1 lds
    buffer_load_dwordx4 v1, s[16:19], s27 offen offset:1024 sc1 lds
    buffer_load_dwordx4 v1, s[16:19], s27 offen offset:2048 sc1 lds
    buffer_load_dwordx4 v1, s[16:19], s27 offen offset:3072 sc1 lds
    s_mov_b32 m0, s32
    s_nop 0
    buffer_load_dwordx4 v1, s[8:11], s31 offen sc1 lds
    buffer_load_dwordx4 v1, s[8:11], s31 offen offset:1024 sc1 lds
    buffer_load_dwordx4 v1, s[8:11], s31 offen offset:2048 sc1 lds
    buffer_load_dwordx4 v1, s[8:11], s31 offen offset:3072 sc1 lds
    s_add_u32 m0, s32, 4096
    s_add_u32 s27, s31, 4096
    buffer_load_dwordx4 v1, s[8:11], s27 offen sc1 lds
    buffer_load_dwordx4 v1, s[8:11], s27 offen offset:1024 sc1 lds
    buffer_load_dwordx4 v1, s[8:11], s27 offen offset:2048 sc1 lds
    buffer_load_dwordx4 v1, s[8:11], s27 offen offset:3072 sc1 lds
    s_add_u32 s31, s31, 131072
    s_add_u32 m0, s32, 16384
    s_nop 0
    buffer_load_dwordx4 v1, s[8:11], s31 offen sc1 lds
    buffer_load_dwordx4 v1, s[8:11], s31 offen offset:1024 sc1 lds
    buffer_load_dwordx4 v1, s[8:11], s31 offen offset:2048 sc1 lds
    buffer_load_dwordx4 v1, s[8:11], s31 offen offset:3072 sc1 lds
    s_add_u32 m0, s32, 20480
    s_add_u32 s27, s31, 4096
    buffer_load_dwordx4 v1, s[8:11], s27 offen sc1 lds
    buffer_load_dwordx4 v1, s[8:11], s27 offen offset:1024 sc1 lds
    buffer_load_dwordx4 v1, s[8:11], s27 offen offset:2048 sc1 lds
    buffer_load_dwordx4 v1, s[8:11], s27 offen offset:3072 sc1 lds
    s_add_u32 s31, s31, 131072
    s_add_u32 m0, s32, 32768
    s_nop 0
    buffer_load_dwordx4 v1, s[8:11], s31 offen sc1 lds
    buffer_load_dwordx4 v1, s[8:11], s31 offen offset:1024 sc1 lds
    buffer_load_dwordx4 v1, s[8:11], s31 offen offset:2048 sc1 lds
    buffer_load_dwordx4 v1, s[8:11], s31 offen offset:3072 sc1 lds
    s_add_u32 m0, s32, 36864
    s_add_u32 s27, s31, 4096
    buffer_load_dwordx4 v1, s[8:11], s27 offen sc1 lds
    buffer_load_dwordx4 v1, s[8:11], s27 offen offset:1024 sc1 lds
    buffer_load_dwordx4 v1, s[8:11], s27 offen offset:2048 sc1 lds
    buffer_load_dwordx4 v1, s[8:11], s27 offen offset:3072 sc1 lds
    s_add_u32 s31, s31, 131072
    s_waitcnt vmcnt(16)
    s_barrier
    s_add_u32 m0, s32, 49152
    s_nop 0
    buffer_load_dwordx4 v1, s[8:11], s31 offen sc1 lds
    buffer_load_dwordx4 v1, s[8:11], s31 offen offset:1024 sc1 lds
    buffer_load_dwordx4 v1, s[8:11], s31 offen offset:2048 sc1 lds
    buffer_load_dwordx4 v1, s[8:11], s31 offen offset:3072 sc1 lds
    s_add_u32 m0, s32, 53248
    s_add_u32 s27, s31, 4096
    buffer_load_dwordx4 v1, s[8:11], s27 offen sc1 lds
    buffer_load_dwordx4 v1, s[8:11], s27 offen offset:1024 sc1 lds
    buffer_load_dwordx4 v1, s[8:11], s27 offen offset:2048 sc1 lds
    buffer_load_dwordx4 v1, s[8:11], s27 offen offset:3072 sc1 lds
    s_add_u32 s31, s31, 131072
    s_mov_b32 s33, 0
    s_mov_b32 s34, 12
pv_ld_95:
    s_waitcnt vmcnt(16)
    s_barrier
    s_add_u32 s28, s32, s33
    s_mov_b32 m0, s28
    s_nop 0
    buffer_load_dwordx4 v1, s[8:11], s31 offen sc1 lds
    buffer_load_dwordx4 v1, s[8:11], s31 offen offset:1024 sc1 lds
    buffer_load_dwordx4 v1, s[8:11], s31 offen offset:2048 sc1 lds
    buffer_load_dwordx4 v1, s[8:11], s31 offen offset:3072 sc1 lds
    s_add_u32 m0, s28, 4096
    s_add_u32 s27, s31, 4096
    buffer_load_dwordx4 v1, s[8:11], s27 offen sc1 lds
    buffer_load_dwordx4 v1, s[8:11], s27 offen offset:1024 sc1 lds
    buffer_load_dwordx4 v1, s[8:11], s27 offen offset:2048 sc1 lds
    buffer_load_dwordx4 v1, s[8:11], s27 offen offset:3072 sc1 lds
    s_add_u32 s31, s31, 131072
    s_add_u32 s33, s33, 16384
    s_cmp_eq_u32 s33, 65536
    s_cselect_b32 s33, 0, s33
    s_sub_u32 s34, s34, 1
    s_cmp_lg_u32 s34, 0
    s_cbranch_scc1 pv_ld_95
    s_waitcnt vmcnt(16)
    s_barrier
    s_waitcnt vmcnt(8)
    s_barrier
    s_waitcnt vmcnt(0)
    s_barrier
    v_lshlrev_b32 v8, 7, v0
    s_lshr_b32 s66, s64, 2
    s_mul_i32 s85, s66, 9
    s_add_u32 s85, s85, 959
    s_lshl_b32 s85, s85, 7
    s_mov_b64 exec, 0x1ff
    buffer_load_dword v9, v8, s[36:39], s85 offen sc1
    s_waitcnt vmcnt(0)
    v_cmp_ne_u32 vcc, 1, v9
    s_nop 0
    s_cmp_eq_u64 vcc, 0
    s_cbranch_scc1 echk_96
echk_96:
    s_mov_b64 exec, -1
    s_cselect_b32 s81, 3, 0
    s_barrier
    s_branch pv_exit_83
role_AT:
    s_mul_i32 s24, s68, 294912
    s_mul_i32 s25, s67, 5120
    s_mul_i32 s75, s68, 4
    s_mul_i32 s76, s67, 5
    s_mul_i32 s72, s67, 9
    s_add_u32 s72, s72, s68
    s_add_u32 s72, s72, 959
    s_mul_i32 s74, s67, 9
    s_mov_b32 s4, s50
    s_mov_b32 s5, s51
    s_mov_b32 s6, 2654208
    s_mov_b32 s7, 0x00020000
    s_add_u32 s8, s62, 23969792
    s_addc_u32 s9, s63, 0
    s_mov_b32 s10, 737280
    s_mov_b32 s11, 0x00020000
    s_add_u32 s12, s62, 24707072
    s_addc_u32 s13, s63, 0
    s_mov_b32 s14, 368640
    s_mov_b32 s15, 0x00020000
    s_cmp_ge_u32 s3, 4
    s_cbranch_scc1 at_loader_97
    s_and_b32 s84, s3, 0
    s_lshr_b32 s83, s3, 0
    s_mul_i32 s27, s83, 4096
    s_add_u32 s27, s27, 0
    v_bfe_u32 v2, v0, 1, 3
    v_lshrrev_b32 v3, 4, v0
    v_xor_b32 v2, v2, v3
    v_lshlrev_b32 v2, 4, v2
    v_and_b32 v3, 15, v0
    v_lshl_add_u32 v4, v3, 7, v2
    v_add_u32 v4, s27, v4
    v_xor_b32 v5, 64, v4
    s_mul_i32 s27, s84, 5120
    s_add_u32 s27, s27, 65536
    v_lshlrev_b32 v6, 4, v0
    v_add_u32 v6, s27, v6
    v_mov_b32 v16, 0
    v_mov_b32 v17, 0
    v_mov_b32 v18, 0
    v_mov_b32 v19, 0
    v_mov_b32 v20, 0
    v_mov_b32 v21, 0
    v_mov_b32 v22, 0
    v_mov_b32 v23, 0
    v_mov_b32 v24, 0
    v_mov_b32 v25, 0
    v_mov_b32 v26, 0
    v_mov_b32 v27, 0
    v_mov_b32 v28, 0
    v_mov_b32 v29, 0
    v_mov_b32 v30, 0
    v_mov_b32 v31, 0
    v_mov_b32 v32, 0
    v_mov_b32 v33, 0
    v_mov_b32 v34, 0
    v_mov_b32 v35, 0
    v_mov_b32 v36, 0
    v_mov_b32 v37, 0
    v_mov_b32 v38, 0
    v_mov_b32 v39, 0
    v_mov_b32 v40, 0
    v_mov_b32 v41, 0
    v_mov_b32 v42, 0
    v_mov_b32 v43, 0
    v_mov_b32 v44, 0
    v_mov_b32 v45, 0
    v_mov_b32 v46, 0
    v_mov_b32 v47, 0
    v_mov_b32 v48, 0
    v_mov_b32 v49, 0
    v_mov_b32 v50, 0
    v_mov_b32 v51, 0
    v_mov_b32 v52, 0
    v_mov_b32 v53, 0
    v_mov_b32 v54, 0
    v_mov_b32 v55, 0
    s_mov_b32 s33, 0
    s_mov_b32 s31, 0
    s_mov_b32 s30, 16384
    s_mov_b32 s32, 10240
    s_mov_b32 s34, 17
    s_barrier
    ds_read_b128 v[56:59], v4 offset:0
    ds_read_b128 v[60:63], v4 offset:2048
    ds_read_b128 v[64:67], v6 offset:0
    ds_read_b128 v[68:71], v6 offset:1024
    ds_read_b128 v[72:75], v6 offset:2048
    ds_read_b128 v[76:79], v6 offset:3072
    ds_read_b128 v[80:83], v6 offset:4096
    s_waitcnt lgkmcnt(0)
at_mm_99:
    v_mfma_f32_16x16x32_bf16 v[16:19], v[56:59], v[64:67], v[16:19]
    ds_read_b128 v[84:87], v5 offset:0
    v_mfma_f32_16x16x32_bf16 v[20:23], v[56:59], v[68:71], v[20:23]
    ds_read_b128 v[88:91], v5 offset:2048
    v_mfma_f32_16x16x32_bf16 v[24:27], v[56:59], v[72:75], v[24:27]
    ds_read_b128 v[92:95], v6 offset:5120
    v_mfma_f32_16x16x32_bf16 v[28:31], v[56:59], v[76:79], v[28:31]
    ds_read_b128 v[96:99], v6 offset:6144
    v_mfma_f32_16x16x32_bf16 v[32:35], v[56:59], v[80:83], v[32:35]
    ds_read_b128 v[100:103], v6 offset:7168
    v_mfma_f32_16x16x32_bf16 v[36:39], v[60:63], v[64:67], v[36:39]
    ds_read_b128 v[104:107], v6 offset:8192
    v_mfma_f32_16x16x32_bf16 v[40:43], v[60:63], v[68:71], v[40:43]
    ds_read_b128 v[108:111], v6 offset:9216
    v_mfma_f32_16x16x32_bf16 v[44:47], v[60:63], v[72:75], v[44:47]
    s_add_u32 s33, s33, 1
    v_mfma_f32_16x16x32_bf16 v[48:51], v[60:63], v[76:79], v[48:51]
    s_cmp_eq_u32 s33, 4
    v_mfma_f32_16x16x32_bf16 v[52:55], v[60:63], v[80:83], v[52:55]
    s_cselect_b32 s35, 4294918144, s30
    s_cselect_b32 s29, 4294936576, s32
    s_cselect_b32 s33, 0, s33
    v_add_u32 v4, s35, v4
    v_add_u32 v5, s35, v5
    v_add_u32 v6, s29, v6
    s_waitcnt lgkmcnt(0)
    s_barrier
    v_mfma_f32_16x16x32_bf16 v[16:19], v[84:87], v[92:95], v[16:19]
    ds_read_b128 v[56:59], v4 offset:0
    v_mfma_f32_16x16x32_bf16 v[20:23], v[84:87], v[96:99], v[20:23]
    ds_read_b128 v[60:63], v4 offset:2048
    v_mfma_f32_16x16x32_bf16 v[24:27], v[84:87], v[100:103], v[24:27]
    ds_read_b128 v[64:67], v6 offset:0
    v_mfma_f32_16x16x32_bf16 v[28:31], v[84:87], v[104:107], v[28:31]
    ds_read_b128 v[68:71], v6 offset:1024
    v_mfma_f32_16x16x32_bf16 v[32:35], v[84:87], v[108:111], v[32:35]
    ds_read_b128 v[72:75], v6 offset:2048
    v_mfma_f32_16x16x32_bf16 v[36:39], v[88:91], v[92:95], v[36:39]
    ds_read_b128 v[76:79], v6 offset:3072
    v_mfma_f32_16x16x32_bf16 v[40:43], v[88:91], v[96:99], v[40:43]
    ds_read_b128 v[80:83], v6 offset:4096
    v_mfma_f32_16x16x32_bf16 v[44:47], v[88:91], v[100:103], v[44:47]
    s_sub_u32 s34, s34, 1
    v_mfma_f32_16x16x32_bf16 v[48:51], v[88:91], v[104:107], v[48:51]
    s_cmp_lg_u32 s34, 0
    v_mfma_f32_16x16x32_bf16 v[52:55], v[88:91], v[108:111], v[52:55]
    s_waitcnt lgkmcnt(0)
    s_cbranch_scc1 at_mm_99
    v_mfma_f32_16x16x32_bf16 v[16:19], v[56:59], v[64:67], v[16:19]
    ds_read_b128 v[84:87], v5 offset:0
    v_mfma_f32_16x16x32_bf16 v[20:23], v[56:59], v[68:71], v[20:23]
    ds_read_b128 v[88:91], v5 offset:2048
    v_mfma_f32_16x16x32_bf16 v[24:27], v[56:59], v[72:75], v[24:27]
    ds_read_b128 v[92:95], v6 offset:5120
    v_mfma_f32_16x16x32_bf16 v[28:31], v[56:59], v[76:79], v[28:31]
    ds_read_b128 v[96:99], v6 offset:6144
    v_mfma_f32_16x16x32_bf16 v[32:35], v[56:59], v[80:83], v[32:35]
    ds_read_b128 v[100:103], v6 offset:7168
    v_mfma_f32_16x16x32_bf16 v[36:39], v[60:63], v[64:67], v[36:39]
    ds_read_b128 v[104:107], v6 offset:8192
    v_mfma_f32_16x16x32_bf16 v[40:43], v[60:63], v[68:71], v[40:43]
    ds_read_b128 v[108:111], v6 offset:9216
    v_mfma_f32_16x16x32_bf16 v[44:47], v[60:63], v[72:75], v[44:47]
    v_mfma_f32_16x16x32_bf16 v[48:51], v[60:63], v[76:79], v[48:51]
    v_mfma_f32_16x16x32_bf16 v[52:55], v[60:63], v[80:83], v[52:55]
    s_waitcnt lgkmcnt(0)
    v_mfma_f32_16x16x32_bf16 v[16:19], v[84:87], v[92:95], v[16:19]
    v_mfma_f32_16x16x32_bf16 v[20:23], v[84:87], v[96:99], v[20:23]
    v_mfma_f32_16x16x32_bf16 v[24:27], v[84:87], v[100:103], v[24:27]
    v_mfma_f32_16x16x32_bf16 v[28:31], v[84:87], v[104:107], v[28:31]
    v_mfma_f32_16x16x32_bf16 v[32:35], v[84:87], v[108:111], v[32:35]
    v_mfma_f32_16x16x32_bf16 v[36:39], v[88:91], v[92:95], v[36:39]
    v_mfma_f32_16x16x32_bf16 v[40:43], v[88:91], v[96:99], v[40:43]
    v_mfma_f32_16x16x32_bf16 v[44:47], v[88:91], v[100:103], v[44:47]
    v_mfma_f32_16x16x32_bf16 v[48:51], v[88:91], v[104:107], v[48:51]
    v_mfma_f32_16x16x32_bf16 v[52:55], v[88:91], v[108:111], v[52:55]
    s_mul_i32 s27, s83, 1
    s_add_u32 s27, s27, s75
    s_mul_i32 s27, s27, 10
    s_mul_i32 s28, s84, 5
    s_add_u32 s27, s27, s28
    s_add_u32 s27, s27, s76
    s_lshl_b32 s26, s27, 10
    v_lshlrev_b32 v1, 4, v0
    s_nop 1
    v_cvt_pk_bf16_f32 v56, v16, v17
    v_cvt_pk_bf16_f32 v57, v18, v19
    v_cvt_pk_bf16_f32 v58, v36, v37
    v_cvt_pk_bf16_f32 v59, v38, v39
    s_add_u32 s27, s26, 0
    buffer_store_dwordx4 v[56:59], v1, s[12:15], s27 offen offset:0 sc1
    v_cvt_pk_bf16_f32 v60, v20, v21
    v_cvt_pk_bf16_f32 v61, v22, v23
    v_cvt_pk_bf16_f32 v62, v40, v41
    v_cvt_pk_bf16_f32 v63, v42, v43
    s_add_u32 s27, s26, 0
    buffer_store_dwordx4 v[60:63], v1, s[12:15], s27 offen offset:1024 sc1
    v_cvt_pk_bf16_f32 v64, v24, v25
    v_cvt_pk_bf16_f32 v65, v26, v27
    v_cvt_pk_bf16_f32 v66, v44, v45
    v_cvt_pk_bf16_f32 v67, v46, v47
    s_add_u32 s27, s26, 0
    buffer_store_dwordx4 v[64:67], v1, s[12:15], s27 offen offset:2048 sc1
    v_cvt_pk_bf16_f32 v68, v28, v29
    v_cvt_pk_bf16_f32 v69, v30, v31
    v_cvt_pk_bf16_f32 v70, v48, v49
    v_cvt_pk_bf16_f32 v71, v50, v51
    s_add_u32 s27, s26, 0
    buffer_store_dwordx4 v[68:71], v1, s[12:15], s27 offen offset:3072 sc1
    v_cvt_pk_bf16_f32 v72, v32, v33
    v_cvt_pk_bf16_f32 v73, v34, v35
    v_cvt_pk_bf16_f32 v74, v52, v53
    v_cvt_pk_bf16_f32 v75, v54, v55
    s_add_u32 s27, s26, 4096
    buffer_store_dwordx4 v[72:75], v1, s[12:15], s27 offen offset:0 sc1
    s_mov_b64 exec, -1
    s_lshl_b32 s27, s72, 7
    v_mov_b32 v8, 0
    v_mov_b32 v9, 1
    s_cmp_lg_u32 s3, 0
    s_waitcnt vmcnt(0)
    s_barrier
    s_cbranch_scc1 sig_100
    s_mov_b64 exec, 1
    buffer_store_dword v9, v8, s[36:39], s27 offen sc1
    s_mov_b64 exec, -1
sig_100:
at_exit_101:
    s_mov_b64 exec, -1
    s_branch next_task
at_loader_97:
    s_and_b32 s82, s3, 1
    s_cmp_ge_u32 s3, 6
    s_cbranch_scc1 at_loaderB_98
    s_lshl_b32 s27, s82, 2
    v_lshrrev_b32 v2, 4, v0
    v_add_u32 v2, s27, v2
    v_and_b32 v1, 7, v0
    v_xor_b32 v1, v1, v2
    v_lshlrev_b32 v1, 4, v1
    s_lshl_b32 s27, s82, 4
    v_lshrrev_b32 v2, 5, v0
    v_lshlrev_b32 v2, 3, v2
    v_add_u32 v2, s27, v2
    v_bfe_u32 v3, v0, 3, 2
    v_add_u32 v2, v2, v3
    s_mov_b32 s27, 2304
    v_mad_u32_u24 v1, v2, s27, v1
    s_mov_b32 s31, s24
    s_lshl_b32 s32, s82, 10
    s_add_u32 s32, s32, 0
    s_add_u32 s29, s31, 2304
    s_mov_b32 s35, 0
    s_mul_i32 s27, s74, 128
    s_add_u32 s31, s31, s27
    s_mov_b32 m0, s32
    s_nop 0
    buffer_load_dwordx4 v1, s[4:7], s31 offen lds
    s_add_u32 m0, s32, 2048
    s_add_u32 s27, s31, 9216
    buffer_load_dwordx4 v1, s[4:7], s27 offen lds
    s_add_u32 m0, s32, 4096
    s_add_u32 s27, s31, 73728
    buffer_load_dwordx4 v1, s[4:7], s27 offen lds
    s_add_u32 m0, s32, 6144
    s_add_u32 s27, s31, 82944
    buffer_load_dwordx4 v1, s[4:7], s27 offen lds
    s_add_u32 m0, s32, 8192
    s_add_u32 s27, s31, 147456
    buffer_load_dwordx4 v1, s[4:7], s27 offen lds
    s_add_u32 m0, s32, 10240
    s_add_u32 s27, s31, 156672
    buffer_load_dwordx4 v1, s[4:7], s27 offen lds
    s_add_u32 m0, s32, 12288
    s_add_u32 s27, s31, 221184
    buffer_load_dwordx4 v1, s[4:7], s27 offen lds
    s_add_u32 m0, s32, 14336
    s_add_u32 s27, s31, 230400
    buffer_load_dwordx4 v1, s[4:7], s27 offen lds
    s_add_u32 s31, s31, 128
    s_cmp_ge_u32 s31, s29
    s_cselect_b32 s27, 2304, 0
    s_sub_u32 s31, s31, s27
    s_add_u32 m0, s32, 16384
    s_nop 0
    buffer_load_dwordx4 v1, s[4:7], s31 offen lds
    s_add_u32 m0, s32, 18432
    s_add_u32 s27, s31, 9216
    buffer_load_dwordx4 v1, s[4:7], s27 offen lds
    s_add_u32 m0, s32, 20480
    s_add_u32 s27, s31, 73728
    buffer_load_dwordx4 v1, s[4:7], s27 offen lds
    s_add_u32 m0, s32, 22528
    s_add_u32 s27, s31, 82944
    buffer_load_dwordx4 v1, s[4:7], s27 offen lds
    s_add_u32 m0, s32, 24576
    s_add_u32 s27, s31, 147456
    buffer_load_dwordx4 v1, s[4:7], s27 offen lds
    s_add_u32 m0, s32, 26624
    s_add_u32 s27, s31, 156672
    buffer_load_dwordx4 v1, s[4:7], s27 offen lds
    s_add_u32 m0, s32, 28672
    s_add_u32 s27, s31, 221184
    buffer_load_dwordx4 v1, s[4:7], s27 offen lds
    s_add_u32 m0, s32, 30720
    s_add_u32 s27, s31, 230400
    buffer_load_dwordx4 v1, s[4:7], s27 offen lds
    s_add_u32 s31, s31, 128
    s_cmp_ge_u32 s31, s29
    s_cselect_b32 s27, 2304, 0
    s_sub_u32 s31, s31, s27
    s_add_u32 m0, s32, 32768
    s_nop 0
    buffer_load_dwordx4 v1, s[4:7], s31 offen lds
    s_add_u32 m0, s32, 34816
    s_add_u32 s27, s31, 9216
    buffer_load_dwordx4 v1, s[4:7], s27 offen lds
    s_add_u32 m0, s32, 36864
    s_add_u32 s27, s31, 73728
    buffer_load_dwordx4 v1, s[4:7], s27 offen lds
    s_add_u32 m0, s32, 38912
    s_add_u32 s27, s31, 82944
    buffer_load_dwordx4 v1, s[4:7], s27 offen lds
    s_add_u32 m0, s32, 40960
    s_add_u32 s27, s31, 147456
    buffer_load_dwordx4 v1, s[4:7], s27 offen lds
    s_add_u32 m0, s32, 43008
    s_add_u32 s27, s31, 156672
    buffer_load_dwordx4 v1, s[4:7], s27 offen lds
    s_add_u32 m0, s32, 45056
    s_add_u32 s27, s31, 221184
    buffer_load_dwordx4 v1, s[4:7], s27 offen lds
    s_add_u32 m0, s32, 47104
    s_add_u32 s27, s31, 230400
    buffer_load_dwordx4 v1, s[4:7], s27 offen lds
    s_add_u32 s31, s31, 128
    s_cmp_ge_u32 s31, s29
    s_cselect_b32 s27, 2304, 0
    s_sub_u32 s31, s31, s27
    s_waitcnt vmcnt(16)
    s_barrier
    s_add_u32 m0, s32, 49152
    s_nop 0
    buffer_load_dwordx4 v1, s[4:7], s31 offen lds
    s_add_u32 m0, s32, 51200
    s_add_u32 s27, s31, 9216
    buffer_load_dwordx4 v1, s[4:7], s27 offen lds
    s_add_u32 m0, s32, 53248
    s_add_u32 s27, s31, 73728
    buffer_load_dwordx4 v1, s[4:7], s27 offen lds
    s_add_u32 m0, s32, 55296
    s_add_u32 s27, s31, 82944
    buffer_load_dwordx4 v1, s[4:7], s27 offen lds
    s_add_u32 m0, s32, 57344
    s_add_u32 s27, s31, 147456
    buffer_load_dwordx4 v1, s[4:7], s27 offen lds
    s_add_u32 m0, s32, 59392
    s_add_u32 s27, s31, 156672
    buffer_load_dwordx4 v1, s[4:7], s27 offen lds
    s_add_u32 m0, s32, 61440
    s_add_u32 s27, s31, 221184
    buffer_load_dwordx4 v1, s[4:7], s27 offen lds
    s_add_u32 m0, s32, 63488
    s_add_u32 s27, s31, 230400
    buffer_load_dwordx4 v1, s[4:7], s27 offen lds
    s_add_u32 s31, s31, 128
    s_cmp_ge_u32 s31, s29
    s_cselect_b32 s27, 2304, 0
    s_sub_u32 s31, s31, s27
    s_mov_b32 s33, 0
    s_mov_b32 s34, 14
at_ld_102:
    s_waitcnt vmcnt(16)
    s_barrier
    s_add_u32 s28, s32, s33
    s_mov_b32 m0, s28
    s_nop 0
    buffer_load_dwordx4 v1, s[4:7], s31 offen lds
    s_add_u32 m0, s28, 2048
    s_add_u32 s27, s31, 9216
    buffer_load_dwordx4 v1, s[4:7], s27 offen lds
    s_add_u32 m0, s28, 4096
    s_add_u32 s27, s31, 73728
    buffer_load_dwordx4 v1, s[4:7], s27 offen lds
    s_add_u32 m0, s28, 6144
    s_add_u32 s27, s31, 82944
    buffer_load_dwordx4 v1, s[4:7], s27 offen lds
    s_add_u32 m0, s28, 8192
    s_add_u32 s27, s31, 147456
    buffer_load_dwordx4 v1, s[4:7], s27 offen lds
    s_add_u32 m0, s28, 10240
    s_add_u32 s27, s31, 156672
    buffer_load_dwordx4 v1, s[4:7], s27 offen lds
    s_add_u32 m0, s28, 12288
    s_add_u32 s27, s31, 221184
    buffer_load_dwordx4 v1, s[4:7], s27 offen lds
    s_add_u32 m0, s28, 14336
    s_add_u32 s27, s31, 230400
    buffer_load_dwordx4 v1, s[4:7], s27 offen lds
    s_add_u32 s31, s31, 128
    s_cmp_ge_u32 s31, s29
    s_cselect_b32 s27, 2304, 0
    s_sub_u32 s31, s31, s27
    s_add_u32 s33, s33, 16384
    s_cmp_eq_u32 s33, 65536
    s_cselect_b32 s33, 0, s33
    s_sub_u32 s34, s34, 1
    s_cmp_lg_u32 s34, 0
    s_cbranch_scc1 at_ld_102
    s_waitcnt vmcnt(16)
    s_barrier
    s_waitcnt vmcnt(8)
    s_barrier
    s_waitcnt vmcnt(0)
    s_barrier
    s_barrier
    s_branch at_exit_101
at_loaderB_98:
    v_lshlrev_b32 v1, 4, v0
    s_mul_i32 s31, s82, 10240
    s_add_u32 s31, s31, s25
    s_mul_i32 s32, s82, 5120
    s_add_u32 s32, s32, 65536
    s_add_u32 s29, s31, 368640
    s_mov_b32 s35, 0
    s_mul_i32 s27, s74, 20480
    s_add_u32 s31, s31, s27
    s_mul_i32 s85, s67, 12
    s_add_u32 s85, s85, 487
    v_min_u32 v252, 5, v0
    v_lshlrev_b32 v252, 7, v252
    s_lshl_b32 s27, s85, 7
    s_mov_b32 s34, 131072
    s_mov_b64 exec, 0x3f
poll_103:
    buffer_load_dword v253, v252, s[36:39], s27 offen sc1
    s_sub_u32 s34, s34, 1
    s_waitcnt vmcnt(0)
    v_cmp_ne_u32 vcc, 1, v253
    s_cmp_eq_u32 s34, 0
    s_cbranch_scc1 polled_104
    s_cmp_eq_u64 vcc, 0
    s_cbranch_scc1 polled_104
    s_sleep 3
    s_branch poll_103
polled_104:
    s_mov_b64 exec, -1
    s_mov_b32 m0, s32
    s_nop 0
    buffer_load_dwordx4 v1, s[8:11], s31 offen sc1 lds
    buffer_load_dwordx4 v1, s[8:11], s31 offen offset:1024 sc1 lds
    buffer_load_dwordx4 v1, s[8:11], s31 offen offset:2048 sc1 lds
    buffer_load_dwordx4 v1, s[8:11], s31 offen offset:3072 sc1 lds
    s_add_u32 m0, s32, 4096
    s_add_u32 s27, s31, 4096
    buffer_load_dwordx4 v1, s[8:11], s27 offen sc1 lds
    s_add_u32 s31, s31, 20480
    s_cmp_ge_u32 s31, s29
    s_cselect_b32 s27, 368640, 0
    s_sub_u32 s31, s31, s27
    s_add_u32 m0, s32, 10240
    s_nop 0
    buffer_load_dwordx4 v1, s[8:11], s31 offen sc1 lds
    buffer_load_dwordx4 v1, s[8:11], s31 offen offset:1024 sc1 lds
    buffer_load_dwordx4 v1, s[8:11], s31 offen offset:2048 sc1 lds
    buffer_load_dwordx4 v1, s[8:11], s31 offen offset:3072 sc1 lds
    s_add_u32 m0, s32, 14336
    s_add_u32 s27, s31, 4096
    buffer_load_dwordx4 v1, s[8:11], s27 offen sc1 lds
    s_add_u32 s31, s31, 20480
    s_cmp_ge_u32 s31, s29
    s_cselect_b32 s27, 368640, 0
    s_sub_u32 s31, s31, s27
    s_add_u32 m0, s32, 20480
    s_nop 0
    buffer_load_dwordx4 v1, s[8:11], s31 offen sc1 lds
    buffer_load_dwordx4 v1, s[8:11], s31 offen offset:1024 sc1 lds
    buffer_load_dwordx4 v1, s[8:11], s31 offen offset:2048 sc1 lds
    buffer_load_dwordx4 v1, s[8:11], s31 offen offset:3072 sc1 lds
    s_add_u32 m0, s32, 24576
    s_add_u32 s27, s31, 4096
    buffer_load_dwordx4 v1, s[8:11], s27 offen sc1 lds
    s_add_u32 s31, s31, 20480
    s_cmp_ge_u32 s31, s29
    s_cselect_b32 s27, 368640, 0
    s_sub_u32 s31, s31, s27
    s_waitcnt vmcnt(10)
    s_barrier
    s_add_u32 m0, s32, 30720
    s_nop 0
    buffer_load_dwordx4 v1, s[8:11], s31 offen sc1 lds
    buffer_load_dwordx4 v1, s[8:11], s31 offen offset:1024 sc1 lds
    buffer_load_dwordx4 v1, s[8:11], s31 offen offset:2048 sc1 lds
    buffer_load_dwordx4 v1, s[8:11], s31 offen offset:3072 sc1 lds
    s_add_u32 m0, s32, 34816
    s_add_u32 s27, s31, 4096
    buffer_load_dwordx4 v1, s[8:11], s27 offen sc1 lds
    s_add_u32 s31, s31, 20480
    s_cmp_ge_u32 s31, s29
    s_cselect_b32 s27, 368640, 0
    s_sub_u32 s31, s31, s27
    s_mov_b32 s33, 0
    s_mov_b32 s34, 14
at_ld_105:
    s_waitcnt vmcnt(10)
    s_barrier
    s_add_u32 s28, s32, s33
    s_mov_b32 m0, s28
    s_nop 0
    buffer_load_dwordx4 v1, s[8:11], s31 offen sc1 lds
    buffer_load_dwordx4 v1, s[8:11], s31 offen offset:1024 sc1 lds
    buffer_load_dwordx4 v1, s[8:11], s31 offen offset:2048 sc1 lds
    buffer_load_dwordx4 v1, s[8:11], s31 offen offset:3072 sc1 lds
    s_add_u32 m0, s28, 4096
    s_add_u32 s27, s31, 4096
    buffer_load_dwordx4 v1, s[8:11], s27 offen sc1 lds
    s_add_u32 s31, s31, 20480
    s_cmp_ge_u32 s31, s29
    s_cselect_b32 s27, 368640, 0
    s_sub_u32 s31, s31, s27
    s_add_u32 s33, s33, 10240
    s_cmp_eq_u32 s33, 40960
    s_cselect_b32 s33, 0, s33
    s_sub_u32 s34, s34, 1
    s_cmp_lg_u32 s34, 0
    s_cbranch_scc1 at_ld_105
    s_waitcnt vmcnt(10)
    s_barrier
    s_waitcnt vmcnt(5)
    s_barrier
    s_waitcnt vmcnt(0)
    s_barrier
    s_barrier
    s_branch at_exit_101
role_BT:
    s_mul_i32 s24, s67, 5120
    s_add_u32 s24, s24, 368640
    s_lshl_b32 s25, s68, 8
    s_mul_i32 s75, s67, 3
    s_lshl_b32 s76, s68, 3
    s_mul_i32 s72, s67, 9
    s_add_u32 s72, s72, s68
    s_add_u32 s72, s72, 995
    s_mul_i32 s74, s67, 9
    s_add_u32 s4, s62, 23969792
    s_addc_u32 s5, s63, 0
    s_mov_b32 s6, 737280
    s_mov_b32 s7, 0x00020000
    s_mov_b32 s8, s54
    s_mov_b32 s9, s55
    s_mov_b32 s10, 2654208
    s_mov_b32 s11, 0x00020000
    s_add_u32 s12, s62, 25075712
    s_addc_u32 s13, s63, 0
    s_mov_b32 s14, 442368
    s_mov_b32 s15, 0x00020000
    s_cmp_ge_u32 s3, 4
    s_cbranch_scc1 bt_loader_106
    s_and_b32 s84, s3, 3
    s_lshr_b32 s83, s3, 2
    s_mul_i32 s27, s83, 5120
    s_add_u32 s27, s27, 0
    v_lshlrev_b32 v4, 4, v0
    v_add_u32 v4, s27, v4
    v_lshrrev_b32 v2, 4, v0
    v_lshlrev_b32 v2, 3, v2
    v_bfe_u32 v3, v0, 2, 2
    v_add_u32 v2, v2, v3
    v_lshlrev_b32 v2, 7, v2
    v_and_b32 v3, 3, v0
    v_lshl_add_u32 v2, v3, 3, v2
    v_bfe_u32 v3, v0, 3, 2
    v_lshl_add_u32 v2, v3, 5, v2
    s_mul_i32 s27, s84, 2
    s_add_u32 s27, s27, 0
    s_and_b32 s28, s27, 3
    s_lshl_b32 s28, s28, 5
    s_lshr_b32 s27, s27, 2
    s_lshl_b32 s27, s27, 13
    s_add_u32 s27, s27, 40960
    v_xor_b32 v5, s28, v2
    v_add_u32 v5, s27, v5
    s_mul_i32 s27, s84, 2
    s_add_u32 s27, s27, 1
    s_and_b32 s28, s27, 3
    s_lshl_b32 s28, s28, 5
    s_lshr_b32 s27, s27, 2
    s_lshl_b32 s27, s27, 13
    s_add_u32 s27, s27, 40960
    v_xor_b32 v6, s28, v2
    v_add_u32 v6, s27, v6
    v_mov_b32 v16, 0
    v_mov_b32 v17, 0
    v_mov_b32 v18, 0
    v_mov_b32 v19, 0
    v_mov_b32 v20, 0
    v_mov_b32 v21, 0
    v_mov_b32 v22, 0
    v_mov_b32 v23, 0
    v_mov_b32 v24, 0
    v_mov_b32 v25, 0
    v_mov_b32 v26, 0
    v_mov_b32 v27, 0
    v_mov_b32 v28, 0
    v_mov_b32 v29, 0
    v_mov_b32 v30, 0
    v_mov_b32 v31, 0
    v_mov_b32 v32, 0
    v_mov_b32 v33, 0
    v_mov_b32 v34, 0
    v_mov_b32 v35, 0
    v_mov_b32 v36, 0
    v_mov_b32 v37, 0
    v_mov_b32 v38, 0
    v_mov_b32 v39, 0
    v_mov_b32 v40, 0
    v_mov_b32 v41, 0
    v_mov_b32 v42, 0
    v_mov_b32 v43, 0
    v_mov_b32 v44, 0
    v_mov_b32 v45, 0
    v_mov_b32 v46, 0
    v_mov_b32 v47, 0
    v_mov_b32 v48, 0
    v_mov_b32 v49, 0
    v_mov_b32 v50, 0
    v_mov_b32 v51, 0
    v_mov_b32 v52, 0
    v_mov_b32 v53, 0
    v_mov_b32 v54, 0
    v_mov_b32 v55, 0
    s_mov_b32 s33, 0
    s_mov_b32 s31, 0
    s_mov_b32 s30, 10240
    s_mov_b32 s32, 16384
    s_mov_b32 s34, 17
    s_barrier
    ds_read_b64_tr_b16 v[76:77], v5 offset:0
    ds_read_b64_tr_b16 v[78:79], v5 offset:512
    ds_read_b64_tr_b16 v[80:81], v6 offset:0
    ds_read_b64_tr_b16 v[82:83], v6 offset:512
    ds_read_b128 v[56:59], v4 offset:0
    ds_read_b128 v[60:63], v4 offset:1024
    ds_read_b128 v[64:67], v4 offset:2048
    ds_read_b128 v[68:71], v4 offset:3072
    ds_read_b128 v[72:75], v4 offset:4096
    s_waitcnt lgkmcnt(0)
bt_mm_108:
    v_mfma_f32_16x16x32_bf16 v[16:19], v[56:59], v[76:79], v[16:19]
    ds_read_b64_tr_b16 v[104:105], v5 offset:4096
    v_mfma_f32_16x16x32_bf16 v[20:23], v[56:59], v[80:83], v[20:23]
    ds_read_b64_tr_b16 v[106:107], v5 offset:4608
    v_mfma_f32_16x16x32_bf16 v[24:27], v[60:63], v[76:79], v[24:27]
    ds_read_b64_tr_b16 v[108:109], v6 offset:4096
    v_mfma_f32_16x16x32_bf16 v[28:31], v[60:63], v[80:83], v[28:31]
    ds_read_b64_tr_b16 v[110:111], v6 offset:4608
    v_mfma_f32_16x16x32_bf16 v[32:35], v[64:67], v[76:79], v[32:35]
    ds_read_b128 v[84:87], v4 offset:5120
    v_mfma_f32_16x16x32_bf16 v[36:39], v[64:67], v[80:83], v[36:39]
    ds_read_b128 v[88:91], v4 offset:6144
    v_mfma_f32_16x16x32_bf16 v[40:43], v[68:71], v[76:79], v[40:43]
    ds_read_b128 v[92:95], v4 offset:7168
    v_mfma_f32_16x16x32_bf16 v[44:47], v[68:71], v[80:83], v[44:47]
    ds_read_b128 v[96:99], v4 offset:8192
    v_mfma_f32_16x16x32_bf16 v[48:51], v[72:75], v[76:79], v[48:51]
    ds_read_b128 v[100:103], v4 offset:9216
    v_mfma_f32_16x16x32_bf16 v[52:55], v[72:75], v[80:83], v[52:55]
    s_add_u32 s33, s33, 1
    s_cmp_eq_u32 s33, 4
    s_cselect_b32 s35, 4294936576, s30
    s_cselect_b32 s29, 4294918144, s32
    s_cselect_b32 s33, 0, s33
    v_add_u32 v4, s35, v4
    v_add_u32 v5, s29, v5
    v_add_u32 v6, s29, v6
    s_waitcnt lgkmcnt(0)
    s_barrier
    v_mfma_f32_16x16x32_bf16 v[16:19], v[84:87], v[104:107], v[16:19]
    ds_read_b64_tr_b16 v[76:77], v5 offset:0
    v_mfma_f32_16x16x32_bf16 v[20:23], v[84:87], v[108:111], v[20:23]
    ds_read_b64_tr_b16 v[78:79], v5 offset:512
    v_mfma_f32_16x16x32_bf16 v[24:27], v[88:91], v[104:107], v[24:27]
    ds_read_b64_tr_b16 v[80:81], v6 offset:0
    v_mfma_f32_16x16x32_bf16 v[28:31], v[88:91], v[108:111], v[28:31]
    ds_read_b64_tr_b16 v[82:83], v6 offset:512
    v_mfma_f32_16x16x32_bf16 v[32:35], v[92:95], v[104:107], v[32:35]
    ds_read_b128 v[56:59], v4 offset:0
    v_mfma_f32_16x16x32_bf16 v[36:39], v[92:95], v[108:111], v[36:39]
    ds_read_b128 v[60:63], v4 offset:1024
    v_mfma_f32_16x16x32_bf16 v[40:43], v[96:99], v[104:107], v[40:43]
    ds_read_b128 v[64:67], v4 offset:2048
    v_mfma_f32_16x16x32_bf16 v[44:47], v[96:99], v[108:111], v[44:47]
    ds_read_b128 v[68:71], v4 offset:3072
    v_mfma_f32_16x16x32_bf16 v[48:51], v[100:103], v[104:107], v[48:51]
    ds_read_b128 v[72:75], v4 offset:4096
    v_mfma_f32_16x16x32_bf16 v[52:55], v[100:103], v[108:111], v[52:55]
    s_sub_u32 s34, s34, 1
    s_cmp_lg_u32 s34, 0
    s_waitcnt lgkmcnt(0)
    s_cbranch_scc1 bt_mm_108
    v_mfma_f32_16x16x32_bf16 v[16:19], v[56:59], v[76:79], v[16:19]
    ds_read_b64_tr_b16 v[104:105], v5 offset:4096
    v_mfma_f32_16x16x32_bf16 v[20:23], v[56:59], v[80:83], v[20:23]
    ds_read_b64_tr_b16 v[106:107], v5 offset:4608
    v_mfma_f32_16x16x32_bf16 v[24:27], v[60:63], v[76:79], v[24:27]
    ds_read_b64_tr_b16 v[108:109], v6 offset:4096
    v_mfma_f32_16x16x32_bf16 v[28:31], v[60:63], v[80:83], v[28:31]
    ds_read_b64_tr_b16 v[110:111], v6 offset:4608
    v_mfma_f32_16x16x32_bf16 v[32:35], v[64:67], v[76:79], v[32:35]
    ds_read_b128 v[84:87], v4 offset:5120
    v_mfma_f32_16x16x32_bf16 v[36:39], v[64:67], v[80:83], v[36:39]
    ds_read_b128 v[88:91], v4 offset:6144
    v_mfma_f32_16x16x32_bf16 v[40:43], v[68:71], v[76:79], v[40:43]
    ds_read_b128 v[92:95], v4 offset:7168
    v_mfma_f32_16x16x32_bf16 v[44:47], v[68:71], v[80:83], v[44:47]
    ds_read_b128 v[96:99], v4 offset:8192
    v_mfma_f32_16x16x32_bf16 v[48:51], v[72:75], v[76:79], v[48:51]
    ds_read_b128 v[100:103], v4 offset:9216
    v_mfma_f32_16x16x32_bf16 v[52:55], v[72:75], v[80:83], v[52:55]
    s_waitcnt lgkmcnt(0)
    v_mfma_f32_16x16x32_bf16 v[16:19], v[84:87], v[104:107], v[16:19]
    v_mfma_f32_16x16x32_bf16 v[20:23], v[84:87], v[108:111], v[20:23]
    v_mfma_f32_16x16x32_bf16 v[24:27], v[88:91], v[104:107], v[24:27]
    v_mfma_f32_16x16x32_bf16 v[28:31], v[88:91], v[108:111], v[28:31]
    v_mfma_f32_16x16x32_bf16 v[32:35], v[92:95], v[104:107], v[32:35]
    v_mfma_f32_16x16x32_bf16 v[36:39], v[92:95], v[108:111], v[36:39]
    v_mfma_f32_16x16x32_bf16 v[40:43], v[96:99], v[104:107], v[40:43]
    v_mfma_f32_16x16x32_bf16 v[44:47], v[96:99], v[108:111], v[44:47]
    v_mfma_f32_16x16x32_bf16 v[48:51], v[100:103], v[104:107], v[48:51]
    v_mfma_f32_16x16x32_bf16 v[52:55], v[100:103], v[108:111], v[52:55]
    s_mul_i32 s27, s83, 2
    s_add_u32 s27, s27, s75
    s_mul_i32 s27, s27, 72
    s_mul_i32 s28, s84, 2
    s_add_u32 s27, s27, s28
    s_add_u32 s27, s27, s76
    s_lshl_b32 s26, s27, 10
    v_bfe_u32 v2, v0, 2, 1
    v_lshlrev_b32 v1, 10, v2
    v_bfe_u32 v2, v0, 3, 1
    v_lshl_add_u32 v1, v2, 6, v1
    v_and_b32 v2, 0x33, v0
    v_lshl_add_u32 v1, v2, 4, v1
    s_nop 1
    v_cvt_pk_bf16_f32 v56, v16, v17
    v_cvt_pk_bf16_f32 v57, v18, v19
    v_cvt_pk_bf16_f32 v58, v24, v25
    v_cvt_pk_bf16_f32 v59, v26, v27
    s_add_u32 s27, s26, 0
    buffer_store_dwordx4 v[56:59], v1, s[12:15], s27 offen offset:0 sc1
    v_cvt_pk_bf16_f32 v60, v20, v21
    v_cvt_pk_bf16_f32 v61, v22, v23
    v_cvt_pk_bf16_f32 v62, v28, v29
    v_cvt_pk_bf16_f32 v63, v30, v31
    s_add_u32 s27, s26, 0
    buffer_store_dwordx4 v[60:63], v1, s[12:15], s27 offen offset:128 sc1
    v_cvt_pk_bf16_f32 v64, v32, v33
    v_cvt_pk_bf16_f32 v65, v34, v35
    v_cvt_pk_bf16_f32 v66, v40, v41
    v_cvt_pk_bf16_f32 v67, v42, v43
    s_add_u32 s27, s26, 73728
    buffer_store_dwordx4 v[64:67], v1, s[12:15], s27 offen offset:0 sc1
    v_cvt_pk_bf16_f32 v68, v36, v37
    v_cvt_pk_bf16_f32 v69, v38, v39
    v_cvt_pk_bf16_f32 v70, v44, v45
    v_cvt_pk_bf16_f32 v71, v46, v47
    s_add_u32 s27, s26, 73728
    buffer_store_dwordx4 v[68:71], v1, s[12:15], s27 offen offset:128 sc1
    v_bfe_u32 v2, v0, 2, 1
    v_lshlrev_b32 v1, 3, v2
    v_bfe_u32 v2, v0, 3, 1
    v_lshl_add_u32 v1, v2, 6, v1
    v_and_b32 v2, 0x33, v0
    v_lshl_add_u32 v1, v2, 4, v1
    s_mul_i32 s27, s67, 216
    s_lshl_b32 s28, s68, 2
    s_add_u32 s27, s27, s28
    s_add_u32 s27, s27, s84
    s_add_u32 s27, s27, 144
    s_lshl_b32 s27, s27, 10
    v_cvt_pk_bf16_f32 v88, v48, v49
    v_cvt_pk_bf16_f32 v89, v50, v51
    buffer_store_dwordx2 v[88:89], v1, s[12:15], s27 offen offset:0 sc1
    v_cvt_pk_bf16_f32 v90, v52, v53
    v_cvt_pk_bf16_f32 v91, v54, v55
    buffer_store_dwordx2 v[90:91], v1, s[12:15], s27 offen offset:128 sc1
    s_mov_b64 exec, -1
    s_lshl_b32 s27, s72, 7
    v_mov_b32 v8, 0
    v_mov_b32 v9, 1
    s_cmp_lg_u32 s3, 0
    s_waitcnt vmcnt(0)
    s_barrier
    s_cbranch_scc1 sig_109
    s_mov_b64 exec, 1
    buffer_store_dword v9, v8, s[36:39], s27 offen sc1
    s_mov_b64 exec, -1
sig_109:
bt_exit_110:
    s_mov_b64 exec, -1
    s_branch next_task
bt_loader_106:
    s_and_b32 s82, s3, 1
    s_cmp_ge_u32 s3, 6
    s_cbranch_scc1 bt_loaderB_107
    v_lshlrev_b32 v1, 4, v0
    s_mul_i32 s31, s82, 10240
    s_add_u32 s31, s31, s24
    s_mul_i32 s32, s82, 5120
    s_add_u32 s32, s32, 0
    s_add_u32 s29, s31, 368640
    s_mov_b32 s35, 0
    s_mul_i32 s27, s74, 20480
    s_add_u32 s31, s31, s27
    s_mul_i32 s85, s67, 12
    s_add_u32 s85, s85, 493
    v_min_u32 v252, 5, v0
    v_lshlrev_b32 v252, 7, v252
    s_lshl_b32 s27, s85, 7
    s_mov_b32 s34, 131072
    s_mov_b64 exec, 0x3f
poll_111:
    buffer_load_dword v253, v252, s[36:39], s27 offen sc1
    s_sub_u32 s34, s34, 1
    s_waitcnt vmcnt(0)
    v_cmp_ne_u32 vcc, 1, v253
    s_cmp_eq_u32 s34, 0
    s_cbranch_scc1 polled_112
    s_cmp_eq_u64 vcc, 0
    s_cbranch_scc1 polled_112
    s_sleep 3
    s_branch poll_111
polled_112:
    s_mov_b64 exec, -1
    s_mov_b32 m0, s32
    s_nop 0
    buffer_load_dwordx4 v1, s[4:7], s31 offen sc1 lds
    buffer_load_dwordx4 v1, s[4:7], s31 offen offset:1024 sc1 lds
    buffer_load_dwordx4 v1, s[4:7], s31 offen offset:2048 sc1 lds
    buffer_load_dwordx4 v1, s[4:7], s31 offen offset:3072 sc1 lds
    s_add_u32 m0, s32, 4096
    s_add_u32 s27, s31, 4096
    buffer_load_dwordx4 v1, s[4:7], s27 offen sc1 lds
    s_add_u32 s31, s31, 20480
    s_cmp_ge_u32 s31, s29
    s_cselect_b32 s27, 368640, 0
    s_sub_u32 s31, s31, s27
    s_add_u32 m0, s32, 10240
    s_nop 0
    buffer_load_dwordx4 v1, s[4:7], s31 offen sc1 lds
    buffer_load_dwordx4 v1, s[4:7], s31 offen offset:1024 sc1 lds
    buffer_load_dwordx4 v1, s[4:7], s31 offen offset:2048 sc1 lds
    buffer_load_dwordx4 v1, s[4:7], s31 offen offset:3072 sc1 lds
    s_add_u32 m0, s32, 14336
    s_add_u32 s27, s31, 4096
    buffer_load_dwordx4 v1, s[4:7], s27 offen sc1 lds
    s_add_u32 s31, s31, 20480
    s_cmp_ge_u32 s31, s29
    s_cselect_b32 s27, 368640, 0
    s_sub_u32 s31, s31, s27
    s_add_u32 m0, s32, 20480
    s_nop 0
    buffer_load_dwordx4 v1, s[4:7], s31 offen sc1 lds
    buffer_load_dwordx4 v1, s[4:7], s31 offen offset:1024 sc1 lds
    buffer_load_dwordx4 v1, s[4:7], s31 offen offset:2048 sc1 lds
    buffer_load_dwordx4 v1, s[4:7], s31 offen offset:3072 sc1 lds
    s_add_u32 m0, s32, 24576
    s_add_u32 s27, s31, 4096
    buffer_load_dwordx4 v1, s[4:7], s27 offen sc1 lds
    s_add_u32 s31, s31, 20480
    s_cmp_ge_u32 s31, s29
    s_cselect_b32 s27, 368640, 0
    s_sub_u32 s31, s31, s27
    s_waitcnt vmcnt(10)
    s_barrier
    s_add_u32 m0, s32, 30720
    s_nop 0
    buffer_load_dwordx4 v1, s[4:7], s31 offen sc1 lds
    buffer_load_dwordx4 v1, s[4:7], s31 offen offset:1024 sc1 lds
    buffer_load_dwordx4 v1, s[4:7], s31 offen offset:2048 sc1 lds
    buffer_load_dwordx4 v1, s[4:7], s31 offen offset:3072 sc1 lds
    s_add_u32 m0, s32, 34816
    s_add_u32 s27, s31, 4096
    buffer_load_dwordx4 v1, s[4:7], s27 offen sc1 lds
    s_add_u32 s31, s31, 20480
    s_cmp_ge_u32 s31, s29
    s_cselect_b32 s27, 368640, 0
    s_sub_u32 s31, s31, s27
    s_mov_b32 s33, 0
    s_mov_b32 s34, 14
bt_ld_113:
    s_waitcnt vmcnt(10)
    s_barrier
    s_add_u32 s28, s32, s33
    s_mov_b32 m0, s28
    s_nop 0
    buffer_load_dwordx4 v1, s[4:7], s31 offen sc1 lds
    buffer_load_dwordx4 v1, s[4:7], s31 offen offset:1024 sc1 lds
    buffer_load_dwordx4 v1, s[4:7], s31 offen offset:2048 sc1 lds
    buffer_load_dwordx4 v1, s[4:7], s31 offen offset:3072 sc1 lds
    s_add_u32 m0, s28, 4096
    s_add_u32 s27, s31, 4096
    buffer_load_dwordx4 v1, s[4:7], s27 offen sc1 lds
    s_add_u32 s31, s31, 20480
    s_cmp_ge_u32 s31, s29
    s_cselect_b32 s27, 368640, 0
    s_sub_u32 s31, s31, s27
    s_add_u32 s33, s33, 10240
    s_cmp_eq_u32 s33, 40960
    s_cselect_b32 s33, 0, s33
    s_sub_u32 s34, s34, 1
    s_cmp_lg_u32 s34, 0
    s_cbranch_scc1 bt_ld_113
    s_waitcnt vmcnt(10)
    s_barrier
    s_waitcnt vmcnt(5)
    s_barrier
    s_waitcnt vmcnt(0)
    s_barrier
    s_barrier
    s_branch bt_exit_110
bt_loaderB_107:
    s_lshl_b32 s27, s82, 2
    v_bfe_u32 v2, v0, 4, 1
    v_lshlrev_b32 v2, 1, v2
    v_or_b32 v2, s27, v2
    v_and_b32 v1, 7, v0
    v_xor_b32 v1, v1, v2
    v_lshlrev_b32 v1, 4, v1
    s_lshl_b32 s27, s82, 3
    v_lshrrev_b32 v2, 3, v0
    v_add_u32 v2, s27, v2
    s_mov_b32 s27, 2304
    v_mad_u32_u24 v1, v2, s27, v1
    s_mov_b32 s31, s25
    s_lshl_b32 s32, s82, 10
    s_add_u32 s32, s32, 40960
    s_add_u32 s29, s31, 2654208
    s_mov_b32 s35, 0
    s_mul_i32 s27, s74, 147456
    s_add_u32 s31, s31, s27
    s_mov_b32 m0, s32
    s_nop 0
    buffer_load_dwordx4 v1, s[8:11], s31 offen lds
    s_add_u32 m0, s32, 2048
    s_add_u32 s27, s31, 36864
    buffer_load_dwordx4 v1, s[8:11], s27 offen lds
    s_add_u32 m0, s32, 4096
    s_add_u32 s27, s31, 73728
    buffer_load_dwordx4 v1, s[8:11], s27 offen lds
    s_add_u32 m0, s32, 6144
    s_add_u32 s27, s31, 110592
    buffer_load_dwordx4 v1, s[8:11], s27 offen lds
    s_add_u32 m0, s32, 8192
    s_add_u32 s27, s31, 128
    buffer_load_dwordx4 v1, s[8:11], s27 offen lds
    s_add_u32 m0, s32, 10240
    s_add_u32 s27, s31, 36992
    buffer_load_dwordx4 v1, s[8:11], s27 offen lds
    s_add_u32 m0, s32, 12288
    s_add_u32 s27, s31, 73856
    buffer_load_dwordx4 v1, s[8:11], s27 offen lds
    s_add_u32 m0, s32, 14336
    s_add_u32 s27, s31, 110720
    buffer_load_dwordx4 v1, s[8:11], s27 offen lds
    s_add_u32 s31, s31, 147456
    s_cmp_ge_u32 s31, s29
    s_cselect_b32 s27, 2654208, 0
    s_sub_u32 s31, s31, s27
    s_add_u32 m0, s32, 16384
    s_nop 0
    buffer_load_dwordx4 v1, s[8:11], s31 offen lds
    s_add_u32 m0, s32, 18432
    s_add_u32 s27, s31, 36864
    buffer_load_dwordx4 v1, s[8:11], s27 offen lds
    s_add_u32 m0, s32, 20480
    s_add_u32 s27, s31, 73728
    buffer_load_dwordx4 v1, s[8:11], s27 offen lds
    s_add_u32 m0, s32, 22528
    s_add_u32 s27, s31, 110592
    buffer_load_dwordx4 v1, s[8:11], s27 offen lds
    s_add_u32 m0, s32, 24576
    s_add_u32 s27, s31, 128
    buffer_load_dwordx4 v1, s[8:11], s27 offen lds
    s_add_u32 m0, s32, 26624
    s_add_u32 s27, s31, 36992
    buffer_load_dwordx4 v1, s[8:11], s27 offen lds
    s_add_u32 m0, s32, 28672
    s_add_u32 s27, s31, 73856
    buffer_load_dwordx4 v1, s[8:11], s27 offen lds
    s_add_u32 m0, s32, 30720
    s_add_u32 s27, s31, 110720
    buffer_load_dwordx4 v1, s[8:11], s27 offen lds
    s_add_u32 s31, s31, 147456
    s_cmp_ge_u32 s31, s29
    s_cselect_b32 s27, 2654208, 0
    s_sub_u32 s31, s31, s27
    s_add_u32 m0, s32, 32768
    s_nop 0
    buffer_load_dwordx4 v1, s[8:11], s31 offen lds
    s_add_u32 m0, s32, 34816
    s_add_u32 s27, s31, 36864
    buffer_load_dwordx4 v1, s[8:11], s27 offen lds
    s_add_u32 m0, s32, 36864
    s_add_u32 s27, s31, 73728
    buffer_load_dwordx4 v1, s[8:11], s27 offen lds
    s_add_u32 m0, s32, 38912
    s_add_u32 s27, s31, 110592
    buffer_load_dwordx4 v1, s[8:11], s27 offen lds
    s_add_u32 m0, s32, 40960
    s_add_u32 s27, s31, 128
    buffer_load_dwordx4 v1, s[8:11], s27 offen lds
    s_add_u32 m0, s32, 43008
    s_add_u32 s27, s31, 36992
    buffer_load_dwordx4 v1, s[8:11], s27 offen lds
    s_add_u32 m0, s32, 45056
    s_add_u32 s27, s31, 73856
    buffer_load_dwordx4 v1, s[8:11], s27 offen lds
    s_add_u32 m0, s32, 47104
    s_add_u32 s27, s31, 110720
    buffer_load_dwordx4 v1, s[8:11], s27 offen lds
    s_add_u32 s31, s31, 147456
    s_cmp_ge_u32 s31, s29
    s_cselect_b32 s27, 2654208, 0
    s_sub_u32 s31, s31, s27
    s_waitcnt vmcnt(16)
    s_barrier
    s_add_u32 m0, s32, 49152
    s_nop 0
    buffer_load_dwordx4 v1, s[8:11], s31 offen lds
    s_add_u32 m0, s32, 51200
    s_add_u32 s27, s31, 36864
    buffer_load_dwordx4 v1, s[8:11], s27 offen lds
    s_add_u32 m0, s32, 53248
    s_add_u32 s27, s31, 73728
    buffer_load_dwordx4 v1, s[8:11], s27 offen lds
    s_add_u32 m0, s32, 55296
    s_add_u32 s27, s31, 110592
    buffer_load_dwordx4 v1, s[8:11], s27 offen lds
    s_add_u32 m0, s32, 57344
    s_add_u32 s27, s31, 128
    buffer_load_dwordx4 v1, s[8:11], s27 offen lds
    s_add_u32 m0, s32, 59392
    s_add_u32 s27, s31, 36992
    buffer_load_dwordx4 v1, s[8:11], s27 offen lds
    s_add_u32 m0, s32, 61440
    s_add_u32 s27, s31, 73856
    buffer_load_dwordx4 v1, s[8:11], s27 offen lds
    s_add_u32 m0, s32, 63488
    s_add_u32 s27, s31, 110720
    buffer_load_dwordx4 v1, s[8:11], s27 offen lds
    s_add_u32 s31, s31, 147456
    s_cmp_ge_u32 s31, s29
    s_cselect_b32 s27, 2654208, 0
    s_sub_u32 s31, s31, s27
    s_mov_b32 s33, 0
    s_mov_b32 s34, 14
bt_ld_114:
    s_waitcnt vmcnt(16)
    s_barrier
    s_add_u32 s28, s32, s33
    s_mov_b32 m0, s28
    s_nop 0
    buffer_load_dwordx4 v1, s[8:11], s31 offen lds
    s_add_u32 m0, s28, 2048
    s_add_u32 s27, s31, 36864
    buffer_load_dwordx4 v1, s[8:11], s27 offen lds
    s_add_u32 m0, s28, 4096
    s_add_u32 s27, s31, 73728
    buffer_load_dwordx4 v1, s[8:11], s27 offen lds
    s_add_u32 m0, s28, 6144
    s_add_u32 s27, s31, 110592
    buffer_load_dwordx4 v1, s[8:11], s27 offen lds
    s_add_u32 m0, s28, 8192
    s_add_u32 s27, s31, 128
    buffer_load_dwordx4 v1, s[8:11], s27 offen lds
    s_add_u32 m0, s28, 10240
    s_add_u32 s27, s31, 36992
    buffer_load_dwordx4 v1, s[8:11], s27 offen lds
    s_add_u32 m0, s28, 12288
    s_add_u32 s27, s31, 73856
    buffer_load_dwordx4 v1, s[8:11], s27 offen lds
    s_add_u32 m0, s28, 14336
    s_add_u32 s27, s31, 110720
    buffer_load_dwordx4 v1, s[8:11], s27 offen lds
    s_add_u32 s31, s31, 147456
    s_cmp_ge_u32 s31, s29
    s_cselect_b32 s27, 2654208, 0
    s_sub_u32 s31, s31, s27
    s_add_u32 s33, s33, 16384
    s_cmp_eq_u32 s33, 65536
    s_cselect_b32 s33, 0, s33
    s_sub_u32 s34, s34, 1
    s_cmp_lg_u32 s34, 0
    s_cbranch_scc1 bt_ld_114
    s_waitcnt vmcnt(16)
    s_barrier
    s_waitcnt vmcnt(8)
    s_barrier
    s_waitcnt vmcnt(0)
    s_barrier
    s_barrier
    s_branch bt_exit_110
role_E:
    s_lshr_b32 s66, s64, 2
    v_lshlrev_b32 v1, 4, v0
    s_and_b32 s67, s65, 1
    s_lshl_b32 s68, s64, 4
    s_lshr_b32 s69, s65, 1
    s_add_u32 s68, s68, s69
    s_lshr_b32 s70, s68, 3
    s_cmp_lt_u32 s3, 4
    s_cbranch_scc1 pe_l
    s_cmp_eq_u32 s81, 3
    s_cbranch_scc1 pe_at
    s_mul_i32 s85, s66, 9
    s_add_u32 s85, s85, 959
    v_min_u32 v252, 8, v0
    v_lshlrev_b32 v252, 7, v252
    s_lshl_b32 s27, s85, 7
    s_mov_b32 s34, 131072
    s_mov_b64 exec, 0x1ff
poll_115:
    buffer_load_dword v253, v252, s[36:39], s27 offen sc1
    s_sub_u32 s34, s34, 1
    s_waitcnt vmcnt(0)
    v_cmp_ne_u32 vcc, 1, v253
    s_cmp_eq_u32 s34, 0
    s_cbranch_scc1 polled_116
    s_cmp_eq_u64 vcc, 0
    s_cbranch_scc1 polled_116
    s_sleep 3
    s_branch poll_115
polled_116:
    s_mov_b64 exec, -1
pe_at:
    s_add_u32 s8, s62, 24707072
    s_addc_u32 s9, s63, 0
    s_mov_b32 s10, 368640
    s_mov_b32 s11, 0x00020000
    s_sub_u32 s71, s3, 4
    s_mul_i32 s72, s71, 90
    s_mul_i32 s73, s66, 5
    s_add_u32 s72, s72, s73
    s_lshl_b32 s72, s72, 10
    s_add_u32 s73, s72, 4096
    buffer_load_dwordx4 v[16:19], v1, s[8:11], s72 offen offset:0 sc1
    buffer_load_dwordx4 v[20:23], v1, s[8:11], s72 offen offset:1024 sc1
    buffer_load_dwordx4 v[24:27], v1, s[8:11], s72 offen offset:2048 sc1
    buffer_load_dwordx4 v[28:31], v1, s[8:11], s72 offen offset:3072 sc1
    buffer_load_dwordx4 v[32:35], v1, s[8:11], s73 offen offset:0 sc1
    s_add_u32 s72, s72, 10240
    s_add_u32 s4, s62, 10338304
    s_addc_u32 s5, s63, 0
    s_mov_b32 s6, 4718592
    s_mov_b32 s7, 0x00020000
    s_mul_i32 s74, s71, 1152
    s_add_u32 s74, s74, s68
    s_lshl_b32 s74, s74, 10
    s_mov_b32 s77, 0x3f803f80
    v_mov_b32 v12, s77
    v_mov_b32 v13, s77
    v_mov_b32 v14, s77
    v_mov_b32 v15, s77
    s_mul_i32 s28, s71, 6144
    v_add_u32 v6, s28, v1
    v_lshlrev_b32 v8, 7, v0
    s_mul_i32 s85, s70, 12
    s_add_u32 s85, s85, 767
    s_lshl_b32 s76, s85, 7
    s_mul_i32 s27, s71, 320
    v_add_u32 v10, s27, v0
    s_and_b32 s75, s71, 1
    s_mul_i32 s75, s75, 9216
    v_add_u32 v11, s75, v1
    s_add_u32 s73, s72, 4096
    buffer_load_dwordx4 v[36:39], v1, s[8:11], s72 offen offset:0 sc1
    buffer_load_dwordx4 v[40:43], v1, s[8:11], s72 offen offset:1024 sc1
    buffer_load_dwordx4 v[44:47], v1, s[8:11], s72 offen offset:2048 sc1
    buffer_load_dwordx4 v[48:51], v1, s[8:11], s72 offen offset:3072 sc1
    buffer_load_dwordx4 v[52:55], v1, s[8:11], s73 offen offset:0 sc1
    s_add_u32 s72, s72, 10240
    s_add_u32 s73, s72, 4096
    buffer_load_dwordx4 v[56:59], v1, s[8:11], s72 offen offset:0 sc1
    buffer_load_dwordx4 v[60:63], v1, s[8:11], s72 offen offset:1024 sc1
    buffer_load_dwordx4 v[64:67], v1, s[8:11], s72 offen offset:2048 sc1
    buffer_load_dwordx4 v[68:71], v1, s[8:11], s72 offen offset:3072 sc1
    buffer_load_dwordx4 v[72:75], v1, s[8:11], s73 offen offset:0 sc1
    s_add_u32 s72, s72, 10240
    s_waitcnt vmcnt(10)
    v_mfma_f32_16x16x32_bf16 v[232:235], v[16:19], v[12:15], 0
    v_mfma_f32_16x16x32_bf16 v[236:239], v[20:23], v[12:15], 0
    v_mfma_f32_16x16x32_bf16 v[240:243], v[24:27], v[12:15], 0
    v_mfma_f32_16x16x32_bf16 v[244:247], v[28:31], v[12:15], 0
    v_mfma_f32_16x16x32_bf16 v[248:251], v[32:35], v[12:15], 0
    s_mov_b32 exec_lo, 0x80008000
    s_mov_b32 exec_hi, 0x80008000
    v_mov_b32 v32, s77
    v_mov_b32 v33, s77
    v_mov_b32 v34, s77
    v_mov_b32 v35, s77
    s_mov_b64 exec, -1
    s_add_u32 s73, s72, 4096
    buffer_load_dwordx4 v[76:79], v1, s[8:11], s72 offen offset:0 sc1
    buffer_load_dwordx4 v[80:83], v1, s[8:11], s72 offen offset:1024 sc1
    buffer_load_dwordx4 v[84:87], v1, s[8:11], s72 offen offset:2048 sc1
    buffer_load_dwordx4 v[88:91], v1, s[8:11], s72 offen offset:3072 sc1
    buffer_load_dwordx4 v[92:95], v1, s[8:11], s73 offen offset:0 sc1
    s_add_u32 s72, s72, 10240
    s_waitcnt vmcnt(10)
    v_mfma_f32_16x16x32_bf16 v[232:235], v[36:39], v[12:15], v[232:235]
    v_mfma_f32_16x16x32_bf16 v[236:239], v[40:43], v[12:15], v[236:239]
    v_mfma_f32_16x16x32_bf16 v[240:243], v[44:47], v[12:15], v[240:243]
    v_mfma_f32_16x16x32_bf16 v[244:247], v[48:51], v[12:15], v[244:247]
    v_mfma_f32_16x16x32_bf16 v[248:251], v[52:55], v[12:15], v[248:251]
    s_mov_b32 exec_lo, 0x80008000
    s_mov_b32 exec_hi, 0x80008000
    v_mov_b32 v52, s77
    v_mov_b32 v53, s77
    v_mov_b32 v54, s77
    v_mov_b32 v55, s77
    s_mov_b64 exec, -1
    s_add_u32 s73, s72, 4096
    buffer_load_dwordx4 v[96:99], v1, s[8:11], s72 offen offset:0 sc1
    buffer_load_dwordx4 v[100:103], v1, s[8:11], s72 offen offset:1024 sc1
    buffer_load_dwordx4 v[104:107], v1, s[8:11], s72 offen offset:2048 sc1
    buffer_load_dwordx4 v[108:111], v1, s[8:11], s72 offen offset:3072 sc1
    buffer_load_dwordx4 v[112:115], v1, s[8:11], s73 offen offset:0 sc1
    s_add_u32 s72, s72, 10240
    s_waitcnt vmcnt(10)
    v_mfma_f32_16x16x32_bf16 v[232:235], v[56:59], v[12:15], v[232:235]
    v_mfma_f32_16x16x32_bf16 v[236:239], v[60:63], v[12:15], v[236:239]
    v_mfma_f32_16x16x32_bf16 v[240:243], v[64:67], v[12:15], v[240:243]
    v_mfma_f32_16x16x32_bf16 v[244:247], v[68:71], v[12:15], v[244:247]
    v_mfma_f32_16x16x32_bf16 v[248:251], v[72:75], v[12:15], v[248:251]
    s_mov_b32 exec_lo, 0x80008000
    s_mov_b32 exec_hi, 0x80008000
    v_mov_b32 v72, s77
    v_mov_b32 v73, s77
    v_mov_b32 v74, s77
    v_mov_b32 v75, s77
    s_mov_b64 exec, -1
    s_add_u32 s73, s72, 4096
    buffer_load_dwordx4 v[116:119], v1, s[8:11], s72 offen offset:0 sc1
    buffer_load_dwordx4 v[120:123], v1, s[8:11], s72 offen offset:1024 sc1
    buffer_load_dwordx4 v[124:127], v1, s[8:11], s72 offen offset:2048 sc1
    buffer_load_dwordx4 v[128:131], v1, s[8:11], s72 offen offset:3072 sc1
    buffer_load_dwordx4 v[132:135], v1, s[8:11], s73 offen offset:0 sc1
    s_add_u32 s72, s72, 10240
    s_waitcnt vmcnt(10)
    v_mfma_f32_16x16x32_bf16 v[232:235], v[76:79], v[12:15], v[232:235]
    v_mfma_f32_16x16x32_bf16 v[236:239], v[80:83], v[12:15], v[236:239]
    v_mfma_f32_16x16x32_bf16 v[240:243], v[84:87], v[12:15], v[240:243]
    v_mfma_f32_16x16x32_bf16 v[244:247], v[88:91], v[12:15], v[244:247]
    v_mfma_f32_16x16x32_bf16 v[248:251], v[92:95], v[12:15], v[248:251]
    s_mov_b32 exec_lo, 0x80008000
    s_mov_b32 exec_hi, 0x80008000
    v_mov_b32 v92, s77
    v_mov_b32 v93, s77
    v_mov_b32 v94, s77
    v_mov_b32 v95, s77
    s_mov_b64 exec, -1
    s_add_u32 s73, s72, 4096
    buffer_load_dwordx4 v[136:139], v1, s[8:11], s72 offen offset:0 sc1
    buffer_load_dwordx4 v[140:143], v1, s[8:11], s72 offen offset:1024 sc1
    buffer_load_dwordx4 v[144:147], v1, s[8:11], s72 offen offset:2048 sc1
    buffer_load_dwordx4 v[148:151], v1, s[8:11], s72 offen offset:3072 sc1
    buffer_load_dwordx4 v[152:155], v1, s[8:11], s73 offen offset:0 sc1
    s_add_u32 s72, s72, 10240
    s_mov_b64 exec, 0xfff
    buffer_load_dword v9, v8, s[36:39], s76 offen sc1
    s_mov_b64 exec, -1
    s_waitcnt vmcnt(11)
    v_mfma_f32_16x16x32_bf16 v[232:235], v[96:99], v[12:15], v[232:235]
    v_mfma_f32_16x16x32_bf16 v[236:239], v[100:103], v[12:15], v[236:239]
    v_mfma_f32_16x16x32_bf16 v[240:243], v[104:107], v[12:15], v[240:243]
    v_mfma_f32_16x16x32_bf16 v[244:247], v[108:111], v[12:15], v[244:247]
    v_mfma_f32_16x16x32_bf16 v[248:251], v[112:115], v[12:15], v[248:251]
    s_mov_b32 exec_lo, 0x80008000
    s_mov_b32 exec_hi, 0x80008000
    v_mov_b32 v112, s77
    v_mov_b32 v113, s77
    v_mov_b32 v114, s77
    v_mov_b32 v115, s77
    s_mov_b64 exec, -1
    s_add_u32 s73, s72, 4096
    buffer_load_dwordx4 v[156:159], v1, s[8:11], s72 offen offset:0 sc1
    buffer_load_dwordx4 v[160:163], v1, s[8:11], s72 offen offset:1024 sc1
    buffer_load_dwordx4 v[164:167], v1, s[8:11], s72 offen offset:2048 sc1
    buffer_load_dwordx4 v[168:171], v1, s[8:11], s72 offen offset:3072 sc1
    buffer_load_dwordx4 v[172:175], v1, s[8:11], s73 offen offset:0 sc1
    s_add_u32 s72, s72, 10240
    s_waitcnt vmcnt(11)
    v_mfma_f32_16x16x32_bf16 v[232:235], v[116:119], v[12:15], v[232:235]
    v_mfma_f32_16x16x32_bf16 v[236:239], v[120:123], v[12:15], v[236:239]
    v_mfma_f32_16x16x32_bf16 v[240:243], v[124:127], v[12:15], v[240:243]
    v_mfma_f32_16x16x32_bf16 v[244:247], v[128:131], v[12:15], v[244:247]
    v_mfma_f32_16x16x32_bf16 v[248:251], v[132:135], v[12:15], v[248:251]
    s_mov_b32 exec_lo, 0x80008000
    s_mov_b32 exec_hi, 0x80008000
    v_mov_b32 v132, s77
    v_mov_b32 v133, s77
    v_mov_b32 v134, s77
    v_mov_b32 v135, s77
    s_mov_b64 exec, -1
    s_add_u32 s73, s72, 4096
    buffer_load_dwordx4 v[176:179], v1, s[8:11], s72 offen offset:0 sc1
    buffer_load_dwordx4 v[180:183], v1, s[8:11], s72 offen offset:1024 sc1
    buffer_load_dwordx4 v[184:187], v1, s[8:11], s72 offen offset:2048 sc1
    buffer_load_dwordx4 v[188:191], v1, s[8:11], s72 offen offset:3072 sc1
    buffer_load_dwordx4 v[192:195], v1, s[8:11], s73 offen offset:0 sc1
    s_waitcnt vmcnt(11)
    v_mfma_f32_16x16x32_bf16 v[232:235], v[136:139], v[12:15], v[232:235]
    v_mfma_f32_16x16x32_bf16 v[236:239], v[140:143], v[12:15], v[236:239]
    v_mfma_f32_16x16x32_bf16 v[240:243], v[144:147], v[12:15], v[240:243]
    v_mfma_f32_16x16x32_bf16 v[244:247], v[148:151], v[12:15], v[244:247]
    v_mfma_f32_16x16x32_bf16 v[248:251], v[152:155], v[12:15], v[248:251]
    s_mov_b32 exec_lo, 0x80008000
    s_mov_b32 exec_hi, 0x80008000
    v_mov_b32 v152, s77
    v_mov_b32 v153, s77
    v_mov_b32 v154, s77
    v_mov_b32 v155, s77
    s_mov_b64 exec, -1
    s_mov_b64 exec, 0xfff
    s_waitcnt vmcnt(10)
    v_cmp_ne_u32 vcc, 1, v9
    s_mov_b64 exec, -1
    s_cmp_eq_u64 vcc, 0
    s_cselect_b32 s81, 1, 0
    s_cbranch_scc0 pe_x_late0
pe_x_go:
    buffer_load_dwordx4 v[196:199], v1, s[4:7], s74 offen sc1
    s_add_u32 s74, s74, 131072
    buffer_load_dwordx4 v[200:203], v1, s[4:7], s74 offen sc1
    s_add_u32 s74, s74, 131072
    buffer_load_dwordx4 v[204:207], v1, s[4:7], s74 offen sc1
    s_add_u32 s74, s74, 131072
    buffer_load_dwordx4 v[208:211], v1, s[4:7], s74 offen sc1
    s_add_u32 s74, s74, 131072
    buffer_load_dwordx4 v[212:215], v1, s[4:7], s74 offen sc1
    s_add_u32 s74, s74, 131072
    buffer_load_dwordx4 v[216:219], v1, s[4:7], s74 offen sc1
    s_add_u32 s74, s74, 131072
    buffer_load_dwordx4 v[220:223], v1, s[4:7], s74 offen sc1
    s_add_u32 s74, s74, 131072
    buffer_load_dwordx4 v[224:227], v1, s[4:7], s74 offen sc1
    s_add_u32 s74, s74, 131072
    buffer_load_dwordx4 v[228:231], v1, s[4:7], s74 offen sc1
    s_cmp_eq_u32 s81, 0
    s_cbranch_scc1 pe_x_done
    s_barrier
    s_waitcnt vmcnt(9)
    s_branch pe_x_late
pe_x_late0:
    s_barrier
    s_waitcnt vmcnt(0)
pe_x_late:
    v_mfma_f32_16x16x32_bf16 v[232:235], v[156:159], v[12:15], v[232:235]
    v_mfma_f32_16x16x32_bf16 v[236:239], v[160:163], v[12:15], v[236:239]
    v_mfma_f32_16x16x32_bf16 v[240:243], v[164:167], v[12:15], v[240:243]
    v_mfma_f32_16x16x32_bf16 v[244:247], v[168:171], v[12:15], v[244:247]
    v_mfma_f32_16x16x32_bf16 v[248:251], v[172:175], v[12:15], v[248:251]
    s_mov_b32 exec_lo, 0x80008000
    s_mov_b32 exec_hi, 0x80008000
    v_mov_b32 v172, s77
    v_mov_b32 v173, s77
    v_mov_b32 v174, s77
    v_mov_b32 v175, s77
    s_mov_b64 exec, -1
    v_mfma_f32_16x16x32_bf16 v[232:235], v[176:179], v[12:15], v[232:235]
    v_mfma_f32_16x16x32_bf16 v[236:239], v[180:183], v[12:15], v[236:239]
    v_mfma_f32_16x16x32_bf16 v[240:243], v[184:187], v[12:15], v[240:243]
    v_mfma_f32_16x16x32_bf16 v[244:247], v[188:191], v[12:15], v[244:247]
    v_mfma_f32_16x16x32_bf16 v[248:251], v[192:195], v[12:15], v[248:251]
    s_mov_b32 exec_lo, 0x80008000
    s_mov_b32 exec_hi, 0x80008000
    v_mov_b32 v192, s77
    v_mov_b32 v193, s77
    v_mov_b32 v194, s77
    v_mov_b32 v195, s77
    s_mov_b64 exec, -1
    s_mov_b32 exec_lo, 0x00010001
    s_mov_b32 exec_hi, 0x00010001
    ds_write_b128 v10, v[232:235] offset:0
    ds_write_b128 v10, v[236:239] offset:64
    ds_write_b128 v10, v[240:243] offset:128
    ds_write_b128 v10, v[244:247] offset:192
    ds_write_b128 v10, v[248:251] offset:256
    s_mov_b64 exec, -1
    s_waitcnt lgkmcnt(0)
    s_barrier
    s_cmp_eq_u32 s81, 1
    s_cbranch_scc1 pe_x_done
    v_min_u32 v2, 11, v0
    v_lshlrev_b32 v2, 7, v2
    s_lshl_b32 s27, s85, 7
    s_mov_b32 s34, 131072
    s_mov_b64 exec, 0xfff
poll_117:
    buffer_load_dword v3, v2, s[36:39], s27 offen sc1
    s_sub_u32 s34, s34, 1
    s_waitcnt vmcnt(0)
    v_cmp_ne_u32 vcc, 1, v3
    s_cmp_eq_u32 s34, 0
    s_cbranch_scc1 polled_118
    s_cmp_eq_u64 vcc, 0
    s_cbranch_scc1 polled_118
    s_sleep 3
    s_branch poll_117
polled_118:
    s_mov_b64 exec, -1
    s_branch pe_x_go
pe_x_done:
    s_waitcnt vmcnt(8)
    v_mfma_f32_16x16x32_bf16 v[232:235], v[16:19], v[196:199], 0
    v_mfma_f32_16x16x32_bf16 v[236:239], v[20:23], v[196:199], 0
    v_mfma_f32_16x16x32_bf16 v[240:243], v[24:27], v[196:199], 0
    v_mfma_f32_16x16x32_bf16 v[244:247], v[28:31], v[196:199], 0
    v_mfma_f32_16x16x32_bf16 v[248:251], v[32:35], v[196:199], 0
    v_mfma_f32_16x16x32_bf16 v[252:255], v[196:199], v[196:199], 0
    s_waitcnt vmcnt(7)
    v_mfma_f32_16x16x32_bf16 v[232:235], v[36:39], v[200:203], v[232:235]
    v_mfma_f32_16x16x32_bf16 v[236:239], v[40:43], v[200:203], v[236:239]
    v_mfma_f32_16x16x32_bf16 v[240:243], v[44:47], v[200:203], v[240:243]
    v_mfma_f32_16x16x32_bf16 v[244:247], v[48:51], v[200:203], v[244:247]
    v_mfma_f32_16x16x32_bf16 v[248:251], v[52:55], v[200:203], v[248:251]
    v_mfma_f32_16x16x32_bf16 v[252:255], v[200:203], v[200:203], v[252:255]
    s_waitcnt vmcnt(6)
    v_mfma_f32_16x16x32_bf16 v[232:235], v[56:59], v[204:207], v[232:235]
    v_mfma_f32_16x16x32_bf16 v[236:239], v[60:63], v[204:207], v[236:239]
    v_mfma_f32_16x16x32_bf16 v[240:243], v[64:67], v[204:207], v[240:243]
    v_mfma_f32_16x16x32_bf16 v[244:247], v[68:71], v[204:207], v[244:247]
    v_mfma_f32_16x16x32_bf16 v[248:251], v[72:75], v[204:207], v[248:251]
    v_mfma_f32_16x16x32_bf16 v[252:255], v[204:207], v[204:207], v[252:255]
    s_waitcnt vmcnt(5)
    v_mfma_f32_16x16x32_bf16 v[232:235], v[76:79], v[208:211], v[232:235]
    v_mfma_f32_16x16x32_bf16 v[236:239], v[80:83], v[208:211], v[236:239]
    v_mfma_f32_16x16x32_bf16 v[240:243], v[84:87], v[208:211], v[240:243]
    v_mfma_f32_16x16x32_bf16 v[244:247], v[88:91], v[208:211], v[244:247]
    v_mfma_f32_16x16x32_bf16 v[248:251], v[92:95], v[208:211], v[248:251]
    v_mfma_f32_16x16x32_bf16 v[252:255], v[208:211], v[208:211], v[252:255]
    s_waitcnt vmcnt(4)
    v_mfma_f32_16x16x32_bf16 v[232:235], v[96:99], v[212:215], v[232:235]
    v_mfma_f32_16x16x32_bf16 v[236:239], v[100:103], v[212:215], v[236:239]
    v_mfma_f32_16x16x32_bf16 v[240:243], v[104:107], v[212:215], v[240:243]
    v_mfma_f32_16x16x32_bf16 v[244:247], v[108:111], v[212:215], v[244:247]
    v_mfma_f32_16x16x32_bf16 v[248:251], v[112:115], v[212:215], v[248:251]
    v_mfma_f32_16x16x32_bf16 v[252:255], v[212:215], v[212:215], v[252:255]
    s_waitcnt vmcnt(3)
    v_mfma_f32_16x16x32_bf16 v[232:235], v[116:119], v[216:219], v[232:235]
    v_mfma_f32_16x16x32_bf16 v[236:239], v[120:123], v[216:219], v[236:239]
    v_mfma_f32_16x16x32_bf16 v[240:243], v[124:127], v[216:219], v[240:243]
    v_mfma_f32_16x16x32_bf16 v[244:247], v[128:131], v[216:219], v[244:247]
    v_mfma_f32_16x16x32_bf16 v[248:251], v[132:135], v[216:219], v[248:251]
    v_mfma_f32_16x16x32_bf16 v[252:255], v[216:219], v[216:219], v[252:255]
    s_waitcnt vmcnt(2)
    v_mfma_f32_16x16x32_bf16 v[232:235], v[136:139], v[220:223], v[232:235]
    v_mfma_f32_16x16x32_bf16 v[236:239], v[140:143], v[220:223], v[236:239]
    v_mfma_f32_16x16x32_bf16 v[240:243], v[144:147], v[220:223], v[240:243]
    v_mfma_f32_16x16x32_bf16 v[244:247], v[148:151], v[220:223], v[244:247]
    v_mfma_f32_16x16x32_bf16 v[248:251], v[152:155], v[220:223], v[248:251]
    v_mfma_f32_16x16x32_bf16 v[252:255], v[220:223], v[220:223], v[252:255]
    s_waitcnt vmcnt(1)
    v_mfma_f32_16x16x32_bf16 v[232:235], v[156:159], v[224:227], v[232:235]
    v_mfma_f32_16x16x32_bf16 v[236:239], v[160:163], v[224:227], v[236:239]
    v_mfma_f32_16x16x32_bf16 v[240:243], v[164:167], v[224:227], v[240:243]
    v_mfma_f32_16x16x32_bf16 v[244:247], v[168:171], v[224:227], v[244:247]
    v_mfma_f32_16x16x32_bf16 v[248:251], v[172:175], v[224:227], v[248:251]
    v_mfma_f32_16x16x32_bf16 v[252:255], v[224:227], v[224:227], v[252:255]
    s_waitcnt vmcnt(0)
    v_mfma_f32_16x16x32_bf16 v[232:235], v[176:179], v[228:231], v[232:235]
    v_mfma_f32_16x16x32_bf16 v[236:239], v[180:183], v[228:231], v[236:239]
    v_mfma_f32_16x16x32_bf16 v[240:243], v[184:187], v[228:231], v[240:243]
    v_mfma_f32_16x16x32_bf16 v[244:247], v[188:191], v[228:231], v[244:247]
    v_mfma_f32_16x16x32_bf16 v[248:251], v[192:195], v[228:231], v[248:251]
    v_mfma_f32_16x16x32_bf16 v[252:255], v[228:231], v[228:231], v[252:255]
    s_nop 2
    ds_write_b128 v6, v[232:235] offset:2048
    ds_write_b128 v6, v[236:239] offset:3072
    ds_write_b128 v6, v[240:243] offset:4096
    ds_write_b128 v6, v[244:247] offset:5120
    ds_write_b128 v6, v[248:251] offset:6144
    s_nop 0
    ds_write_b128 v6, v[252:255] offset:7168
    s_waitcnt lgkmcnt(0)
    s_barrier
    s_mov_b64 exec, -1
    s_endpgm
pe_l:
    s_add_u32 s16, s62, 25075712
    s_addc_u32 s17, s63, 0
    s_mov_b32 s18, 442368
    s_mov_b32 s19, 0x00020000
    s_mov_b32 s12, s58
    s_mov_b32 s13, s59
    s_mov_b32 s14, 4718592
    s_mov_b32 s15, 0x00020000
    s_mul_i32 s75, s3, 5
    s_min_u32 s75, s75, 14
    s_mul_i32 s73, s67, 18
    s_add_u32 s73, s73, s75
    s_mul_i32 s76, s66, 216
    s_lshl_b32 s77, s73, 1
    s_add_u32 s76, s76, s77
    s_lshl_b32 s76, s76, 10
    s_mul_i32 s72, s66, 216
    s_add_u32 s72, s72, s73
    s_add_u32 s72, s72, 144
    s_lshl_b32 s72, s72, 10
    v_lshlrev_b32 v252, 7, v0
    s_mul_i32 s85, s66, 9
    s_add_u32 s85, s85, 995
    s_lshl_b32 s77, s85, 7
    s_mov_b64 exec, 0x1ff
    buffer_load_dword v253, v252, s[36:39], s77 offen sc1
    s_mov_b64 exec, -1
    v_and_b32 v5, 3, v0
    v_lshlrev_b32 v5, 6, v5
    v_and_b32 v2, 0x3c, v0
    v_add_u32 v5, v5, v2
    v_lshrrev_b32 v6, 2, v0
    s_mov_b32 s27, 2304
    v_mul_u32_u24 v6, s27, v6
    v_and_b32 v2, 3, v0
    v_lshl_add_u32 v6, v2, 4, v6
    v_and_b32 v14, 48, v0
    s_lshl_b32 s27, s75, 10
    v_add_u32 v15, s27, v1
    s_add_u32 s4, s62, 10338304
    s_addc_u32 s5, s63, 0
    s_mov_b32 s6, 4718592
    s_mov_b32 s7, 0x00020000
    s_lshl_b32 s74, s73, 7
    s_add_u32 s74, s74, s68
    s_lshl_b32 s74, s74, 10
    v_and_b32 v7, 15, v0
    v_lshlrev_b32 v8, 4, v7
    v_lshrrev_b32 v9, 2, v7
    v_lshl_add_u32 v9, v9, 8, v8
    v_and_b32 v7, 3, v7
    v_lshl_add_u32 v9, v7, 2, v9
    s_mul_i32 s29, s68, 36864
    s_lshl_b32 s28, s73, 6
    s_add_u32 s29, s29, s28
    v_mov_b32 v4, 0xff800000
    s_mov_b64 exec, 0x1ff
    s_waitcnt vmcnt(0)
    v_cmp_ne_u32 vcc, 1, v253
    s_mov_b64 exec, -1
    s_barrier
    s_cmp_eq_u64 vcc, 0
    s_cbranch_scc1 pe_bt_go
    v_min_u32 v252, 8, v0
    v_lshlrev_b32 v252, 7, v252
    s_lshl_b32 s27, s85, 7
    s_mov_b32 s34, 131072
    s_mov_b64 exec, 0x1ff
poll_119:
    buffer_load_dword v253, v252, s[36:39], s27 offen sc1
    s_sub_u32 s34, s34, 1
    s_waitcnt vmcnt(0)
    v_cmp_ne_u32 vcc, 1, v253
    s_cmp_eq_u32 s34, 0
    s_cbranch_scc1 polled_120
    s_cmp_eq_u64 vcc, 0
    s_cbranch_scc1 polled_120
    s_sleep 3
    s_branch poll_119
polled_120:
    s_mov_b64 exec, -1
pe_bt_go:
    s_cmp_ge_u32 s3, 2
    s_cbranch_scc1 pe_no5
    s_add_u32 s77, s76, 8192
    buffer_load_dwordx4 v[48:51], v1, s[16:19], s77 offen offset:0 sc1
    buffer_load_dwordx4 v[52:55], v1, s[16:19], s77 offen offset:1024 sc1
    s_add_u32 s77, s76, 81920
    buffer_load_dwordx4 v[88:91], v1, s[16:19], s77 offen offset:0 sc1
    buffer_load_dwordx4 v[92:95], v1, s[16:19], s77 offen offset:1024 sc1
    s_add_u32 s77, s72, 4096
    buffer_load_dwordx4 v[112:115], v1, s[16:19], s77 offen offset:0 sc1
pe_no5:
    s_barrier
    ds_read_b128 v[136:139], v14 offset:0
    ds_read_b128 v[156:159], v14 offset:320
    ds_read_b128 v[176:179], v14 offset:640
    ds_read_b128 v[216:219], v14 offset:960
    ds_read_b128 v[140:143], v14 offset:64
    ds_read_b128 v[160:163], v14 offset:384
    ds_read_b128 v[180:183], v14 offset:704
    ds_read_b128 v[220:223], v14 offset:1024
    ds_read_b128 v[144:147], v14 offset:128
    ds_read_b128 v[164:167], v14 offset:448
    ds_read_b128 v[184:187], v14 offset:768
    ds_read_b128 v[224:227], v14 offset:1088
    ds_read_b128 v[148:151], v14 offset:192
    ds_read_b128 v[168:171], v14 offset:512
    ds_read_b128 v[188:191], v14 offset:832
    ds_read_b128 v[228:231], v14 offset:1152
    ds_read_b128 v[152:155], v14 offset:256
    ds_read_b128 v[172:175], v14 offset:576
    ds_read_b128 v[192:195], v14 offset:896
    ds_read_b128 v[232:235], v14 offset:1216
    s_add_u32 s77, s76, 0
    buffer_load_dwordx4 v[16:19], v1, s[16:19], s77 offen offset:0 sc1
    buffer_load_dwordx4 v[20:23], v1, s[16:19], s77 offen offset:1024 sc1
    buffer_load_dwordx4 v[24:27], v1, s[16:19], s77 offen offset:2048 sc1
    buffer_load_dwordx4 v[28:31], v1, s[16:19], s77 offen offset:3072 sc1
    s_add_u32 s77, s76, 4096
    buffer_load_dwordx4 v[32:35], v1, s[16:19], s77 offen offset:0 sc1
    buffer_load_dwordx4 v[36:39], v1, s[16:19], s77 offen offset:1024 sc1
    buffer_load_dwordx4 v[40:43], v1, s[16:19], s77 offen offset:2048 sc1
    buffer_load_dwordx4 v[44:47], v1, s[16:19], s77 offen offset:3072 sc1
    s_add_u32 s77, s76, 73728
    buffer_load_dwordx4 v[56:59], v1, s[16:19], s77 offen offset:0 sc1
    buffer_load_dwordx4 v[60:63], v1, s[16:19], s77 offen offset:1024 sc1
    buffer_load_dwordx4 v[64:67], v1, s[16:19], s77 offen offset:2048 sc1
    buffer_load_dwordx4 v[68:71], v1, s[16:19], s77 offen offset:3072 sc1
    s_add_u32 s77, s76, 77824
    buffer_load_dwordx4 v[72:75], v1, s[16:19], s77 offen offset:0 sc1
    buffer_load_dwordx4 v[76:79], v1, s[16:19], s77 offen offset:1024 sc1
    buffer_load_dwordx4 v[80:83], v1, s[16:19], s77 offen offset:2048 sc1
    buffer_load_dwordx4 v[84:87], v1, s[16:19], s77 offen offset:3072 sc1
    buffer_load_dwordx4 v[96:99], v1, s[16:19], s72 offen offset:0 sc1
    buffer_load_dwordx4 v[100:103], v1, s[16:19], s72 offen offset:1024 sc1
    buffer_load_dwordx4 v[104:107], v1, s[16:19], s72 offen offset:2048 sc1
    buffer_load_dwordx4 v[108:111], v1, s[16:19], s72 offen offset:3072 sc1
    s_waitcnt lgkmcnt(15)
    v_pk_add_f32 v[136:137], v[136:137], v[156:157]
    v_pk_add_f32 v[176:177], v[176:177], v[216:217]
    v_pk_add_f32 v[196:197], v[136:137], v[176:177]
    v_pk_add_f32 v[138:139], v[138:139], v[158:159]
    v_pk_add_f32 v[178:179], v[178:179], v[218:219]
    v_pk_add_f32 v[198:199], v[138:139], v[178:179]
    s_waitcnt lgkmcnt(12)
    v_pk_add_f32 v[140:141], v[140:141], v[160:161]
    v_pk_add_f32 v[180:181], v[180:181], v[220:221]
    v_pk_add_f32 v[200:201], v[140:141], v[180:181]
    v_pk_add_f32 v[142:143], v[142:143], v[162:163]
    v_pk_add_f32 v[182:183], v[182:183], v[222:223]
    v_pk_add_f32 v[202:203], v[142:143], v[182:183]
    s_waitcnt lgkmcnt(8)
    v_pk_add_f32 v[144:145], v[144:145], v[164:165]
    v_pk_add_f32 v[184:185], v[184:185], v[224:225]
    v_pk_add_f32 v[204:205], v[144:145], v[184:185]
    v_pk_add_f32 v[146:147], v[146:147], v[166:167]
    v_pk_add_f32 v[186:187], v[186:187], v[226:227]
    v_pk_add_f32 v[206:207], v[146:147], v[186:187]
    s_waitcnt lgkmcnt(4)
    v_pk_add_f32 v[148:149], v[148:149], v[168:169]
    v_pk_add_f32 v[188:189], v[188:189], v[228:229]
    v_pk_add_f32 v[208:209], v[148:149], v[188:189]
    v_pk_add_f32 v[150:151], v[150:151], v[170:171]
    v_pk_add_f32 v[190:191], v[190:191], v[230:231]
    v_pk_add_f32 v[210:211], v[150:151], v[190:191]
    s_waitcnt lgkmcnt(0)
    v_pk_add_f32 v[152:153], v[152:153], v[172:173]
    v_pk_add_f32 v[192:193], v[192:193], v[232:233]
    v_pk_add_f32 v[212:213], v[152:153], v[192:193]
    v_pk_add_f32 v[154:155], v[154:155], v[174:175]
    v_pk_add_f32 v[194:195], v[194:195], v[234:235]
    v_pk_add_f32 v[214:215], v[154:155], v[194:195]
    v_cmp_le_u32 vcc, 48, v0
    s_mov_b32 s78, 0x3f803f80
    s_barrier
    ds_read_b32 v248, v8 offset:6924
    ds_read_b32 v252, v9 offset:7168
    ds_read_b32 v249, v8 offset:13068
    ds_read_b32 v253, v9 offset:13312
    ds_read_b32 v250, v8 offset:19212
    ds_read_b32 v254, v9 offset:19456
    ds_read_b32 v251, v8 offset:25356
    ds_read_b32 v255, v9 offset:25600
    ds_read_b128 v[136:139], v1 offset:2048
    ds_read_b128 v[156:159], v1 offset:8192
    ds_read_b128 v[176:179], v1 offset:14336
    ds_read_b128 v[216:219], v1 offset:20480
    ds_read_b128 v[140:143], v1 offset:3072
    ds_read_b128 v[160:163], v1 offset:9216
    ds_read_b128 v[180:183], v1 offset:15360
    ds_read_b128 v[220:223], v1 offset:21504
    ds_read_b128 v[144:147], v1 offset:4096
    ds_read_b128 v[164:167], v1 offset:10240
    ds_read_b128 v[184:187], v1 offset:16384
    ds_read_b128 v[224:227], v1 offset:22528
    ds_read_b128 v[148:151], v1 offset:5120
    ds_read_b128 v[168:171], v1 offset:11264
    ds_read_b128 v[188:191], v1 offset:17408
    ds_read_b128 v[228:231], v1 offset:23552
    ds_read_b128 v[152:155], v1 offset:6144
    ds_read_b128 v[172:175], v1 offset:12288
    ds_read_b128 v[192:195], v1 offset:18432
    ds_read_b128 v[232:235], v1 offset:24576
    buffer_load_dwordx4 v[116:119], v1, s[4:7], s74 offen sc1
    s_add_u32 s74, s74, 131072
    buffer_load_dwordx4 v[120:123], v1, s[4:7], s74 offen sc1
    s_add_u32 s74, s74, 131072
    buffer_load_dwordx4 v[124:127], v1, s[4:7], s74 offen sc1
    s_add_u32 s74, s74, 131072
    buffer_load_dwordx4 v[128:131], v1, s[4:7], s74 offen sc1
    s_add_u32 s74, s74, 131072
    buffer_load_dwordx4 v[132:135], v1, s[4:7], s74 offen sc1
    s_waitcnt lgkmcnt(15)
    v_add_f32 v248, v248, v249
    v_add_f32 v250, v250, v251
    v_add_f32 v252, v252, v253
    v_add_f32 v254, v254, v255
    v_add_f32 v248, v248, v250
    v_add_f32 v252, v252, v254
    v_mul_f32 v10, 0xba638e39, v248
    v_mul_f32 v12, 0x3a638e39, v252
    v_fma_f32 v12, -v10, v10, v12
    v_max_f32 v12, 0, v12
    v_add_f32 v12, 0x3727c5ac, v12
    v_rsq_f32 v12, v12
    v_mov_b32 v11, v10
    v_mul_f32 v12, 0x3d2e1a93, v12
    s_waitcnt lgkmcnt(15)
    v_pk_add_f32 v[136:137], v[136:137], v[156:157]
    v_pk_add_f32 v[176:177], v[176:177], v[216:217]
    v_pk_add_f32 v[136:137], v[136:137], v[176:177]
    v_pk_add_f32 v[138:139], v[138:139], v[158:159]
    v_pk_add_f32 v[178:179], v[178:179], v[218:219]
    v_pk_add_f32 v[138:139], v[138:139], v[178:179]
    s_waitcnt lgkmcnt(12)
    v_pk_add_f32 v[140:141], v[140:141], v[160:161]
    v_pk_add_f32 v[180:181], v[180:181], v[220:221]
    v_pk_add_f32 v[140:141], v[140:141], v[180:181]
    v_pk_add_f32 v[142:143], v[142:143], v[162:163]
    v_pk_add_f32 v[182:183], v[182:183], v[222:223]
    v_pk_add_f32 v[142:143], v[142:143], v[182:183]
    s_waitcnt lgkmcnt(8)
    v_pk_add_f32 v[144:145], v[144:145], v[164:165]
    v_pk_add_f32 v[184:185], v[184:185], v[224:225]
    v_pk_add_f32 v[144:145], v[144:145], v[184:185]
    v_pk_add_f32 v[146:147], v[146:147], v[166:167]
    v_pk_add_f32 v[186:187], v[186:187], v[226:227]
    v_pk_add_f32 v[146:147], v[146:147], v[186:187]
    s_waitcnt lgkmcnt(4)
    v_pk_add_f32 v[148:149], v[148:149], v[168:169]
    v_pk_add_f32 v[188:189], v[188:189], v[228:229]
    v_pk_add_f32 v[148:149], v[148:149], v[188:189]
    v_pk_add_f32 v[150:151], v[150:151], v[170:171]
    v_pk_add_f32 v[190:191], v[190:191], v[230:231]
    v_pk_add_f32 v[150:151], v[150:151], v[190:191]
    s_waitcnt lgkmcnt(0)
    v_pk_add_f32 v[152:153], v[152:153], v[172:173]
    v_pk_add_f32 v[192:193], v[192:193], v[232:233]
    v_pk_add_f32 v[152:153], v[152:153], v[192:193]
    v_pk_add_f32 v[154:155], v[154:155], v[174:175]
    v_pk_add_f32 v[194:195], v[194:195], v[234:235]
    v_pk_add_f32 v[154:155], v[154:155], v[194:195]
    v_pk_fma_f32 v[136:137], v[196:197], v[10:11], v[136:137]
    v_pk_fma_f32 v[138:139], v[198:199], v[10:11], v[138:139]
    v_pk_fma_f32 v[140:141], v[200:201], v[10:11], v[140:141]
    v_pk_fma_f32 v[142:143], v[202:203], v[10:11], v[142:143]
    v_pk_fma_f32 v[144:145], v[204:205], v[10:11], v[144:145]
    v_pk_fma_f32 v[146:147], v[206:207], v[10:11], v[146:147]
    v_pk_fma_f32 v[148:149], v[208:209], v[10:11], v[148:149]
    v_pk_fma_f32 v[150:151], v[210:211], v[10:11], v[150:151]
    v_pk_fma_f32 v[152:153], v[212:213], v[10:11], v[152:153]
    v_pk_fma_f32 v[154:155], v[214:215], v[10:11], v[154:155]
    v_cndmask_b32 v153, v153, v4, vcc
    v_cndmask_b32 v154, v154, v4, vcc
    v_cndmask_b32 v155, v155, v4, vcc
    v_max3_f32 v2, v136, v137, v138
    v_max3_f32 v3, v139, v140, v141
    v_max3_f32 v3, v3, v142, v143
    v_max3_f32 v2, v2, v144, v145
    v_max3_f32 v3, v3, v146, v147
    v_max3_f32 v2, v2, v148, v149
    v_max3_f32 v3, v3, v150, v151
    v_max3_f32 v2, v2, v152, v153
    v_max3_f32 v3, v3, v154, v155
    v_max_f32 v2, v2, v3
    v_mov_b32 v3, v2
    s_nop 1
    v_permlane32_swap_b32 v2, v3
    s_nop 0
    v_max_f32 v2, v2, v3
    v_mov_b32 v3, v2
    s_nop 1
    v_permlane16_swap_b32 v2, v3
    s_nop 0
    v_max_f32 v2, v2, v3
    v_mul_f32 v2, v2, v12
    v_fma_f32 v136, v136, v12, -v2
    v_fma_f32 v137, v137, v12, -v2
    v_fma_f32 v138, v138, v12, -v2
    v_fma_f32 v139, v139, v12, -v2
    v_fma_f32 v140, v140, v12, -v2
    v_fma_f32 v141, v141, v12, -v2
    v_fma_f32 v142, v142, v12, -v2
    v_fma_f32 v143, v143, v12, -v2
    v_fma_f32 v144, v144, v12, -v2
    v_fma_f32 v145, v145, v12, -v2
    v_fma_f32 v146, v146, v12, -v2
    v_fma_f32 v147, v147, v12, -v2
    v_fma_f32 v148, v148, v12, -v2
    v_fma_f32 v149, v149, v12, -v2
    v_fma_f32 v150, v150, v12, -v2
    v_fma_f32 v151, v151, v12, -v2
    v_fma_f32 v152, v152, v12, -v2
    v_fma_f32 v153, v153, v12, -v2
    v_fma_f32 v154, v154, v12, -v2
    v_fma_f32 v155, v155, v12, -v2
    v_exp_f32 v136, v136
    v_exp_f32 v137, v137
    v_exp_f32 v138, v138
    v_exp_f32 v139, v139
    v_exp_f32 v140, v140
    v_exp_f32 v141, v141
    v_exp_f32 v142, v142
    v_exp_f32 v143, v143
    v_exp_f32 v144, v144
    v_exp_f32 v145, v145
    v_exp_f32 v146, v146
    v_exp_f32 v147, v147
    v_exp_f32 v148, v148
    v_exp_f32 v149, v149
    v_exp_f32 v150, v150
    v_exp_f32 v151, v151
    v_exp_f32 v152, v152
    v_exp_f32 v153, v153
    v_exp_f32 v154, v154
    v_exp_f32 v155, v155
    v_cvt_pk_bf16_f32 v216, v136, v137
    v_cvt_pk_bf16_f32 v217, v138, v139
    v_cvt_pk_bf16_f32 v218, v140, v141
    v_cvt_pk_bf16_f32 v219, v142, v143
    v_cvt_pk_bf16_f32 v220, v144, v145
    v_cvt_pk_bf16_f32 v221, v146, v147
    v_cvt_pk_bf16_f32 v222, v148, v149
    v_cvt_pk_bf16_f32 v223, v150, v151
    v_cvt_pk_bf16_f32 v224, v152, v153
    v_cvt_pk_bf16_f32 v225, v154, v155
    v_mov_b32 v248, s78
    v_mov_b32 v249, s78
    v_mov_b32 v250, s78
    v_mov_b32 v251, s78
    s_nop 0
    s_waitcnt vmcnt(17)
    v_mfma_f32_16x16x32_bf16 v[252:255], v[248:251], v[216:219], 0
    s_waitcnt vmcnt(0) lgkmcnt(0)
    v_lshlrev_b32 v136, 16, v116
    v_mfma_f32_16x16x32_bf16 v[156:159], v[16:19], v[216:219], 0
    v_and_b32 v137, 0xffff0000, v116
    v_lshlrev_b32 v138, 16, v117
    v_mfma_f32_16x16x32_bf16 v[160:163], v[20:23], v[216:219], 0
    v_and_b32 v139, 0xffff0000, v117
    v_lshlrev_b32 v140, 16, v118
    v_mfma_f32_16x16x32_bf16 v[164:167], v[24:27], v[216:219], 0
    v_and_b32 v141, 0xffff0000, v118
    v_lshlrev_b32 v142, 16, v119
    v_mfma_f32_16x16x32_bf16 v[168:171], v[28:31], v[216:219], 0
    v_and_b32 v143, 0xffff0000, v119
    v_lshlrev_b32 v144, 16, v120
    v_mfma_f32_16x16x32_bf16 v[172:175], v[32:35], v[216:219], 0
    v_and_b32 v145, 0xffff0000, v120
    v_lshlrev_b32 v146, 16, v121
    v_mfma_f32_16x16x32_bf16 v[176:179], v[36:39], v[216:219], 0
    v_and_b32 v147, 0xffff0000, v121
    v_lshlrev_b32 v148, 16, v122
    v_mfma_f32_16x16x32_bf16 v[180:183], v[40:43], v[216:219], 0
    v_and_b32 v149, 0xffff0000, v122
    v_lshlrev_b32 v150, 16, v123
    v_mfma_f32_16x16x32_bf16 v[184:187], v[44:47], v[216:219], 0
    v_and_b32 v151, 0xffff0000, v123
    v_lshlrev_b32 v152, 16, v124
    v_mfma_f32_16x16x32_bf16 v[188:191], v[48:51], v[216:219], 0
    v_and_b32 v153, 0xffff0000, v124
    v_lshlrev_b32 v154, 16, v125
    v_mfma_f32_16x16x32_bf16 v[192:195], v[52:55], v[216:219], 0
    v_and_b32 v155, 0xffff0000, v125
    v_lshlrev_b32 v196, 16, v126
    s_waitcnt vmcnt(9)
    v_and_b32 v197, 0xffff0000, v126
    v_lshlrev_b32 v198, 16, v127
    v_mfma_f32_16x16x32_bf16 v[252:255], v[248:251], v[220:223], v[252:255]
    v_and_b32 v199, 0xffff0000, v127
    v_lshlrev_b32 v200, 16, v128
    v_mfma_f32_16x16x32_bf16 v[156:159], v[56:59], v[220:223], v[156:159]
    v_and_b32 v201, 0xffff0000, v128
    v_lshlrev_b32 v202, 16, v129
    v_mfma_f32_16x16x32_bf16 v[160:163], v[60:63], v[220:223], v[160:163]
    v_and_b32 v203, 0xffff0000, v129
    v_lshlrev_b32 v204, 16, v130
    v_mfma_f32_16x16x32_bf16 v[164:167], v[64:67], v[220:223], v[164:167]
    v_and_b32 v205, 0xffff0000, v130
    v_lshlrev_b32 v206, 16, v131
    v_mfma_f32_16x16x32_bf16 v[168:171], v[68:71], v[220:223], v[168:171]
    v_and_b32 v207, 0xffff0000, v131
    v_lshlrev_b32 v208, 16, v132
    v_mfma_f32_16x16x32_bf16 v[172:175], v[72:75], v[220:223], v[172:175]
    v_and_b32 v209, 0xffff0000, v132
    v_lshlrev_b32 v210, 16, v133
    v_mfma_f32_16x16x32_bf16 v[176:179], v[76:79], v[220:223], v[176:179]
    v_and_b32 v211, 0xffff0000, v133
    v_lshlrev_b32 v212, 16, v134
    v_mfma_f32_16x16x32_bf16 v[180:183], v[80:83], v[220:223], v[180:183]
    v_and_b32 v213, 0xffff0000, v134
    v_lshlrev_b32 v214, 16, v135
    v_mfma_f32_16x16x32_bf16 v[184:187], v[84:87], v[220:223], v[184:187]
    v_and_b32 v215, 0xffff0000, v135
    v_mfma_f32_16x16x32_bf16 v[188:191], v[88:91], v[220:223], v[188:191]
    v_mfma_f32_16x16x32_bf16 v[192:195], v[92:95], v[220:223], v[192:195]
    s_waitcnt vmcnt(5)
    v_mfma_f32_16x16x16_bf16 v[252:255], v[248:249], v[224:225], v[252:255]
    v_mfma_f32_16x16x16_bf16 v[156:159], v[96:97], v[224:225], v[156:159]
    v_mfma_f32_16x16x16_bf16 v[160:163], v[98:99], v[224:225], v[160:163]
    v_mfma_f32_16x16x16_bf16 v[164:167], v[100:101], v[224:225], v[164:167]
    v_mfma_f32_16x16x16_bf16 v[168:171], v[102:103], v[224:225], v[168:171]
    v_mfma_f32_16x16x16_bf16 v[172:175], v[104:105], v[224:225], v[172:175]
    v_mfma_f32_16x16x16_bf16 v[176:179], v[106:107], v[224:225], v[176:179]
    v_mfma_f32_16x16x16_bf16 v[180:183], v[108:109], v[224:225], v[180:183]
    v_mfma_f32_16x16x16_bf16 v[184:187], v[110:111], v[224:225], v[184:187]
    v_mfma_f32_16x16x16_bf16 v[188:191], v[112:113], v[224:225], v[188:191]
    v_mfma_f32_16x16x16_bf16 v[192:195], v[114:115], v[224:225], v[192:195]
    v_rcp_f32 v2, v252
    s_nop 0
    v_mov_b32 v3, v2
    v_pk_fma_f32 v[156:157], v[156:157], v[2:3], v[136:137]
    v_pk_fma_f32 v[158:159], v[158:159], v[2:3], v[138:139]
    v_pk_fma_f32 v[160:161], v[160:161], v[2:3], v[140:141]
    v_pk_fma_f32 v[162:163], v[162:163], v[2:3], v[142:143]
    v_cvt_pk_bf16_f32 v116, v156, v157
    v_cvt_pk_bf16_f32 v117, v158, v159
    v_cvt_pk_bf16_f32 v118, v160, v161
    v_cvt_pk_bf16_f32 v119, v162, v163
    ds_bpermute_b32 v16, v5, v116
    ds_bpermute_b32 v17, v5, v117
    ds_bpermute_b32 v18, v5, v118
    ds_bpermute_b32 v19, v5, v119
    v_pk_fma_f32 v[164:165], v[164:165], v[2:3], v[144:145]
    v_pk_fma_f32 v[166:167], v[166:167], v[2:3], v[146:147]
    v_pk_fma_f32 v[168:169], v[168:169], v[2:3], v[148:149]
    v_pk_fma_f32 v[170:171], v[170:171], v[2:3], v[150:151]
    v_cvt_pk_bf16_f32 v120, v164, v165
    v_cvt_pk_bf16_f32 v121, v166, v167
    v_cvt_pk_bf16_f32 v122, v168, v169
    v_cvt_pk_bf16_f32 v123, v170, v171
    ds_bpermute_b32 v20, v5, v120
    ds_bpermute_b32 v21, v5, v121
    ds_bpermute_b32 v22, v5, v122
    ds_bpermute_b32 v23, v5, v123
    s_waitcnt lgkmcnt(4)
    buffer_store_dwordx4 v[16:19], v6, s[12:15], s29 offen offset:0 sc1
    v_pk_fma_f32 v[172:173], v[172:173], v[2:3], v[152:153]
    v_pk_fma_f32 v[174:175], v[174:175], v[2:3], v[154:155]
    v_pk_fma_f32 v[176:177], v[176:177], v[2:3], v[196:197]
    v_pk_fma_f32 v[178:179], v[178:179], v[2:3], v[198:199]
    v_cvt_pk_bf16_f32 v124, v172, v173
    v_cvt_pk_bf16_f32 v125, v174, v175
    v_cvt_pk_bf16_f32 v126, v176, v177
    v_cvt_pk_bf16_f32 v127, v178, v179
    ds_bpermute_b32 v24, v5, v124
    ds_bpermute_b32 v25, v5, v125
    ds_bpermute_b32 v26, v5, v126
    ds_bpermute_b32 v27, v5, v127
    s_waitcnt lgkmcnt(4)
    buffer_store_dwordx4 v[20:23], v6, s[12:15], s29 offen offset:64 sc1
    v_pk_fma_f32 v[180:181], v[180:181], v[2:3], v[200:201]
    v_pk_fma_f32 v[182:183], v[182:183], v[2:3], v[202:203]
    v_pk_fma_f32 v[184:185], v[184:185], v[2:3], v[204:205]
    v_pk_fma_f32 v[186:187], v[186:187], v[2:3], v[206:207]
    v_cvt_pk_bf16_f32 v128, v180, v181
    v_cvt_pk_bf16_f32 v129, v182, v183
    v_cvt_pk_bf16_f32 v130, v184, v185
    v_cvt_pk_bf16_f32 v131, v186, v187
    ds_bpermute_b32 v28, v5, v128
    ds_bpermute_b32 v29, v5, v129
    ds_bpermute_b32 v30, v5, v130
    ds_bpermute_b32 v31, v5, v131
    s_waitcnt lgkmcnt(4)
    buffer_store_dwordx4 v[24:27], v6, s[12:15], s29 offen offset:128 sc1
    v_pk_fma_f32 v[188:189], v[188:189], v[2:3], v[208:209]
    v_pk_fma_f32 v[190:191], v[190:191], v[2:3], v[210:211]
    v_pk_fma_f32 v[192:193], v[192:193], v[2:3], v[212:213]
    v_pk_fma_f32 v[194:195], v[194:195], v[2:3], v[214:215]
    v_cvt_pk_bf16_f32 v132, v188, v189
    v_cvt_pk_bf16_f32 v133, v190, v191
    v_cvt_pk_bf16_f32 v134, v192, v193
    v_cvt_pk_bf16_f32 v135, v194, v195
    ds_bpermute_b32 v32, v5, v132
    ds_bpermute_b32 v33, v5, v133
    ds_bpermute_b32 v34, v5, v134
    ds_bpermute_b32 v35, v5, v135
    s_waitcnt lgkmcnt(4)
    buffer_store_dwordx4 v[28:31], v6, s[12:15], s29 offen offset:192 sc1
    s_cmp_ge_u32 s3, 2
    s_cbranch_scc1 pe_no5s
    s_waitcnt lgkmcnt(0)
    buffer_store_dwordx4 v[32:35], v6, s[12:15], s29 offen offset:256 sc1
pe_no5s:
    s_mov_b64 exec, -1
    s_endpgm
.p2align 6
.type task_table,@object
task_table:
    .quad 0x700050001
    .quad 0x4700450061
    .quad 0xc07080500c1
    .quad 0xc4708458621
    .quad 0x8700858681
    .quad 0xc700c586e1
    .quad 0xc8708854c41
    .quad 0xcc708c54ca1
    .quad 0x1742058201
    .quad 0x5742458261
    .quad 0xc174a0582c1
    .quad 0xc574a454821
    .quad 0x9742854881
    .quad 0xd742c548e1
    .quad 0xc974a850e41
    .quad 0xcd74ac50ea1
    .quad 0x2784054401
    .quad 0x6784454461
    .quad 0xc278c0544c1
    .quad 0xc678c450a21
    .quad 0xa784850a81
    .quad 0xe784c50ae1
    .quad 0xca78c859041
    .quad 0xce78cc590a1
    .quad 0x3706054011
    .quad 0x7706454071
    .quad 0xc370e0540d1
    .quad 0xc770e450631
    .quad 0xb706850691
    .quad 0xf706c506f1
    .quad 0xcb70e858c51
    .quad 0xcf70ec58cb1
    .quad 0x20740150211
    .quad 0x24740550271
    .quad 0xe07481502d1
    .quad 0xe4748558831
    .quad 0x28740958891
    .quad 0x2c740d588f1
    .quad 0xe8748954e51
    .quad 0xec748d54eb1
    .quad 0x21782158411
    .quad 0x25782558471
    .quad 0xe178a1584d1
    .quad 0xe578a554a31
    .quad 0x29782954a91
    .quad 0x2d782d54af1
    .quad 0xe978a951051
    .quad 0xed78ad510b1
    .quad 0x22704158021
    .quad 0x26704558081
    .quad 0xe270c1580e1
    .quad 0xe670c554641
    .quad 0x2a7049546a1
    .quad 0x2e704d50c01
    .quad 0xea70c950c61
    .quad 0xee70cd50cc1
    .quad 0x23746154221
    .quad 0x27746554281
    .quad 0xe374e1542e1
    .quad 0xe774e550841
    .quad 0x2b7469508a1
    .quad 0x2f746d58e01
    .quad 0xeb74e958e61
    .quad 0xef74ed58ec1
    .quad 0x40780250421
    .quad 0x44780650481
    .quad 0x1007882504e1
    .quad 0x104788658a41
    .quad 0x48780a58aa1
    .quad 0x4c780e55001
    .quad 0x108788a55061
    .quad 0x10c788e550c1
    .quad 0x41702250031
    .quad 0x45702650091
    .quad 0x10170a2500f1
    .quad 0x10570a658651
    .quad 0x49702a586b1
    .quad 0x4d702e54c11
    .quad 0x10970aa54c71
    .quad 0x10d70ae54cd1
    .quad 0x42744258231
    .quad 0x46744658291
    .quad 0x10274c2582f1
    .quad 0x10674c654851
    .quad 0x4a744a548b1
    .quad 0x4e744e50e11
    .quad 0x10a74ca50e71
    .quad 0x10e74ce50ed1
    .quad 0x43786254431
    .quad 0x47786654491
    .quad 0x10378e2544f1
    .quad 0x10778e650a51
    .quad 0x4b786a50ab1
    .quad 0x4f786e59011
    .quad 0x10b78ea59071
    .quad 0x10f78ee590d1
    .quad 0x60700354041
    .quad 0x647007540a1
    .quad 0x120708350601
    .quad 0x124708750661
    .quad 0x68700b506c1
    .quad 0x6c700f58c21
    .quad 0x128708b58c81
    .quad 0x12c708f58ce1
    .quad 0x61742350241
    .quad 0x657427502a1
    .quad 0x12174a358801
    .quad 0x12574a758861
    .quad 0x69742b588c1
    .quad 0x6d742f54e21
    .quad 0x12974ab54e81
    .quad 0x12d74af54ee1
    .quad 0x62784358441
    .quad 0x667847584a1
    .quad 0x12278c354a01
    .quad 0x12678c754a61
    .quad 0x6a784b54ac1
    .quad 0x6e784f51021
    .quad 0x12a78cb51081
    .quad 0x12e78cf510e1
    .quad 0x63706358051
    .quad 0x677067580b1
    .quad 0x12370e354611
    .quad 0x12770e754671
    .quad 0x6b706b546d1
    .quad 0x6f706f50c31
    .quad 0x12b70eb50c91
    .quad 0x12f70ef50cf1
    .quad 0x8078a064251
    .quad 0x847022642b1
    .quad 0x14078a360811
    .quad 0x144702560871
    .quad 0x8874a8608d1
    .quad 0x8c70e868e31
    .quad 0x14878ac68e91
    .quad 0x14c74ec68ef1
    .quad 0x81700660451
    .quad 0x827604b1
    .quad 0x141748668a11
    .quad 0x14570a768a71
    .quad 0x8978a968ad1
    .quad 0x8d700f65031
    .quad 0x14970ad65091
    .quad 0x14d78ed650f1
    .quad 0x42660003
    .quad 0x4760403
    .quad 0x8a660603
    .quad 0x4c760a03
    .quad 0x80e60c03
    .quad 0x42f61003
    .quad 0x6f61203
    .quad 0xee61603
    .quad 0x84660013
    .quad 0x46760413
    .quad 0xc660613
    .quad 0x8e760a13
    .quad 0x2e60c13
    .quad 0x84f61013
    .quad 0x8e61213
    .quad 0x48f61613
    .quad 0x6660203
    .quad 0x8574e060c62
    .quad 0x4e660803
    .quad 0x14674e364c72
    .quad 0x44e60e03
    .quad 0x8e74e968c8202f4
    .quad 0x4ae61403
    .quad 0x8af60604
    .quad 0x40760213
    .quad 0x8678e164e62
    .quad 0x88760813
    .quad 0x14778e468e7202d4
    .quad 0x86e60e13
    .quad 0x8f78ea60e820304
    .quad 0x8ce61413
    .quad 0xcf60634
    .quad 0x8270a160294018a
    .quad 0x8770e269062
    .quad 0x14270a4602a4019a
    .quad 0x16470e56107202e4
    .quad 0x8a70aa602b401aa
    .quad 0xac7088650820314
    .quad 0x14a78cb602c401ba
    .quad 0x4ef60664
    .quad 0x8374a260002
    .quad 0xa4748060602
    .quad 0x14374a560c02
    .quad 0x165748360032
    .quad 0x8b78c860632
    .quad 0xad748960c32
    .quad 0x14b70cc60062
    .quad 0x14e708b60662
    .quad 0xa070c064202
    .quad 0xa5788164802
    .quad 0x16070c364e02
    .quad 0x166788464232
    .quad 0xa870c964832
    .quad 0xae788a64e32
    .quad 0x16874cd64262
    .quad 0x14f748c64862
    .quad 0xa174c168402
    .quad 0xa6708268a02
    .quad 0x16174c469002
    .quad 0x167708568432
    .quad 0xa974ca68a32
    .quad 0xc1944869032
    .quad 0x169780b68462
    .quad 0x16c788d68a62
    .quad 0xa278c264012
    .quad 0x101984064612
    .quad 0x16278c564c12
    .quad 0x81984364042
    .quad 0xaa780864642
    .quad 0xc0984964c42
    .quad 0x16a700c64072
    .quad 0x16d744b64672
    .quad 0xa3700068212
    .quad 0x100904168812
    .quad 0x163700368e12
    .quad 0x80904468242
    .quad 0xab700968842
    .quad 0xe1804a68e42
    .quad 0xe1940d68272
    .quad 0x16e784c68872
    .quad 0x41940160412
    .quad 0x1944260a12
    .quad 0x61940461012
    .quad 0xa1844560442
    .quad 0xa1940a60a42
    .quad 0xe0886861042
    .quad 0xe0902b60472
    .quad 0x16f704d60a72
    .quad 0x40980268022
    .quad 0x906068622
    .quad 0x60980568c22
    .quad 0xa0806368052
    .quad 0xa0902868652
    .quad 0x21806968c52
    .quad 0x101842c68082
    .quad 0xa7786b68682
    .quad 0x61842060222
    .quad 0x41846160822
    .quad 0x81842360e22
    .quad 0x1846460252
    .quad 0xc1842960852
    .quad 0x20846a60e52
    .quad 0x100882d60282
    .quad 0x21906c60882
    .quad 0x60882164422
    .quad 0x40886264a22
    .quad 0x80882465022
    .quad 0x886564452
    .quad 0xc0882a64a52
    .quad 0xaf74ab65052
    .quad 0x16b70eb64482
    .quad 0x20946d64a82
.size task_table, 2048
code_end:
    s_endpgm
.section .rodata,"a"
.p2align 6
.amdhsa_kernel standalone__pixart__diffusion_kernel
  .amdhsa_next_free_vgpr 256
  .amdhsa_next_free_sgpr 102
  .amdhsa_accum_offset 256
  .amdhsa_group_segment_fixed_size 0
  .amdhsa_kernarg_size 96
  .amdhsa_user_sgpr_count 2
  .amdhsa_user_sgpr_kernarg_segment_ptr 1
  .amdhsa_system_sgpr_workgroup_id_x 1
.end_amdhsa_kernel
```
